```python
import torch

def _softmax(x, axis=-1):
    return torch.softmax(x, dim=axis)
def _gelu(x):
    return torch.nn.functional.gelu(x, approximate="tanh")
def _silu(x):
    return torch.nn.functional.silu(x)
def _sigmoid(x):
    return torch.sigmoid(x)
def _layernorm(x, axis=-1, eps=1e-5):
    m = x.mean(dim=axis, keepdim=True)
    v = x.var(dim=axis, keepdim=True, unbiased=False)
    return (x - m) / torch.sqrt(v + eps)
def _scatter_add(tgt, idx, src, axis=0):
    return tgt.clone().index_add_(axis, idx, src)
def _segment_sum(src, seg, n):
    out = torch.zeros((n,) + src.shape[1:], dtype=src.dtype)
    return out.index_add_(0, seg, src)
def _pad(x, pw):
    flat = tuple(v for pair in reversed(pw) for v in pair)
    return torch.nn.functional.pad(x, flat)

kernel_name = 'parallel_sum__linear_attn_block__geglu_ffn__prompt'

def setup_inputs():

    _w = (lambda a: (lambda t: t.to(torch.bfloat16) if t.is_floating_point() else t)(torch.as_tensor(a)))
    def _A_setup():
        B, S, D = 1, 2048, 640
        return {
            "x": _w((lambda *s: torch.randn(*s, dtype=torch.bfloat16) * 0.05)(B, S, D)),
            "wqkv": _w((lambda *s: torch.randn(*s, dtype=torch.bfloat16) * 0.2)(D, 3 * D)),
            "wo": _w((lambda *s: torch.randn(*s, dtype=torch.bfloat16) * 0.2)(D, D)),
        }
    _A_in = _A_setup()

    def _B_setup():
        B, S, D, F = 1, 2048, 640, 1728
        return {
            "x": _w((lambda *s: torch.randn(*s, dtype=torch.bfloat16) * 0.05)(B, S, D)),
            "w_gate": _w((lambda *s: torch.randn(*s, dtype=torch.bfloat16) * 0.05)(D, F)),
            "w_up": _w((lambda *s: torch.randn(*s, dtype=torch.bfloat16) * 0.05)(D, F)),
            "w_down": _w((lambda *s: torch.randn(*s, dtype=torch.bfloat16) * 0.05)(F, D)),
        }
    _B_in = _B_setup()

    return {
        "A_x": _A_in["x"],
        "A_wqkv": _A_in["wqkv"],
        "A_wo": _A_in["wo"],
        "B_x": _B_in["x"],
        "B_w_gate": _B_in["w_gate"],
        "B_w_up": _B_in["w_up"],
        "B_w_down": _B_in["w_down"],
    }

def reference(A_x, A_wqkv, A_wo, B_x, B_w_gate, B_w_up, B_w_down):
    def _A_ref(x, wqkv, wo):
        B, S, D = x.shape
        H = 32; Dh = D // H
        qkv = (lambda x, *d: x.permute(*d))((x @ wqkv).reshape(B, S, 3, H, Dh), 2, 0, 3, 1, 4)
        q, k, v = qkv[0], qkv[1], qkv[2]
        phi = lambda t: torch.where(t > 0, t + 1, torch.exp(t)) + 1e-6
        pq, pk = phi(q), phi(k)
        kv = torch.einsum("bhsd,bhse->bhde", pk, v)
        z = torch.einsum("bhsd->bhd", pk)
        num = torch.einsum("bhqd,bhde->bhqe", pq, kv)
        den = torch.einsum("bhqd,bhd->bhq", pq, z)[..., None] + 1e-6
        o = num / den
        return (lambda x, *d: x.permute(*d))(o, 0, 2, 1, 3).reshape(B, S, D) @ wo

    def _B_ref(x, w_gate, w_up, w_down):
        return (_gelu(x @ w_gate) * (x @ w_up)) @ w_down

    x = A_x
    xn = _layernorm(x, axis=-1)
    return x + _A_ref(xn, A_wqkv, A_wo) + _B_ref(xn, B_w_gate, B_w_up, B_w_down)
```

```asm
; @launch grid=(256,1,1) block=(512,1,1) lds=163840
.amdgcn_target "amdgcn-amd-amdhsa--gfx950"
.text
.globl parallel_sum__linear_attn_block__geglu_ffn__prompt_kernel
.type parallel_sum__linear_attn_block__geglu_ffn__prompt_kernel,@function
.p2align 8
parallel_sum__linear_attn_block__geglu_ffn__prompt_kernel:
    s_cmp_ge_u32 s2, 256
    s_cbranch_scc1 L_k1_exit
    s_load_dwordx16 s[16:31], s[0:1], 0
    s_load_dwordx4 s[32:35], s[0:1], 64
    s_getpc_b64 s[10:11]
L_pc:
    s_sub_u32 s10, s10, L_pc-parallel_sum__linear_attn_block__geglu_ffn__prompt_kernel
    s_subb_u32 s11, s11, 0
    s_lshr_b32 s4, s2, 3
    s_lshl_b32 s4, s4, 7
    v_lshl_add_u32 v2, v0, 12, s4
    v_min_u32 v2, L_code_end-parallel_sum__linear_attn_block__geglu_ffn__prompt_kernel-4, v2
    v_cmp_gt_u32 vcc, 16, v0
    s_nop 0
    s_and_saveexec_b64 s[12:13], vcc
    s_cbranch_execz L_nocw
    global_load_dword v255, v2, s[10:11]
L_nocw:
    s_mov_b64 exec, s[12:13]
    v_and_b32 v1, 63, v0
    v_lshrrev_b32 v2, 6, v0
    s_nop 0
    v_readfirstlane_b32 s56, v2
    s_and_b32 s3, s2, 7
    s_lshr_b32 s4, s2, 3
    s_add_u32 s4, s4, 30
    s_and_b32 s4, s4, 31
    s_lshr_b32 s5, s3, 2
    s_and_b32 s6, s3, 3
    s_mul_i32 s7, s6, 30
    s_add_u32 s7, s7, s4
    s_lshr_b32 s58, s7, 3
    s_and_b32 s57, s7, 7
    s_lshl_b32 s8, s6, 1
    s_add_u32 s8, s8, s4
    s_sub_u32 s8, s8, 30
    s_cmp_lt_u32 s4, 30
    s_cselect_b32 s58, s58, 15
    s_cselect_b32 s57, s57, s8
    s_lshl_b32 s5, s5, 3
    s_add_u32 s57, s57, s5
    s_and_b32 s3, s57, 7
    s_lshr_b32 s4, s3, 2
    s_add_u32 s76, s3, s4
    s_lshr_b32 s4, s57, 3
    s_add_u32 s76, s76, s4
    s_waitcnt lgkmcnt(0)
    s_mov_b32 s36, s16
    s_and_b32 s37, s17, 0xffff
    s_mov_b32 s38, 2621440
    s_mov_b32 s39, 0x20000
    s_mov_b32 s44, s34
    s_and_b32 s45, s35, 0xffff
    s_mov_b32 s46, 16777216
    s_mov_b32 s47, 0x20000
    s_mov_b32 s48, s32
    s_and_b32 s49, s33, 0xffff
    s_mov_b32 s50, 256
    s_mov_b32 s51, 0x20000
    s_lshl_b32 s77, s57, 7
    s_lshl_b32 s71, s58, 3
    s_add_u32 s77, s77, s71
    s_add_u32 s77, s77, s56
    s_mul_i32 s71, s77, 1280
    v_lshlrev_b32 v2, 3, v1
    v_lshlrev_b32 v3, 2, v1
    buffer_load_dwordx2 v[56:57], v2, s[36:39], s71 offen
    buffer_load_dwordx2 v[58:59], v2, s[36:39], s71 offen offset:512
    buffer_load_dword v60, v3, s[36:39], s71 offen offset:1024
    s_cmp_eq_u32 s58, 15
    s_cbranch_scc1 L_aux
    v_lshrrev_b32 v2, 3, v1
    v_lshrrev_b32 v3, 4, v1
    v_and_b32 v4, 7, v1
    v_xor_b32 v3, v3, v4
    s_lshl_b32 s3, s57, 7
    s_and_b32 s4, s56, 3
    s_lshl_b32 s66, s4, 12
    s_lshl_b32 s4, s4, 5
    s_add_u32 s3, s3, s4
    v_add_u32 v2, s3, v2
    v_mul_u32_u24 v2, 1280, v2
    v_lshl_add_u32 v6, v3, 4, v2
    v_xor_b32 v3, 4, v3
    v_lshl_add_u32 v7, v3, 4, v2
    v_add_u32 v7, 10240, v7
    s_lshl_b32 s62, s76, 7
    s_mov_b32 s63, 0
    s_cmp_ge_u32 s58, 13
    s_cbranch_scc1 L_typeQ
    s_cmp_ge_u32 s58, 9
    s_cbranch_scc1 L_typeK
    s_lshr_b32 s72, s56, 2
    s_and_b32 s73, s56, 3
    s_mov_b32 s40, s24
    s_and_b32 s41, s25, 0xffff
    s_mov_b32 s42, 2211840
    s_mov_b32 s43, 0x20000
    s_mov_b32 s52, s26
    s_and_b32 s53, s27, 0xffff
    s_mov_b32 s54, 2211840
    s_mov_b32 s55, 0x20000
    s_and_b32 s71, s56, 3
    v_lshrrev_b32 v2, 3, v1
    s_lshl_b32 s75, s71, 3
    v_add_u32 v2, s75, v2
    v_mul_u32_u24 v2, 3456, v2
    v_and_b32 v3, 7, v1
    v_lshrrev_b32 v4, 2, v1
    v_and_b32 v4, 4, v4
    v_xor_b32 v3, v3, v4
    s_mul_i32 s75, s58, 384
    v_add_u32 v2, s75, v2
    s_and_b32 s75, s56, 1
    s_lshl_b32 s75, s75, 1
    v_xor_b32 v3, s75, v3
    v_lshl_add_u32 v8, v3, 4, v2
    v_lshl_add_u32 v9, v3, 4, v2
    s_lshr_b32 s70, s56, 2
    s_lshl_b32 s71, s71, 10
    s_add_u32 s74, s71, 155648
    s_mul_i32 s64, s70, 24576
    s_add_u32 s64, s64, s71
    s_add_u32 s64, s64, 32768
    s_mul_i32 s60, s76, 221184
    s_mul_i32 s70, s70, 110592
    s_add_u32 s60, s60, s70
    s_mov_b32 s61, 0
    s_cmp_lt_u32 s56, 4
    s_cbranch_scc1 L_G_p1
    s_add_u32 m0, s66, 0
    s_add_u32 s70, s62, 20480
    buffer_load_dwordx4 v6, s[36:39], s62 offen lds
    s_add_u32 m0, s66, 1024
    s_add_u32 s70, s62, 20480
    buffer_load_dwordx4 v7, s[36:39], s62 offen lds
    s_add_u32 m0, s66, 2048
    s_add_u32 s70, s62, 20480
    buffer_load_dwordx4 v6, s[36:39], s70 offen lds
    s_add_u32 m0, s66, 3072
    s_add_u32 s70, s62, 20480
    buffer_load_dwordx4 v7, s[36:39], s70 offen lds
    s_xor_b32 s66, s66, 16384
    s_add_u32 s62, s62, 128
    s_cmp_eq_u32 s62, 1280
    s_cselect_b32 s62, 0, s62
    s_branch L_G_p2
L_G_p1:
    s_add_u32 m0, s64, 0
    s_nop 0
    buffer_load_dwordx4 v8, s[40:43], s60 offen offset:0 lds
    s_add_u32 m0, s64, 3968
    s_nop 0
    buffer_load_dwordx4 v8, s[40:43], s60 offen offset:128 lds
    s_add_u32 m0, s64, 7936
    s_nop 0
    buffer_load_dwordx4 v8, s[40:43], s60 offen offset:256 lds
    s_add_u32 m0, s64, 12288
    s_nop 0
    buffer_load_dwordx4 v9, s[52:55], s60 offen offset:0 lds
    s_add_u32 m0, s64, 16256
    s_nop 0
    buffer_load_dwordx4 v9, s[52:55], s60 offen offset:128 lds
    s_add_u32 m0, s64, 20224
    s_nop 0
    buffer_load_dwordx4 v9, s[52:55], s60 offen offset:256 lds
    s_add_u32 s64, s64, 49152
    s_cmp_ge_u32 s64, s74
    s_cselect_b32 s70, 122880, 0
    s_sub_u32 s64, s64, s70
    s_add_u32 s60, s60, 221184
    s_cmp_ge_u32 s60, 2211840
    s_cselect_b32 s70, 2211840, 0
    s_sub_u32 s60, s60, s70
L_G_p2:
    v_and_b32 v2, 15, v1
    v_lshrrev_b32 v3, 4, v1
    v_bfe_u32 v4, v1, 1, 3
    v_xor_b32 v3, v3, v4
    s_lshl_b32 s70, s72, 13
    v_lshl_add_u32 v2, v2, 7, s70
    v_xor_b32 v4, 0, v3
    v_lshl_add_u32 v11, v4, 4, v2
    v_add_u32 v12, 2048, v11
    v_xor_b32 v4, 4, v3
    v_lshl_add_u32 v13, v4, 4, v2
    v_add_u32 v14, 2048, v13
    v_lshrrev_b32 v2, 4, v1
    v_lshlrev_b32 v2, 10, v2
    v_bfe_u32 v3, v1, 2, 2
    v_lshl_add_u32 v2, v3, 7, v2
    v_and_b32 v4, 3, v1
    v_lshl_add_u32 v2, v4, 3, v2
    v_and_b32 v3, 2, v3
    v_bfe_u32 v4, v1, 4, 1
    v_xor_b32 v3, v3, v4
    s_mul_i32 s70, s73, 3
    s_add_u32 s70, s70, 0
    s_lshr_b32 s71, s70, 2
    s_lshl_b32 s71, s71, 12
    s_and_b32 s70, s70, 3
    v_xor_b32 v4, s70, v3
    v_lshl_add_u32 v4, v4, 5, v2
    v_add_u32 v15, s71, v4
    s_mul_i32 s70, s73, 3
    s_add_u32 s70, s70, 1
    s_lshr_b32 s71, s70, 2
    s_lshl_b32 s71, s71, 12
    s_and_b32 s70, s70, 3
    v_xor_b32 v4, s70, v3
    v_lshl_add_u32 v4, v4, 5, v2
    v_add_u32 v16, s71, v4
    s_mul_i32 s70, s73, 3
    s_add_u32 s70, s70, 2
    s_lshr_b32 s71, s70, 2
    s_lshl_b32 s71, s71, 12
    s_and_b32 s70, s70, 3
    v_xor_b32 v4, s70, v3
    v_lshl_add_u32 v4, v4, 5, v2
    v_add_u32 v17, s71, v4
    s_mov_b32 s65, 32768
    v_and_b32 v25, 15, v1
    v_lshlrev_b32 v25, 8, v25
    v_add_u32 v25, 14221440, v25
    v_and_b32 v2, 15, v1
    v_bfe_u32 v3, v1, 4, 1
    v_cmp_eq_u32 vcc, v2, v3
    v_mov_b32 v4, 0x3f803f80
    s_nop 0
    v_cndmask_b32 v52, 0, v4, vcc
    v_mov_b32 v53, v52
    v_mov_b32 v54, v52
    v_mov_b32 v55, v52
    v_mov_b32 v248, 0x3f803f80
    v_mov_b32 v249, 0x3f803f80
    v_mov_b32 v250, 0x3f803f80
    v_mov_b32 v251, 0x3f803f80
    v_mov_b32 v32, 0
    v_mov_b32 v33, 0
    v_mov_b32 v34, 0
    v_mov_b32 v35, 0
    v_mov_b32 v36, 0
    v_mov_b32 v37, 0
    v_mov_b32 v38, 0
    v_mov_b32 v39, 0
    v_mov_b32 v40, 0
    v_mov_b32 v41, 0
    v_mov_b32 v42, 0
    v_mov_b32 v43, 0
    v_mov_b32 v44, 0
    v_mov_b32 v45, 0
    v_mov_b32 v46, 0
    v_mov_b32 v47, 0
    v_mov_b32 v48, 0
    v_mov_b32 v49, 0
    v_mov_b32 v50, 0
    v_mov_b32 v51, 0
    v_mov_b32 v52, 0
    v_mov_b32 v53, 0
    v_mov_b32 v54, 0
    v_mov_b32 v55, 0
    v_mov_b32 v152, 0
    v_mov_b32 v153, 0
    v_mov_b32 v154, 0
    v_mov_b32 v155, 0
    v_mov_b32 v156, 0
    v_mov_b32 v157, 0
    v_mov_b32 v158, 0
    v_mov_b32 v159, 0
    v_mov_b32 v160, 0
    v_mov_b32 v161, 0
    v_mov_b32 v162, 0
    v_mov_b32 v163, 0
    v_mov_b32 v164, 0
    v_mov_b32 v165, 0
    v_mov_b32 v166, 0
    v_mov_b32 v167, 0
    v_mov_b32 v168, 0
    v_mov_b32 v169, 0
    v_mov_b32 v170, 0
    v_mov_b32 v171, 0
    v_mov_b32 v172, 0
    v_mov_b32 v173, 0
    v_mov_b32 v174, 0
    v_mov_b32 v175, 0
    v_mov_b32 v176, 0
    v_mov_b32 v177, 0
    v_mov_b32 v178, 0
    v_mov_b32 v179, 0
    v_mov_b32 v180, 0
    v_mov_b32 v181, 0
    v_mov_b32 v182, 0
    v_mov_b32 v183, 0
    v_mov_b32 v184, 0
    v_mov_b32 v185, 0
    v_mov_b32 v186, 0
    v_mov_b32 v187, 0
    v_mov_b32 v188, 0
    v_mov_b32 v189, 0
    v_mov_b32 v190, 0
    v_mov_b32 v191, 0
    v_mov_b32 v192, 0
    v_mov_b32 v193, 0
    v_mov_b32 v194, 0
    v_mov_b32 v195, 0
    v_mov_b32 v196, 0
    v_mov_b32 v197, 0
    v_mov_b32 v198, 0
    v_mov_b32 v199, 0
    v_mov_b32 v200, 0
    v_mov_b32 v201, 0
    v_mov_b32 v202, 0
    v_mov_b32 v203, 0
    v_mov_b32 v204, 0
    v_mov_b32 v205, 0
    v_mov_b32 v206, 0
    v_mov_b32 v207, 0
    v_mov_b32 v208, 0
    v_mov_b32 v209, 0
    v_mov_b32 v210, 0
    v_mov_b32 v211, 0
    v_mov_b32 v212, 0
    v_mov_b32 v213, 0
    v_mov_b32 v214, 0
    v_mov_b32 v215, 0
    v_mov_b32 v216, 0
    v_mov_b32 v217, 0
    v_mov_b32 v218, 0
    v_mov_b32 v219, 0
    v_mov_b32 v220, 0
    v_mov_b32 v221, 0
    v_mov_b32 v222, 0
    v_mov_b32 v223, 0
    v_mov_b32 v224, 0
    v_mov_b32 v225, 0
    v_mov_b32 v226, 0
    v_mov_b32 v227, 0
    v_mov_b32 v228, 0
    v_mov_b32 v229, 0
    v_mov_b32 v230, 0
    v_mov_b32 v231, 0
    v_mov_b32 v232, 0
    v_mov_b32 v233, 0
    v_mov_b32 v234, 0
    v_mov_b32 v235, 0
    v_mov_b32 v236, 0
    v_mov_b32 v237, 0
    v_mov_b32 v238, 0
    v_mov_b32 v239, 0
    v_mov_b32 v240, 0
    v_mov_b32 v241, 0
    v_mov_b32 v242, 0
    v_mov_b32 v243, 0
    v_mov_b32 v244, 0
    v_mov_b32 v245, 0
    v_mov_b32 v246, 0
    v_mov_b32 v247, 0
    s_mov_b32 s80, 2
    s_bitcmp1_b32 0x88ff, s57
    s_cselect_b32 s68, 0, 99
    s_cmp_eq_u32 s72, 0
    s_cselect_b32 s68, s68, 99
    s_mov_b32 s70, 0xe
    s_cmp_eq_u32 s56, 0
    s_cselect_b32 s69, s70, 0
    s_cmp_eq_u32 s56, 3
    s_cselect_b32 s70, 0xc0, 0
    s_or_b32 s69, s69, s70
    s_or_b32 s69, s69, 0x300
    s_mov_b32 s59, 0
    s_mov_b32 s78, 0
    s_and_b32 s3, s2, 7
    s_lshr_b32 s4, s2, 3
    s_and_b32 s17, s4, 7
    s_lshr_b32 s4, s4, 3
    s_lshl_b32 s3, s3, 2
    s_add_u32 s16, s3, s4
    s_sub_u32 s3, s56, 4
    s_mul_i32 s4, s3, 14
    s_cmp_eq_u32 s3, 3
    s_cselect_b32 s5, 1, 0
    s_sub_u32 s4, s4, s5
    s_cmp_ge_u32 s3, 2
    s_cselect_b32 s5, 13, 14
    s_cselect_b32 s26, 1073741824, 0
    s_and_b32 s6, s16, 3
    s_lshl_b32 s6, s6, 1
    s_add_u32 s6, s6, s17
    s_mul_i32 s6, s6, 7
    s_lshr_b32 s6, s6, 2
    s_sub_u32 s7, s6, s5
    s_cmp_ge_u32 s6, s5
    s_cselect_b32 s6, s7, s6
    s_mul_i32 s22, s16, 54
    s_add_u32 s22, s22, s4
    s_lshl_b32 s22, s22, 12
    s_lshl_b32 s7, s5, 12
    s_add_u32 s23, s22, s7
    s_lshl_b32 s7, s6, 12
    s_add_u32 s18, s22, s7
    s_mul_i32 s24, s17, 74
    s_add_u32 s24, s24, s4
    s_mul_i32 s24, s24, 5120
    s_add_u32 s24, s24, 10485760
    s_mul_i32 s7, s5, 5120
    s_add_u32 s25, s24, s7
    s_mul_i32 s7, s6, 5120
    s_add_u32 s19, s24, s7
    s_cmp_lt_u32 s56, 4
    s_cselect_b32 s19, 1073741824, s19
    s_cmp_ge_u32 s56, 4
    s_cbranch_scc1 L_G_roleB
    s_waitcnt vmcnt(6)
    v_lshlrev_b32 v64, 16, v56
    v_and_b32 v65, 0xffff0000, v56
    v_lshlrev_b32 v66, 16, v57
    v_and_b32 v67, 0xffff0000, v57
    v_lshlrev_b32 v68, 16, v58
    v_and_b32 v69, 0xffff0000, v58
    v_lshlrev_b32 v70, 16, v59
    v_and_b32 v71, 0xffff0000, v59
    v_lshlrev_b32 v72, 16, v60
    v_and_b32 v73, 0xffff0000, v60
    v_add_f32 v76, v64, v65
    v_add_f32 v76, v76, v66
    v_add_f32 v76, v76, v67
    v_add_f32 v76, v76, v68
    v_add_f32 v76, v76, v69
    v_add_f32 v76, v76, v70
    v_add_f32 v76, v76, v71
    v_add_f32 v76, v76, v72
    v_add_f32 v76, v76, v73
    s_nop 1
    v_add_f32_dpp v76, v76, v76 quad_perm:[1,0,3,2] row_mask:0xf bank_mask:0xf
    s_nop 1
    v_add_f32_dpp v76, v76, v76 quad_perm:[2,3,0,1] row_mask:0xf bank_mask:0xf
    s_nop 1
    v_add_f32_dpp v76, v76, v76 row_half_mirror row_mask:0xf bank_mask:0xf
    s_nop 1
    v_add_f32_dpp v76, v76, v76 row_mirror row_mask:0xf bank_mask:0xf
    s_nop 0
    v_readlane_b32 s4, v76, 0
    v_readlane_b32 s5, v76, 16
    v_readlane_b32 s6, v76, 32
    v_readlane_b32 s7, v76, 48
    v_mov_b32 v76, s4
    v_mov_b32 v77, s6
    v_add_f32 v76, s5, v76
    v_add_f32 v77, s7, v77
    v_add_f32 v76, v76, v77
    v_mul_f32 v76, 0x3acccccd, v76
    v_sub_f32 v64, v64, v76
    v_sub_f32 v65, v65, v76
    v_sub_f32 v66, v66, v76
    v_sub_f32 v67, v67, v76
    v_sub_f32 v68, v68, v76
    v_sub_f32 v69, v69, v76
    v_sub_f32 v70, v70, v76
    v_sub_f32 v71, v71, v76
    v_sub_f32 v72, v72, v76
    v_sub_f32 v73, v73, v76
    v_mul_f32 v77, v64, v64
    v_fmac_f32 v77, v65, v65
    v_fmac_f32 v77, v66, v66
    v_fmac_f32 v77, v67, v67
    v_fmac_f32 v77, v68, v68
    v_fmac_f32 v77, v69, v69
    v_fmac_f32 v77, v70, v70
    v_fmac_f32 v77, v71, v71
    v_fmac_f32 v77, v72, v72
    v_fmac_f32 v77, v73, v73
    s_nop 1
    v_add_f32_dpp v77, v77, v77 quad_perm:[1,0,3,2] row_mask:0xf bank_mask:0xf
    s_nop 1
    v_add_f32_dpp v77, v77, v77 quad_perm:[2,3,0,1] row_mask:0xf bank_mask:0xf
    s_nop 1
    v_add_f32_dpp v77, v77, v77 row_half_mirror row_mask:0xf bank_mask:0xf
    s_nop 1
    v_add_f32_dpp v77, v77, v77 row_mirror row_mask:0xf bank_mask:0xf
    s_nop 0
    v_readlane_b32 s4, v77, 0
    v_readlane_b32 s5, v77, 16
    v_readlane_b32 s6, v77, 32
    v_readlane_b32 s7, v77, 48
    v_mov_b32 v77, s4
    v_mov_b32 v78, s6
    v_add_f32 v77, s5, v77
    v_add_f32 v78, s7, v78
    v_add_f32 v77, v77, v78
    v_mov_b32 v78, 0x3727c5ac
    v_fmac_f32 v78, 0x3acccccd, v77
    v_mov_b32 v77, v78
    v_cmp_eq_u32 vcc, 0, v1
    v_mov_b32 v4, 1073741824
    s_nop 0
    v_cndmask_b32 v2, v4, v1, vcc
    s_lshl_b32 s70, s77, 3
    s_add_u32 s70, s70, 13631488
    buffer_store_dwordx2 v[76:77], v2, s[44:47], s70 offen sc1
    s_waitcnt vmcnt(1)
    s_barrier
    v_add_u32 v20, s65, v15
    v_add_u32 v21, s65, v16
    v_add_u32 v22, s65, v17
    ds_read_b64_tr_b16 v[72:73], v20 offset:0
    ds_read_b64_tr_b16 v[74:75], v20 offset:512
    ds_read_b64_tr_b16 v[80:81], v21 offset:0
    ds_read_b64_tr_b16 v[82:83], v21 offset:512
    ds_read_b64_tr_b16 v[88:89], v22 offset:0
    ds_read_b64_tr_b16 v[90:91], v22 offset:512
    ds_read_b64_tr_b16 v[76:77], v20 offset:12288
    ds_read_b64_tr_b16 v[78:79], v20 offset:12800
    ds_read_b64_tr_b16 v[84:85], v21 offset:12288
    ds_read_b64_tr_b16 v[86:87], v21 offset:12800
    ds_read_b128 v[56:59], v11 offset:0
    ds_read_b128 v[64:67], v11 offset:4096
    ds_read_b128 v[60:63], v12 offset:0
    ds_read_b128 v[68:71], v12 offset:4096
    ds_read_b64_tr_b16 v[92:93], v22 offset:12288
    ds_read_b64_tr_b16 v[94:95], v22 offset:12800
    s_add_u32 s65, s65, 24576
    s_cmp_eq_u32 s65, 155648
    s_cselect_b32 s65, 32768, s65
    s_setprio 1
    s_waitcnt lgkmcnt(0)
    v_mfma_f32_16x16x32_bf16 v[152:155], v[72:75], v[56:59], v[152:155]
    v_mfma_f32_16x16x32_bf16 v[160:163], v[72:75], v[64:67], v[160:163]
    v_mfma_f32_16x16x32_bf16 v[156:159], v[72:75], v[60:63], v[156:159]
    v_mfma_f32_16x16x32_bf16 v[164:167], v[72:75], v[68:71], v[164:167]
    v_mfma_f32_16x16x32_bf16 v[184:187], v[80:83], v[56:59], v[184:187]
    v_mfma_f32_16x16x32_bf16 v[192:195], v[80:83], v[64:67], v[192:195]
    v_mfma_f32_16x16x32_bf16 v[188:191], v[80:83], v[60:63], v[188:191]
    v_mfma_f32_16x16x32_bf16 v[196:199], v[80:83], v[68:71], v[196:199]
    v_mfma_f32_16x16x32_bf16 v[216:219], v[88:91], v[56:59], v[216:219]
    v_mfma_f32_16x16x32_bf16 v[224:227], v[88:91], v[64:67], v[224:227]
    v_mfma_f32_16x16x32_bf16 v[220:223], v[88:91], v[60:63], v[220:223]
    v_mfma_f32_16x16x32_bf16 v[228:231], v[88:91], v[68:71], v[228:231]
    v_mfma_f32_16x16x32_bf16 v[168:171], v[76:79], v[56:59], v[168:171]
    v_mfma_f32_16x16x32_bf16 v[176:179], v[76:79], v[64:67], v[176:179]
    v_mfma_f32_16x16x32_bf16 v[172:175], v[76:79], v[60:63], v[172:175]
    v_mfma_f32_16x16x32_bf16 v[180:183], v[76:79], v[68:71], v[180:183]
    v_mfma_f32_16x16x32_bf16 v[200:203], v[84:87], v[56:59], v[200:203]
    v_mfma_f32_16x16x32_bf16 v[208:211], v[84:87], v[64:67], v[208:211]
    v_mfma_f32_16x16x32_bf16 v[204:207], v[84:87], v[60:63], v[204:207]
    v_mfma_f32_16x16x32_bf16 v[212:215], v[84:87], v[68:71], v[212:215]
    v_mfma_f32_16x16x32_bf16 v[232:235], v[92:95], v[56:59], v[232:235]
    v_mfma_f32_16x16x32_bf16 v[240:243], v[92:95], v[64:67], v[240:243]
    v_mfma_f32_16x16x32_bf16 v[236:239], v[92:95], v[60:63], v[236:239]
    v_mfma_f32_16x16x32_bf16 v[244:247], v[92:95], v[68:71], v[244:247]
    s_cmp_lg_u32 s68, 0
    s_cbranch_scc1 L_GA_pc0
    v_mfma_f32_16x16x32_bf16 v[32:35], v[72:75], v[248:251], v[32:35]
    v_mfma_f32_16x16x32_bf16 v[40:43], v[80:83], v[248:251], v[40:43]
    v_mfma_f32_16x16x32_bf16 v[48:51], v[88:91], v[248:251], v[48:51]
    v_mfma_f32_16x16x32_bf16 v[36:39], v[76:79], v[248:251], v[36:39]
    v_mfma_f32_16x16x32_bf16 v[44:47], v[84:87], v[248:251], v[44:47]
    v_mfma_f32_16x16x32_bf16 v[52:55], v[92:95], v[248:251], v[52:55]
L_GA_pc0:
    s_add_u32 m0, s64, 0
    s_nop 0
    buffer_load_dwordx4 v8, s[40:43], s60 offen offset:0 lds
    s_add_u32 m0, s64, 3968
    s_nop 0
    buffer_load_dwordx4 v8, s[40:43], s60 offen offset:128 lds
    s_add_u32 m0, s64, 7936
    s_nop 0
    buffer_load_dwordx4 v8, s[40:43], s60 offen offset:256 lds
    s_add_u32 m0, s64, 12288
    s_nop 0
    buffer_load_dwordx4 v9, s[52:55], s60 offen offset:0 lds
    s_add_u32 m0, s64, 16256
    s_nop 0
    buffer_load_dwordx4 v9, s[52:55], s60 offen offset:128 lds
    s_add_u32 m0, s64, 20224
    s_nop 0
    buffer_load_dwordx4 v9, s[52:55], s60 offen offset:256 lds
    s_add_u32 s64, s64, 49152
    s_cmp_ge_u32 s64, s74
    s_cselect_b32 s70, 122880, 0
    s_sub_u32 s64, s64, s70
    s_add_u32 s60, s60, 221184
    s_cmp_ge_u32 s60, 2211840
    s_cselect_b32 s70, 2211840, 0
    s_sub_u32 s60, s60, s70
    s_sub_u32 s81, s56, 1
    s_cmp_gt_u32 s81, 1
    s_cbranch_scc1 L_GA_nou
    s_lshl_b32 s92, s58, 4
    s_add_u32 s92, s92, s57
    s_lshl_b32 s92, s92, 1
    s_add_u32 s92, s92, s81
    s_lshl_b32 s82, s81, 12
    s_add_u32 s82, s82, 155648
    s_mul_i32 s93, s92, 205
    s_lshr_b32 s93, s93, 11
    s_mul_i32 s94, s93, 10
    s_sub_u32 s94, s92, s94
    s_cmp_lt_u32 s93, 54
    s_cselect_b32 s88, s28, s20
    s_cselect_b32 s89, s29, s21
    s_mov_b32 s90, 819200
    s_cselect_b32 s90, 2211840, s90
    s_cselect_b32 s70, 0, 54
    s_and_b32 s89, s89, 0xffff
    s_mov_b32 s91, 0x20000
    s_sub_u32 s70, s93, s70
    s_mul_i32 s70, s70, 40960
    s_lshl_b32 s71, s94, 7
    s_add_u32 s70, s70, s71
    v_lshrrev_b32 v2, 3, v1
    v_mul_u32_u24 v2, 1280, v2
    v_and_b32 v3, 7, v1
    v_lshl_add_u32 v2, v3, 4, v2
    s_add_u32 m0, s82, 0
    s_nop 0
    buffer_load_dwordx4 v2, s[88:91], s70 offen lds
    s_add_u32 s70, s70, 10240
    s_add_u32 m0, s82, 1024
    s_nop 0
    buffer_load_dwordx4 v2, s[88:91], s70 offen lds
    s_add_u32 s70, s70, 10240
    s_add_u32 m0, s82, 2048
    s_nop 0
    buffer_load_dwordx4 v2, s[88:91], s70 offen lds
    s_add_u32 s70, s70, 10240
    s_add_u32 m0, s82, 3072
    s_nop 0
    buffer_load_dwordx4 v2, s[88:91], s70 offen lds
    s_add_u32 s70, s70, 10240
L_GA_nou:
    s_barrier
    v_add_u32 v20, s65, v15
    v_add_u32 v21, s65, v16
    v_add_u32 v22, s65, v17
    ds_read_b64_tr_b16 v[120:121], v20 offset:0
    ds_read_b64_tr_b16 v[122:123], v20 offset:512
    ds_read_b64_tr_b16 v[128:129], v21 offset:0
    ds_read_b64_tr_b16 v[130:131], v21 offset:512
    ds_read_b64_tr_b16 v[136:137], v22 offset:0
    ds_read_b64_tr_b16 v[138:139], v22 offset:512
    ds_read_b64_tr_b16 v[124:125], v20 offset:12288
    ds_read_b64_tr_b16 v[126:127], v20 offset:12800
    ds_read_b64_tr_b16 v[132:133], v21 offset:12288
    ds_read_b64_tr_b16 v[134:135], v21 offset:12800
    ds_read_b128 v[104:107], v13 offset:0
    ds_read_b128 v[112:115], v13 offset:4096
    ds_read_b128 v[108:111], v14 offset:0
    ds_read_b128 v[116:119], v14 offset:4096
    ds_read_b64_tr_b16 v[140:141], v22 offset:12288
    ds_read_b64_tr_b16 v[142:143], v22 offset:12800
    s_add_u32 s65, s65, 24576
    s_cmp_eq_u32 s65, 155648
    s_cselect_b32 s65, 32768, s65
    s_waitcnt lgkmcnt(0)
    v_mfma_f32_16x16x32_bf16 v[152:155], v[120:123], v[104:107], v[152:155]
    v_mfma_f32_16x16x32_bf16 v[160:163], v[120:123], v[112:115], v[160:163]
    v_mfma_f32_16x16x32_bf16 v[156:159], v[120:123], v[108:111], v[156:159]
    v_mfma_f32_16x16x32_bf16 v[164:167], v[120:123], v[116:119], v[164:167]
    v_mfma_f32_16x16x32_bf16 v[184:187], v[128:131], v[104:107], v[184:187]
    v_mfma_f32_16x16x32_bf16 v[192:195], v[128:131], v[112:115], v[192:195]
    v_mfma_f32_16x16x32_bf16 v[188:191], v[128:131], v[108:111], v[188:191]
    v_mfma_f32_16x16x32_bf16 v[196:199], v[128:131], v[116:119], v[196:199]
    v_mfma_f32_16x16x32_bf16 v[216:219], v[136:139], v[104:107], v[216:219]
    v_mfma_f32_16x16x32_bf16 v[224:227], v[136:139], v[112:115], v[224:227]
    v_mfma_f32_16x16x32_bf16 v[220:223], v[136:139], v[108:111], v[220:223]
    v_mfma_f32_16x16x32_bf16 v[228:231], v[136:139], v[116:119], v[228:231]
    v_mfma_f32_16x16x32_bf16 v[168:171], v[124:127], v[104:107], v[168:171]
    v_mfma_f32_16x16x32_bf16 v[176:179], v[124:127], v[112:115], v[176:179]
    v_mfma_f32_16x16x32_bf16 v[172:175], v[124:127], v[108:111], v[172:175]
    v_mfma_f32_16x16x32_bf16 v[180:183], v[124:127], v[116:119], v[180:183]
    v_mfma_f32_16x16x32_bf16 v[200:203], v[132:135], v[104:107], v[200:203]
    v_mfma_f32_16x16x32_bf16 v[208:211], v[132:135], v[112:115], v[208:211]
    v_mfma_f32_16x16x32_bf16 v[204:207], v[132:135], v[108:111], v[204:207]
    v_mfma_f32_16x16x32_bf16 v[212:215], v[132:135], v[116:119], v[212:215]
    v_mfma_f32_16x16x32_bf16 v[232:235], v[140:143], v[104:107], v[232:235]
    v_mfma_f32_16x16x32_bf16 v[240:243], v[140:143], v[112:115], v[240:243]
    v_mfma_f32_16x16x32_bf16 v[236:239], v[140:143], v[108:111], v[236:239]
    v_mfma_f32_16x16x32_bf16 v[244:247], v[140:143], v[116:119], v[244:247]
    s_add_u32 m0, s64, 0
    s_nop 0
    buffer_load_dwordx4 v8, s[40:43], s60 offen offset:0 lds
    s_add_u32 m0, s64, 3968
    s_nop 0
    buffer_load_dwordx4 v8, s[40:43], s60 offen offset:128 lds
    s_add_u32 m0, s64, 7936
    s_nop 0
    buffer_load_dwordx4 v8, s[40:43], s60 offen offset:256 lds
    s_add_u32 m0, s64, 12288
    s_nop 0
    buffer_load_dwordx4 v9, s[52:55], s60 offen offset:0 lds
    s_add_u32 m0, s64, 16256
    s_nop 0
    buffer_load_dwordx4 v9, s[52:55], s60 offen offset:128 lds
    s_add_u32 m0, s64, 20224
    s_nop 0
    buffer_load_dwordx4 v9, s[52:55], s60 offen offset:256 lds
    s_add_u32 s64, s64, 49152
    s_cmp_ge_u32 s64, s74
    s_cselect_b32 s70, 122880, 0
    s_sub_u32 s64, s64, s70
    s_add_u32 s60, s60, 221184
    s_cmp_ge_u32 s60, 2211840
    s_cselect_b32 s70, 2211840, 0
    s_sub_u32 s60, s60, s70
    s_cmp_eq_u32 s68, 0
    s_cbranch_scc1 L_GA_cs1
    s_waitcnt vmcnt(6)
L_GA_pc1:
    s_cmp_gt_u32 s81, 1
    s_cbranch_scc1 L_GA_pc2
    s_mul_i32 s93, s92, 205
    s_lshr_b32 s93, s93, 11
    s_mul_i32 s94, s93, 10
    s_sub_u32 s94, s92, s94
    v_bfe_u32 v2, v1, 2, 2
    v_lshlrev_b32 v2, 7, v2
    v_and_b32 v3, 3, v1
    v_lshl_add_u32 v2, v3, 3, v2
    v_lshrrev_b32 v3, 4, v1
    s_cmp_lt_u32 s93, 54
    s_cselect_b32 s70, 10, 9
    s_movk_i32 s71, 512
    s_cselect_b32 s71, s71, 2048
    v_lshlrev_b32 v3, s70, v3
    v_add3_u32 v2, v2, v3, s82
    v_add_u32 v3, s71, v2
    ds_read_b64_tr_b16 v[96:97], v2 offset:0
    ds_read_b64_tr_b16 v[98:99], v3 offset:0
    ds_read_b64_tr_b16 v[100:101], v2 offset:32
    ds_read_b64_tr_b16 v[102:103], v3 offset:32
    ds_read_b64_tr_b16 v[144:145], v2 offset:64
    ds_read_b64_tr_b16 v[146:147], v3 offset:64
    ds_read_b64_tr_b16 v[148:149], v2 offset:96
    ds_read_b64_tr_b16 v[150:151], v3 offset:96
    v_lshlrev_b32 v4, 4, v1
    s_waitcnt lgkmcnt(0)
    s_lshl_b32 s70, s94, 2
    s_add_u32 s70, s70, 0
    s_mul_i32 s71, s70, 205
    s_lshr_b32 s71, s71, 10
    s_mul_i32 s75, s71, 365
    s_add_u32 s70, s70, s75
    s_mul_i32 s75, s93, 5
    s_add_u32 s70, s70, s75
    s_lshl_b32 s70, s70, 10
    s_add_u32 s70, s70, 10485760
    s_cmp_lt_u32 s92, 740
    s_cselect_b32 s70, s70, 1073741824
    buffer_store_dwordx4 v[96:99], v4, s[44:47], s70 offen sc1
    s_lshl_b32 s70, s94, 2
    s_add_u32 s70, s70, 1
    s_mul_i32 s71, s70, 205
    s_lshr_b32 s71, s71, 10
    s_mul_i32 s75, s71, 365
    s_add_u32 s70, s70, s75
    s_mul_i32 s75, s93, 5
    s_add_u32 s70, s70, s75
    s_lshl_b32 s70, s70, 10
    s_add_u32 s70, s70, 10485760
    s_cmp_lt_u32 s92, 740
    s_cselect_b32 s70, s70, 1073741824
    buffer_store_dwordx4 v[100:103], v4, s[44:47], s70 offen sc1
    s_lshl_b32 s70, s94, 2
    s_add_u32 s70, s70, 2
    s_mul_i32 s71, s70, 205
    s_lshr_b32 s71, s71, 10
    s_mul_i32 s75, s71, 365
    s_add_u32 s70, s70, s75
    s_mul_i32 s75, s93, 5
    s_add_u32 s70, s70, s75
    s_lshl_b32 s70, s70, 10
    s_add_u32 s70, s70, 10485760
    s_cmp_lt_u32 s92, 740
    s_cselect_b32 s70, s70, 1073741824
    buffer_store_dwordx4 v[144:147], v4, s[44:47], s70 offen sc1
    s_lshl_b32 s70, s94, 2
    s_add_u32 s70, s70, 3
    s_mul_i32 s71, s70, 205
    s_lshr_b32 s71, s71, 10
    s_mul_i32 s75, s71, 365
    s_add_u32 s70, s70, s75
    s_mul_i32 s75, s93, 5
    s_add_u32 s70, s70, s75
    s_lshl_b32 s70, s70, 10
    s_add_u32 s70, s70, 10485760
    s_cmp_lt_u32 s92, 740
    s_cselect_b32 s70, s70, 1073741824
    buffer_store_dwordx4 v[148:151], v4, s[44:47], s70 offen sc1
L_GA_pc2:
    s_barrier
    v_xor_b32 v11, 16384, v11
    v_xor_b32 v12, 16384, v12
    v_xor_b32 v13, 16384, v13
    v_xor_b32 v14, 16384, v14
    v_add_u32 v20, s65, v15
    v_add_u32 v21, s65, v16
    v_add_u32 v22, s65, v17
    ds_read_b64_tr_b16 v[72:73], v20 offset:0
    ds_read_b64_tr_b16 v[74:75], v20 offset:512
    ds_read_b64_tr_b16 v[80:81], v21 offset:0
    ds_read_b64_tr_b16 v[82:83], v21 offset:512
    ds_read_b64_tr_b16 v[88:89], v22 offset:0
    ds_read_b64_tr_b16 v[90:91], v22 offset:512
    ds_read_b64_tr_b16 v[76:77], v20 offset:12288
    ds_read_b64_tr_b16 v[78:79], v20 offset:12800
    ds_read_b64_tr_b16 v[84:85], v21 offset:12288
    ds_read_b64_tr_b16 v[86:87], v21 offset:12800
    ds_read_b128 v[56:59], v11 offset:0
    ds_read_b128 v[64:67], v11 offset:4096
    ds_read_b128 v[60:63], v12 offset:0
    ds_read_b128 v[68:71], v12 offset:4096
    ds_read_b64_tr_b16 v[92:93], v22 offset:12288
    ds_read_b64_tr_b16 v[94:95], v22 offset:12800
    s_add_u32 s65, s65, 24576
    s_cmp_eq_u32 s65, 155648
    s_cselect_b32 s65, 32768, s65
    s_mov_b32 s59, 1
    s_waitcnt lgkmcnt(0)
.p2align 6
L_GA_loop:
    v_mfma_f32_16x16x32_bf16 v[152:155], v[72:75], v[56:59], v[152:155]
    v_add_u32 v20, s65, v15
    v_add_u32 v21, s65, v16
    v_add_u32 v22, s65, v17
    v_mfma_f32_16x16x32_bf16 v[160:163], v[72:75], v[64:67], v[160:163]
    ds_read_b64_tr_b16 v[120:121], v20 offset:0
    v_mfma_f32_16x16x32_bf16 v[156:159], v[72:75], v[60:63], v[156:159]
    ds_read_b64_tr_b16 v[122:123], v20 offset:512
    v_mfma_f32_16x16x32_bf16 v[164:167], v[72:75], v[68:71], v[164:167]
    ds_read_b64_tr_b16 v[128:129], v21 offset:0
    v_mfma_f32_16x16x32_bf16 v[184:187], v[80:83], v[56:59], v[184:187]
    ds_read_b64_tr_b16 v[130:131], v21 offset:512
    v_mfma_f32_16x16x32_bf16 v[192:195], v[80:83], v[64:67], v[192:195]
    ds_read_b64_tr_b16 v[136:137], v22 offset:0
    v_mfma_f32_16x16x32_bf16 v[188:191], v[80:83], v[60:63], v[188:191]
    ds_read_b64_tr_b16 v[138:139], v22 offset:512
    v_mfma_f32_16x16x32_bf16 v[196:199], v[80:83], v[68:71], v[196:199]
    ds_read_b64_tr_b16 v[124:125], v20 offset:12288
    v_mfma_f32_16x16x32_bf16 v[216:219], v[88:91], v[56:59], v[216:219]
    ds_read_b64_tr_b16 v[126:127], v20 offset:12800
    v_mfma_f32_16x16x32_bf16 v[224:227], v[88:91], v[64:67], v[224:227]
    ds_read_b64_tr_b16 v[132:133], v21 offset:12288
    v_mfma_f32_16x16x32_bf16 v[220:223], v[88:91], v[60:63], v[220:223]
    ds_read_b64_tr_b16 v[134:135], v21 offset:12800
    v_mfma_f32_16x16x32_bf16 v[228:231], v[88:91], v[68:71], v[228:231]
    ds_read_b128 v[104:107], v13 offset:0
    v_mfma_f32_16x16x32_bf16 v[168:171], v[76:79], v[56:59], v[168:171]
    ds_read_b128 v[112:115], v13 offset:4096
    v_mfma_f32_16x16x32_bf16 v[176:179], v[76:79], v[64:67], v[176:179]
    ds_read_b128 v[108:111], v14 offset:0
    v_mfma_f32_16x16x32_bf16 v[172:175], v[76:79], v[60:63], v[172:175]
    ds_read_b128 v[116:119], v14 offset:4096
    v_mfma_f32_16x16x32_bf16 v[180:183], v[76:79], v[68:71], v[180:183]
    ds_read_b64_tr_b16 v[140:141], v22 offset:12288
    v_mfma_f32_16x16x32_bf16 v[200:203], v[84:87], v[56:59], v[200:203]
    ds_read_b64_tr_b16 v[142:143], v22 offset:12800
    v_mfma_f32_16x16x32_bf16 v[208:211], v[84:87], v[64:67], v[208:211]
    v_mfma_f32_16x16x32_bf16 v[204:207], v[84:87], v[60:63], v[204:207]
    s_add_u32 s65, s65, 24576
    s_cmp_eq_u32 s65, 155648
    s_cselect_b32 s65, 32768, s65
    v_mfma_f32_16x16x32_bf16 v[212:215], v[84:87], v[68:71], v[212:215]
    v_mfma_f32_16x16x32_bf16 v[232:235], v[92:95], v[56:59], v[232:235]
    v_mfma_f32_16x16x32_bf16 v[240:243], v[92:95], v[64:67], v[240:243]
    v_mfma_f32_16x16x32_bf16 v[236:239], v[92:95], v[60:63], v[236:239]
    v_mfma_f32_16x16x32_bf16 v[244:247], v[92:95], v[68:71], v[244:247]
    s_bitcmp1_b32 s69, s59
    s_cbranch_scc1 L_GA_spec
L_GA_specr:
    s_add_u32 m0, s64, 0
    s_nop 0
    buffer_load_dwordx4 v8, s[40:43], s60 offen offset:0 lds
    s_add_u32 m0, s64, 3968
    s_nop 0
    buffer_load_dwordx4 v8, s[40:43], s60 offen offset:128 lds
    s_add_u32 m0, s64, 7936
    s_nop 0
    buffer_load_dwordx4 v8, s[40:43], s60 offen offset:256 lds
    s_add_u32 m0, s64, 12288
    s_nop 0
    buffer_load_dwordx4 v9, s[52:55], s60 offen offset:0 lds
    s_add_u32 m0, s64, 16256
    s_nop 0
    buffer_load_dwordx4 v9, s[52:55], s60 offen offset:128 lds
    s_add_u32 m0, s64, 20224
    s_nop 0
    buffer_load_dwordx4 v9, s[52:55], s60 offen offset:256 lds
    s_add_u32 s64, s64, 49152
    s_cmp_ge_u32 s64, s74
    s_cselect_b32 s70, 122880, 0
    s_sub_u32 s64, s64, s70
    s_add_u32 s60, s60, 221184
    s_cmp_ge_u32 s60, 2211840
    s_cselect_b32 s70, 2211840, 0
    s_sub_u32 s60, s60, s70
    s_waitcnt vmcnt(6) lgkmcnt(0)
L_GA_bar:
    s_barrier
    v_mfma_f32_16x16x32_bf16 v[152:155], v[120:123], v[104:107], v[152:155]
    v_xor_b32 v11, 16384, v11
    v_xor_b32 v12, 16384, v12
    v_add_u32 v20, s65, v15
    v_add_u32 v21, s65, v16
    v_add_u32 v22, s65, v17
    v_mfma_f32_16x16x32_bf16 v[160:163], v[120:123], v[112:115], v[160:163]
    ds_read_b64_tr_b16 v[72:73], v20 offset:0
    v_mfma_f32_16x16x32_bf16 v[156:159], v[120:123], v[108:111], v[156:159]
    ds_read_b64_tr_b16 v[74:75], v20 offset:512
    v_mfma_f32_16x16x32_bf16 v[164:167], v[120:123], v[116:119], v[164:167]
    ds_read_b64_tr_b16 v[80:81], v21 offset:0
    v_mfma_f32_16x16x32_bf16 v[184:187], v[128:131], v[104:107], v[184:187]
    ds_read_b64_tr_b16 v[82:83], v21 offset:512
    v_mfma_f32_16x16x32_bf16 v[192:195], v[128:131], v[112:115], v[192:195]
    ds_read_b64_tr_b16 v[88:89], v22 offset:0
    v_mfma_f32_16x16x32_bf16 v[188:191], v[128:131], v[108:111], v[188:191]
    ds_read_b64_tr_b16 v[90:91], v22 offset:512
    v_mfma_f32_16x16x32_bf16 v[196:199], v[128:131], v[116:119], v[196:199]
    ds_read_b64_tr_b16 v[76:77], v20 offset:12288
    v_mfma_f32_16x16x32_bf16 v[216:219], v[136:139], v[104:107], v[216:219]
    ds_read_b64_tr_b16 v[78:79], v20 offset:12800
    v_mfma_f32_16x16x32_bf16 v[224:227], v[136:139], v[112:115], v[224:227]
    ds_read_b64_tr_b16 v[84:85], v21 offset:12288
    v_mfma_f32_16x16x32_bf16 v[220:223], v[136:139], v[108:111], v[220:223]
    ds_read_b64_tr_b16 v[86:87], v21 offset:12800
    v_mfma_f32_16x16x32_bf16 v[228:231], v[136:139], v[116:119], v[228:231]
    ds_read_b128 v[56:59], v11 offset:0
    v_mfma_f32_16x16x32_bf16 v[168:171], v[124:127], v[104:107], v[168:171]
    ds_read_b128 v[64:67], v11 offset:4096
    v_mfma_f32_16x16x32_bf16 v[176:179], v[124:127], v[112:115], v[176:179]
    ds_read_b128 v[60:63], v12 offset:0
    v_mfma_f32_16x16x32_bf16 v[172:175], v[124:127], v[108:111], v[172:175]
    ds_read_b128 v[68:71], v12 offset:4096
    v_mfma_f32_16x16x32_bf16 v[180:183], v[124:127], v[116:119], v[180:183]
    ds_read_b64_tr_b16 v[92:93], v22 offset:12288
    v_mfma_f32_16x16x32_bf16 v[200:203], v[132:135], v[104:107], v[200:203]
    ds_read_b64_tr_b16 v[94:95], v22 offset:12800
    v_mfma_f32_16x16x32_bf16 v[208:211], v[132:135], v[112:115], v[208:211]
    s_add_u32 s65, s65, 24576
    s_cmp_eq_u32 s65, 155648
    s_cselect_b32 s65, 32768, s65
    v_xor_b32 v13, 16384, v13
    v_mfma_f32_16x16x32_bf16 v[204:207], v[132:135], v[108:111], v[204:207]
    v_xor_b32 v14, 16384, v14
    v_mfma_f32_16x16x32_bf16 v[212:215], v[132:135], v[116:119], v[212:215]
    v_mfma_f32_16x16x32_bf16 v[232:235], v[140:143], v[104:107], v[232:235]
    v_mfma_f32_16x16x32_bf16 v[240:243], v[140:143], v[112:115], v[240:243]
    v_mfma_f32_16x16x32_bf16 v[236:239], v[140:143], v[108:111], v[236:239]
    s_add_u32 s59, s59, 1
    s_cmp_lt_u32 s59, 10
    v_mfma_f32_16x16x32_bf16 v[244:247], v[140:143], v[116:119], v[244:247]
    s_waitcnt lgkmcnt(0)
    s_cbranch_scc1 L_GA_loop
    s_branch L_G_epi
L_GA_cs1:
    v_mfma_f32_16x16x32_bf16 v[32:35], v[120:123], v[248:251], v[32:35]
    v_mfma_f32_16x16x32_bf16 v[40:43], v[128:131], v[248:251], v[40:43]
    v_mfma_f32_16x16x32_bf16 v[48:51], v[136:139], v[248:251], v[48:51]
    v_mfma_f32_16x16x32_bf16 v[36:39], v[124:127], v[248:251], v[36:39]
    v_mfma_f32_16x16x32_bf16 v[44:47], v[132:135], v[248:251], v[44:47]
    v_mfma_f32_16x16x32_bf16 v[52:55], v[140:143], v[248:251], v[52:55]
    v_and_b32 v2, 15, v1
    v_lshrrev_b32 v3, 4, v1
    v_lshlrev_b32 v3, 4, v3
    v_lshl_add_u32 v3, v2, 6, v3
    v_cmp_gt_u32 vcc, 1, v2
    v_mov_b32 v4, 1073741824
    s_nop 0
    v_cndmask_b32 v3, v4, v3, vcc
    s_mul_i32 s70, s58, 10
    s_add_u32 s70, s70, s76
    s_mul_i32 s70, s70, 1536
    s_mul_i32 s71, s73, 384
    s_add_u32 s70, s70, s71
    s_add_u32 s70, s70, 13697024
    buffer_store_dwordx4 v[32:35], v3, s[44:47], s70 offen offset:0 sc1
    buffer_store_dwordx4 v[36:39], v3, s[44:47], s70 offen offset:64 sc1
    buffer_store_dwordx4 v[40:43], v3, s[44:47], s70 offen offset:128 sc1
    buffer_store_dwordx4 v[44:47], v3, s[44:47], s70 offen offset:192 sc1
    buffer_store_dwordx4 v[48:51], v3, s[44:47], s70 offen offset:256 sc1
    buffer_store_dwordx4 v[52:55], v3, s[44:47], s70 offen offset:320 sc1
    s_waitcnt vmcnt(12)
    s_branch L_GA_pc1
L_GA_spec:
    s_cmp_eq_u32 s59, 9
    s_cbranch_scc1 L_GA_sum
    s_cmp_eq_u32 s59, 8
    s_cbranch_scc1 L_GA_go
    s_cmp_eq_u32 s59, 7
    s_cbranch_scc1 L_GA_chk
    s_cmp_eq_u32 s59, 6
    s_cbranch_scc1 L_GA_poll0
L_GA_pub:
    s_cmp_lg_u32 s59, 2
    s_cbranch_scc1 L_GA_pub1
    s_branch L_GA_wz_c
L_GA_wz:
    s_sleep 4
    buffer_load_dword v30, off, s[48:51], 0 sc1
L_GA_wz_c:
    s_waitcnt vmcnt(0)
    v_readfirstlane_b32 s70, v30
    s_add_u32 s78, s78, 1
    s_cmp_gt_u32 s78, 1048576
    s_cbranch_scc1 L_GA_wz_ok
    s_cmp_lt_u32 s70, 16
    s_cbranch_scc1 L_GA_wz
L_GA_wz_ok:
L_GA_pub1:
    s_add_u32 m0, s64, 0
    s_nop 0
    buffer_load_dwordx4 v8, s[40:43], s60 offen offset:0 lds
    s_add_u32 m0, s64, 3968
    s_nop 0
    buffer_load_dwordx4 v8, s[40:43], s60 offen offset:128 lds
    s_add_u32 m0, s64, 7936
    s_nop 0
    buffer_load_dwordx4 v8, s[40:43], s60 offen offset:256 lds
    s_add_u32 m0, s64, 12288
    s_nop 0
    buffer_load_dwordx4 v9, s[52:55], s60 offen offset:0 lds
    s_add_u32 m0, s64, 16256
    s_nop 0
    buffer_load_dwordx4 v9, s[52:55], s60 offen offset:128 lds
    s_add_u32 m0, s64, 20224
    s_nop 0
    buffer_load_dwordx4 v9, s[52:55], s60 offen offset:256 lds
    s_add_u32 s64, s64, 49152
    s_cmp_ge_u32 s64, s74
    s_cselect_b32 s70, 122880, 0
    s_sub_u32 s64, s64, s70
    s_add_u32 s60, s60, 221184
    s_cmp_ge_u32 s60, 2211840
    s_cselect_b32 s70, 2211840, 0
    s_sub_u32 s60, s60, s70
    s_cmp_eq_u32 s59, 3
    s_cbranch_scc1 L_GA_pub3
    s_cmp_eq_u32 s59, 2
    s_cbranch_scc1 L_GA_pub2
    buffer_load_dword v30, off, s[48:51], 0 sc1
    s_branch L_GA_pub3
L_GA_pub2:
    s_lshl_b32 s70, s57, 8
    s_add_u32 s70, s70, 14221440
    v_mov_b32 v2, 1073741824
    v_writelane_b32 v2, s70, 0
    v_mov_b32 v3, 1
    buffer_atomic_add v3, v2, s[44:47], 0 offen sc1
L_GA_pub3:
    s_waitcnt vmcnt(7) lgkmcnt(0)
    s_branch L_GA_bar
L_GA_poll0:
    s_add_u32 m0, s64, 0
    s_nop 0
    buffer_load_dwordx4 v8, s[40:43], s60 offen offset:0 lds
    s_add_u32 m0, s64, 3968
    s_nop 0
    buffer_load_dwordx4 v8, s[40:43], s60 offen offset:128 lds
    s_add_u32 m0, s64, 7936
    s_nop 0
    buffer_load_dwordx4 v8, s[40:43], s60 offen offset:256 lds
    s_add_u32 m0, s64, 12288
    s_nop 0
    buffer_load_dwordx4 v9, s[52:55], s60 offen offset:0 lds
    s_add_u32 m0, s64, 16256
    s_nop 0
    buffer_load_dwordx4 v9, s[52:55], s60 offen offset:128 lds
    s_add_u32 m0, s64, 20224
    s_nop 0
    buffer_load_dwordx4 v9, s[52:55], s60 offen offset:256 lds
    s_add_u32 s64, s64, 49152
    s_cmp_ge_u32 s64, s74
    s_cselect_b32 s70, 122880, 0
    s_sub_u32 s64, s64, s70
    s_add_u32 s60, s60, 221184
    s_cmp_ge_u32 s60, 2211840
    s_cselect_b32 s70, 2211840, 0
    s_sub_u32 s60, s60, s70
    buffer_load_dword v30, v25, s[44:47], 0 offen sc1
    s_waitcnt vmcnt(7) lgkmcnt(0)
    s_branch L_GA_bar
L_GA_poll:
    s_sleep 8
    buffer_load_dword v30, v25, s[44:47], 0 offen sc1
L_GA_chk:
    s_waitcnt vmcnt(0)
    v_cmp_gt_u32 vcc, 16, v30
    s_add_u32 s78, s78, 1
    s_cmp_gt_u32 s78, 1048576
    s_cbranch_scc1 L_GA_specr
    s_cmp_lg_u64 vcc, 0
    s_cbranch_scc1 L_GA_poll
    s_branch L_GA_specr
L_GA_go:
    v_lshlrev_b32 v2, 3, v0
    v_cmp_gt_u32 vcc, 192, v0
    v_mov_b32 v4, 1073741824
    s_nop 0
    v_cndmask_b32 v2, v4, v2, vcc
    s_mul_i32 s70, s58, 15360
    s_add_u32 s70, s70, 13697024
    buffer_load_dwordx2 v[32:33], v2, s[44:47], s70 offen offset:0 sc1
    buffer_load_dwordx2 v[34:35], v2, s[44:47], s70 offen offset:1536 sc1
    s_add_u32 s70, s70, 3072
    buffer_load_dwordx2 v[36:37], v2, s[44:47], s70 offen offset:0 sc1
    buffer_load_dwordx2 v[38:39], v2, s[44:47], s70 offen offset:1536 sc1
    s_add_u32 s70, s70, 3072
    buffer_load_dwordx2 v[40:41], v2, s[44:47], s70 offen offset:0 sc1
    buffer_load_dwordx2 v[42:43], v2, s[44:47], s70 offen offset:1536 sc1
    s_add_u32 s70, s70, 3072
    buffer_load_dwordx2 v[44:45], v2, s[44:47], s70 offen offset:0 sc1
    buffer_load_dwordx2 v[46:47], v2, s[44:47], s70 offen offset:1536 sc1
    s_add_u32 s70, s70, 3072
    buffer_load_dwordx2 v[48:49], v2, s[44:47], s70 offen offset:0 sc1
    buffer_load_dwordx2 v[50:51], v2, s[44:47], s70 offen offset:1536 sc1
    s_lshl_b32 s70, s57, 10
    s_add_u32 s70, s70, 13631488
    v_lshlrev_b32 v3, 2, v0
    buffer_load_dword v31, v3, s[44:47], s70 offen sc1
    s_lshr_b32 s4, s2, 3
    s_and_b32 s4, s4, 7
    s_mul_i32 s4, s4, 378880
    s_and_b32 s5, s56, 3
    s_mul_i32 s5, s5, 6144
    s_add_u32 s4, s4, s5
    s_add_u32 s4, s4, 10762240
    s_add_u32 s5, s5, 32768
    v_lshlrev_b32 v2, 4, v1
    s_add_u32 m0, s5, 0
    s_add_u32 s6, s4, 0
    buffer_load_dwordx4 v2, s[44:47], s6 offen offset:0 sc1 lds
    buffer_load_dwordx4 v2, s[44:47], s6 offen offset:1024 sc1 lds
    buffer_load_dwordx4 v2, s[44:47], s6 offen offset:2048 sc1 lds
    buffer_load_dwordx4 v2, s[44:47], s6 offen offset:3072 sc1 lds
    s_add_u32 m0, s5, 4096
    s_add_u32 s6, s4, 4096
    buffer_load_dwordx4 v2, s[44:47], s6 offen offset:0 sc1 lds
    buffer_load_dwordx4 v2, s[44:47], s6 offen offset:1024 sc1 lds
    s_waitcnt vmcnt(17) lgkmcnt(0)
    s_branch L_GA_bar
L_GA_sum:
    s_waitcnt vmcnt(6)
    v_add_f32 v32, v32, v34
    v_add_f32 v33, v33, v35
    v_add_f32 v32, v32, v36
    v_add_f32 v33, v33, v37
    v_add_f32 v32, v32, v38
    v_add_f32 v33, v33, v39
    v_add_f32 v32, v32, v40
    v_add_f32 v33, v33, v41
    v_add_f32 v32, v32, v42
    v_add_f32 v33, v33, v43
    v_add_f32 v32, v32, v44
    v_add_f32 v33, v33, v45
    v_add_f32 v32, v32, v46
    v_add_f32 v33, v33, v47
    v_add_f32 v32, v32, v48
    v_add_f32 v33, v33, v49
    v_add_f32 v32, v32, v50
    v_add_f32 v33, v33, v51
    v_lshlrev_b32 v2, 3, v0
    v_add_u32 v2, 155648, v2
    ds_write_b64 v2, v[32:33]
    v_lshlrev_b32 v3, 2, v0
    v_add_u32 v3, 157696, v3
    ds_write_b32 v3, v31
    s_lshr_b32 s4, s2, 3
    s_and_b32 s4, s4, 7
    s_mul_i32 s4, s4, 378880
    s_and_b32 s5, s56, 3
    s_mul_i32 s5, s5, 5120
    s_add_u32 s4, s4, s5
    s_add_u32 s4, s4, 10815488
    s_add_u32 s5, s5, 86016
    v_lshlrev_b32 v2, 4, v1
    s_add_u32 m0, s5, 0
    s_add_u32 s6, s4, 0
    buffer_load_dwordx4 v2, s[44:47], s6 offen offset:0 sc1 lds
    buffer_load_dwordx4 v2, s[44:47], s6 offen offset:1024 sc1 lds
    buffer_load_dwordx4 v2, s[44:47], s6 offen offset:2048 sc1 lds
    buffer_load_dwordx4 v2, s[44:47], s6 offen offset:3072 sc1 lds
    s_add_u32 m0, s5, 4096
    s_add_u32 s6, s4, 4096
    buffer_load_dwordx4 v2, s[44:47], s6 offen offset:0 sc1 lds
    s_waitcnt lgkmcnt(0)
    s_branch L_GA_bar
L_G_roleB:
    s_add_u32 m0, s64, 0
    s_nop 0
    buffer_load_dwordx4 v8, s[40:43], s60 offen offset:0 lds
    s_add_u32 m0, s64, 3968
    s_nop 0
    buffer_load_dwordx4 v8, s[40:43], s60 offen offset:128 lds
    s_add_u32 m0, s64, 7936
    s_nop 0
    buffer_load_dwordx4 v8, s[40:43], s60 offen offset:256 lds
    s_add_u32 m0, s64, 12288
    s_nop 0
    buffer_load_dwordx4 v9, s[52:55], s60 offen offset:0 lds
    s_add_u32 m0, s64, 16256
    s_nop 0
    buffer_load_dwordx4 v9, s[52:55], s60 offen offset:128 lds
    s_add_u32 m0, s64, 20224
    s_nop 0
    buffer_load_dwordx4 v9, s[52:55], s60 offen offset:256 lds
    s_add_u32 s64, s64, 49152
    s_cmp_ge_u32 s64, s74
    s_cselect_b32 s70, 122880, 0
    s_sub_u32 s64, s64, s70
    s_add_u32 s60, s60, 221184
    s_cmp_ge_u32 s60, 2211840
    s_cselect_b32 s70, 2211840, 0
    s_sub_u32 s60, s60, s70
    s_waitcnt vmcnt(10)
    v_lshlrev_b32 v64, 16, v56
    v_and_b32 v65, 0xffff0000, v56
    v_lshlrev_b32 v66, 16, v57
    v_and_b32 v67, 0xffff0000, v57
    v_lshlrev_b32 v68, 16, v58
    v_and_b32 v69, 0xffff0000, v58
    v_lshlrev_b32 v70, 16, v59
    v_and_b32 v71, 0xffff0000, v59
    v_lshlrev_b32 v72, 16, v60
    v_and_b32 v73, 0xffff0000, v60
    v_add_f32 v76, v64, v65
    v_add_f32 v76, v76, v66
    v_add_f32 v76, v76, v67
    v_add_f32 v76, v76, v68
    v_add_f32 v76, v76, v69
    v_add_f32 v76, v76, v70
    v_add_f32 v76, v76, v71
    v_add_f32 v76, v76, v72
    v_add_f32 v76, v76, v73
    s_nop 1
    v_add_f32_dpp v76, v76, v76 quad_perm:[1,0,3,2] row_mask:0xf bank_mask:0xf
    s_nop 1
    v_add_f32_dpp v76, v76, v76 quad_perm:[2,3,0,1] row_mask:0xf bank_mask:0xf
    s_nop 1
    v_add_f32_dpp v76, v76, v76 row_half_mirror row_mask:0xf bank_mask:0xf
    s_nop 1
    v_add_f32_dpp v76, v76, v76 row_mirror row_mask:0xf bank_mask:0xf
    s_nop 0
    v_readlane_b32 s4, v76, 0
    v_readlane_b32 s5, v76, 16
    v_readlane_b32 s6, v76, 32
    v_readlane_b32 s7, v76, 48
    v_mov_b32 v76, s4
    v_mov_b32 v77, s6
    v_add_f32 v76, s5, v76
    v_add_f32 v77, s7, v77
    v_add_f32 v76, v76, v77
    v_mul_f32 v76, 0x3acccccd, v76
    v_sub_f32 v64, v64, v76
    v_sub_f32 v65, v65, v76
    v_sub_f32 v66, v66, v76
    v_sub_f32 v67, v67, v76
    v_sub_f32 v68, v68, v76
    v_sub_f32 v69, v69, v76
    v_sub_f32 v70, v70, v76
    v_sub_f32 v71, v71, v76
    v_sub_f32 v72, v72, v76
    v_sub_f32 v73, v73, v76
    v_mul_f32 v77, v64, v64
    v_fmac_f32 v77, v65, v65
    v_fmac_f32 v77, v66, v66
    v_fmac_f32 v77, v67, v67
    v_fmac_f32 v77, v68, v68
    v_fmac_f32 v77, v69, v69
    v_fmac_f32 v77, v70, v70
    v_fmac_f32 v77, v71, v71
    v_fmac_f32 v77, v72, v72
    v_fmac_f32 v77, v73, v73
    s_nop 1
    v_add_f32_dpp v77, v77, v77 quad_perm:[1,0,3,2] row_mask:0xf bank_mask:0xf
    s_nop 1
    v_add_f32_dpp v77, v77, v77 quad_perm:[2,3,0,1] row_mask:0xf bank_mask:0xf
    s_nop 1
    v_add_f32_dpp v77, v77, v77 row_half_mirror row_mask:0xf bank_mask:0xf
    s_nop 1
    v_add_f32_dpp v77, v77, v77 row_mirror row_mask:0xf bank_mask:0xf
    s_nop 0
    v_readlane_b32 s4, v77, 0
    v_readlane_b32 s5, v77, 16
    v_readlane_b32 s6, v77, 32
    v_readlane_b32 s7, v77, 48
    v_mov_b32 v77, s4
    v_mov_b32 v78, s6
    v_add_f32 v77, s5, v77
    v_add_f32 v78, s7, v78
    v_add_f32 v77, v77, v78
    v_mov_b32 v78, 0x3727c5ac
    v_fmac_f32 v78, 0x3acccccd, v77
    v_mov_b32 v77, v78
    v_cmp_eq_u32 vcc, 0, v1
    v_mov_b32 v4, 1073741824
    s_nop 0
    v_cndmask_b32 v2, v4, v1, vcc
    s_lshl_b32 s70, s77, 3
    s_add_u32 s70, s70, 13631488
    buffer_store_dwordx2 v[76:77], v2, s[44:47], s70 offen sc1
    s_waitcnt vmcnt(7)
    s_barrier
    v_add_u32 v20, s65, v15
    v_add_u32 v21, s65, v16
    v_add_u32 v22, s65, v17
    ds_read_b64_tr_b16 v[72:73], v20 offset:0
    ds_read_b64_tr_b16 v[74:75], v20 offset:512
    ds_read_b64_tr_b16 v[80:81], v21 offset:0
    ds_read_b64_tr_b16 v[82:83], v21 offset:512
    ds_read_b64_tr_b16 v[88:89], v22 offset:0
    ds_read_b64_tr_b16 v[90:91], v22 offset:512
    ds_read_b64_tr_b16 v[76:77], v20 offset:12288
    ds_read_b64_tr_b16 v[78:79], v20 offset:12800
    ds_read_b64_tr_b16 v[84:85], v21 offset:12288
    ds_read_b64_tr_b16 v[86:87], v21 offset:12800
    ds_read_b128 v[56:59], v11 offset:0
    ds_read_b128 v[64:67], v11 offset:4096
    ds_read_b128 v[60:63], v12 offset:0
    ds_read_b128 v[68:71], v12 offset:4096
    ds_read_b64_tr_b16 v[92:93], v22 offset:12288
    ds_read_b64_tr_b16 v[94:95], v22 offset:12800
    s_add_u32 s65, s65, 24576
    s_cmp_eq_u32 s65, 155648
    s_cselect_b32 s65, 32768, s65
    s_add_u32 m0, s66, 0
    s_add_u32 s70, s62, 20480
    buffer_load_dwordx4 v6, s[36:39], s62 offen lds
    s_add_u32 m0, s66, 1024
    s_add_u32 s70, s62, 20480
    buffer_load_dwordx4 v7, s[36:39], s62 offen lds
    s_add_u32 m0, s66, 2048
    s_add_u32 s70, s62, 20480
    buffer_load_dwordx4 v6, s[36:39], s70 offen lds
    s_add_u32 m0, s66, 3072
    s_add_u32 s70, s62, 20480
    buffer_load_dwordx4 v7, s[36:39], s70 offen lds
    s_xor_b32 s66, s66, 16384
    s_add_u32 s62, s62, 128
    s_cmp_eq_u32 s62, 1280
    s_cselect_b32 s62, 0, s62
    s_waitcnt lgkmcnt(0)
    v_mfma_f32_16x16x32_bf16 v[152:155], v[72:75], v[56:59], v[152:155]
    v_mfma_f32_16x16x32_bf16 v[160:163], v[72:75], v[64:67], v[160:163]
    v_mfma_f32_16x16x32_bf16 v[156:159], v[72:75], v[60:63], v[156:159]
    v_mfma_f32_16x16x32_bf16 v[164:167], v[72:75], v[68:71], v[164:167]
    v_mfma_f32_16x16x32_bf16 v[184:187], v[80:83], v[56:59], v[184:187]
    v_mfma_f32_16x16x32_bf16 v[192:195], v[80:83], v[64:67], v[192:195]
    v_mfma_f32_16x16x32_bf16 v[188:191], v[80:83], v[60:63], v[188:191]
    v_mfma_f32_16x16x32_bf16 v[196:199], v[80:83], v[68:71], v[196:199]
    v_mfma_f32_16x16x32_bf16 v[216:219], v[88:91], v[56:59], v[216:219]
    v_mfma_f32_16x16x32_bf16 v[224:227], v[88:91], v[64:67], v[224:227]
    v_mfma_f32_16x16x32_bf16 v[220:223], v[88:91], v[60:63], v[220:223]
    v_mfma_f32_16x16x32_bf16 v[228:231], v[88:91], v[68:71], v[228:231]
    v_mfma_f32_16x16x32_bf16 v[168:171], v[76:79], v[56:59], v[168:171]
    v_mfma_f32_16x16x32_bf16 v[176:179], v[76:79], v[64:67], v[176:179]
    v_mfma_f32_16x16x32_bf16 v[172:175], v[76:79], v[60:63], v[172:175]
    v_mfma_f32_16x16x32_bf16 v[180:183], v[76:79], v[68:71], v[180:183]
    v_mfma_f32_16x16x32_bf16 v[200:203], v[84:87], v[56:59], v[200:203]
    v_mfma_f32_16x16x32_bf16 v[208:211], v[84:87], v[64:67], v[208:211]
    v_mfma_f32_16x16x32_bf16 v[204:207], v[84:87], v[60:63], v[204:207]
    v_mfma_f32_16x16x32_bf16 v[212:215], v[84:87], v[68:71], v[212:215]
    v_mfma_f32_16x16x32_bf16 v[232:235], v[92:95], v[56:59], v[232:235]
    v_mfma_f32_16x16x32_bf16 v[240:243], v[92:95], v[64:67], v[240:243]
    v_mfma_f32_16x16x32_bf16 v[236:239], v[92:95], v[60:63], v[236:239]
    v_mfma_f32_16x16x32_bf16 v[244:247], v[92:95], v[68:71], v[244:247]
    s_waitcnt vmcnt(5)
    s_barrier
    v_add_u32 v20, s65, v15
    v_add_u32 v21, s65, v16
    v_add_u32 v22, s65, v17
    ds_read_b64_tr_b16 v[120:121], v20 offset:0
    ds_read_b64_tr_b16 v[122:123], v20 offset:512
    ds_read_b64_tr_b16 v[128:129], v21 offset:0
    ds_read_b64_tr_b16 v[130:131], v21 offset:512
    ds_read_b64_tr_b16 v[136:137], v22 offset:0
    ds_read_b64_tr_b16 v[138:139], v22 offset:512
    ds_read_b64_tr_b16 v[124:125], v20 offset:12288
    ds_read_b64_tr_b16 v[126:127], v20 offset:12800
    ds_read_b64_tr_b16 v[132:133], v21 offset:12288
    ds_read_b64_tr_b16 v[134:135], v21 offset:12800
    ds_read_b128 v[104:107], v13 offset:0
    ds_read_b128 v[112:115], v13 offset:4096
    ds_read_b128 v[108:111], v14 offset:0
    ds_read_b128 v[116:119], v14 offset:4096
    ds_read_b64_tr_b16 v[140:141], v22 offset:12288
    ds_read_b64_tr_b16 v[142:143], v22 offset:12800
    s_add_u32 s65, s65, 24576
    s_cmp_eq_u32 s65, 155648
    s_cselect_b32 s65, 32768, s65
    s_add_u32 m0, s64, 0
    s_nop 0
    buffer_load_dwordx4 v8, s[40:43], s60 offen offset:0 lds
    s_add_u32 m0, s64, 3968
    s_nop 0
    buffer_load_dwordx4 v8, s[40:43], s60 offen offset:128 lds
    s_add_u32 m0, s64, 7936
    s_nop 0
    buffer_load_dwordx4 v8, s[40:43], s60 offen offset:256 lds
    s_add_u32 m0, s64, 12288
    s_nop 0
    buffer_load_dwordx4 v9, s[52:55], s60 offen offset:0 lds
    s_add_u32 m0, s64, 16256
    s_nop 0
    buffer_load_dwordx4 v9, s[52:55], s60 offen offset:128 lds
    s_add_u32 m0, s64, 20224
    s_nop 0
    buffer_load_dwordx4 v9, s[52:55], s60 offen offset:256 lds
    s_add_u32 s64, s64, 49152
    s_cmp_ge_u32 s64, s74
    s_cselect_b32 s70, 122880, 0
    s_sub_u32 s64, s64, s70
    s_add_u32 s60, s60, 221184
    s_cmp_ge_u32 s60, 2211840
    s_cselect_b32 s70, 2211840, 0
    s_sub_u32 s60, s60, s70
    s_waitcnt lgkmcnt(0)
    v_mfma_f32_16x16x32_bf16 v[152:155], v[120:123], v[104:107], v[152:155]
    v_mfma_f32_16x16x32_bf16 v[160:163], v[120:123], v[112:115], v[160:163]
    v_mfma_f32_16x16x32_bf16 v[156:159], v[120:123], v[108:111], v[156:159]
    v_mfma_f32_16x16x32_bf16 v[164:167], v[120:123], v[116:119], v[164:167]
    v_mfma_f32_16x16x32_bf16 v[184:187], v[128:131], v[104:107], v[184:187]
    v_mfma_f32_16x16x32_bf16 v[192:195], v[128:131], v[112:115], v[192:195]
    v_mfma_f32_16x16x32_bf16 v[188:191], v[128:131], v[108:111], v[188:191]
    v_mfma_f32_16x16x32_bf16 v[196:199], v[128:131], v[116:119], v[196:199]
    v_mfma_f32_16x16x32_bf16 v[216:219], v[136:139], v[104:107], v[216:219]
    v_mfma_f32_16x16x32_bf16 v[224:227], v[136:139], v[112:115], v[224:227]
    v_mfma_f32_16x16x32_bf16 v[220:223], v[136:139], v[108:111], v[220:223]
    v_mfma_f32_16x16x32_bf16 v[228:231], v[136:139], v[116:119], v[228:231]
    v_mfma_f32_16x16x32_bf16 v[168:171], v[124:127], v[104:107], v[168:171]
    v_mfma_f32_16x16x32_bf16 v[176:179], v[124:127], v[112:115], v[176:179]
    v_mfma_f32_16x16x32_bf16 v[172:175], v[124:127], v[108:111], v[172:175]
    v_mfma_f32_16x16x32_bf16 v[180:183], v[124:127], v[116:119], v[180:183]
    v_mfma_f32_16x16x32_bf16 v[200:203], v[132:135], v[104:107], v[200:203]
    v_mfma_f32_16x16x32_bf16 v[208:211], v[132:135], v[112:115], v[208:211]
    v_mfma_f32_16x16x32_bf16 v[204:207], v[132:135], v[108:111], v[204:207]
    v_mfma_f32_16x16x32_bf16 v[212:215], v[132:135], v[116:119], v[212:215]
    v_mfma_f32_16x16x32_bf16 v[232:235], v[140:143], v[104:107], v[232:235]
    v_mfma_f32_16x16x32_bf16 v[240:243], v[140:143], v[112:115], v[240:243]
    v_mfma_f32_16x16x32_bf16 v[236:239], v[140:143], v[108:111], v[236:239]
    v_mfma_f32_16x16x32_bf16 v[244:247], v[140:143], v[116:119], v[244:247]
    s_waitcnt vmcnt(0)
    s_barrier
    s_add_u32 m0, s66, 0
    s_add_u32 s70, s62, 20480
    buffer_load_dwordx4 v6, s[36:39], s62 offen lds
    s_add_u32 m0, s66, 1024
    s_add_u32 s70, s62, 20480
    buffer_load_dwordx4 v7, s[36:39], s62 offen lds
    s_add_u32 m0, s66, 2048
    s_add_u32 s70, s62, 20480
    buffer_load_dwordx4 v6, s[36:39], s70 offen lds
    s_add_u32 m0, s66, 3072
    s_add_u32 s70, s62, 20480
    buffer_load_dwordx4 v7, s[36:39], s70 offen lds
    s_xor_b32 s66, s66, 16384
    s_add_u32 s62, s62, 128
    s_cmp_eq_u32 s62, 1280
    s_cselect_b32 s62, 0, s62
    s_add_u32 m0, s64, 0
    s_nop 0
    buffer_load_dwordx4 v8, s[40:43], s60 offen offset:0 lds
    s_add_u32 m0, s64, 3968
    s_nop 0
    buffer_load_dwordx4 v8, s[40:43], s60 offen offset:128 lds
    s_add_u32 m0, s64, 7936
    s_nop 0
    buffer_load_dwordx4 v8, s[40:43], s60 offen offset:256 lds
    s_add_u32 m0, s64, 12288
    s_nop 0
    buffer_load_dwordx4 v9, s[52:55], s60 offen offset:0 lds
    s_add_u32 m0, s64, 16256
    s_nop 0
    buffer_load_dwordx4 v9, s[52:55], s60 offen offset:128 lds
    s_add_u32 m0, s64, 20224
    s_nop 0
    buffer_load_dwordx4 v9, s[52:55], s60 offen offset:256 lds
    s_add_u32 s64, s64, 49152
    s_cmp_ge_u32 s64, s74
    s_cselect_b32 s70, 122880, 0
    s_sub_u32 s64, s64, s70
    s_add_u32 s60, s60, 221184
    s_cmp_ge_u32 s60, 2211840
    s_cselect_b32 s70, 2211840, 0
    s_sub_u32 s60, s60, s70
    v_xor_b32 v11, 16384, v11
    v_xor_b32 v12, 16384, v12
    v_xor_b32 v13, 16384, v13
    v_xor_b32 v14, 16384, v14
    v_add_u32 v20, s65, v15
    v_add_u32 v21, s65, v16
    v_add_u32 v22, s65, v17
    ds_read_b64_tr_b16 v[72:73], v20 offset:0
    ds_read_b64_tr_b16 v[74:75], v20 offset:512
    ds_read_b64_tr_b16 v[80:81], v21 offset:0
    ds_read_b64_tr_b16 v[82:83], v21 offset:512
    ds_read_b64_tr_b16 v[88:89], v22 offset:0
    ds_read_b64_tr_b16 v[90:91], v22 offset:512
    ds_read_b64_tr_b16 v[76:77], v20 offset:12288
    ds_read_b64_tr_b16 v[78:79], v20 offset:12800
    ds_read_b64_tr_b16 v[84:85], v21 offset:12288
    ds_read_b64_tr_b16 v[86:87], v21 offset:12800
    ds_read_b128 v[56:59], v11 offset:0
    ds_read_b128 v[64:67], v11 offset:4096
    ds_read_b128 v[60:63], v12 offset:0
    ds_read_b128 v[68:71], v12 offset:4096
    ds_read_b64_tr_b16 v[92:93], v22 offset:12288
    ds_read_b64_tr_b16 v[94:95], v22 offset:12800
    s_add_u32 s65, s65, 24576
    s_cmp_eq_u32 s65, 155648
    s_cselect_b32 s65, 32768, s65
    s_mov_b32 s59, 1
    s_waitcnt lgkmcnt(0)
.p2align 6
L_GB_loop:
    v_mfma_f32_16x16x32_bf16 v[152:155], v[72:75], v[56:59], v[152:155]
    v_add_u32 v20, s65, v15
    v_add_u32 v21, s65, v16
    v_add_u32 v22, s65, v17
    v_mfma_f32_16x16x32_bf16 v[160:163], v[72:75], v[64:67], v[160:163]
    ds_read_b64_tr_b16 v[120:121], v20 offset:0
    v_mfma_f32_16x16x32_bf16 v[156:159], v[72:75], v[60:63], v[156:159]
    ds_read_b64_tr_b16 v[122:123], v20 offset:512
    v_mfma_f32_16x16x32_bf16 v[164:167], v[72:75], v[68:71], v[164:167]
    ds_read_b64_tr_b16 v[128:129], v21 offset:0
    v_mfma_f32_16x16x32_bf16 v[184:187], v[80:83], v[56:59], v[184:187]
    ds_read_b64_tr_b16 v[130:131], v21 offset:512
    v_mfma_f32_16x16x32_bf16 v[192:195], v[80:83], v[64:67], v[192:195]
    ds_read_b64_tr_b16 v[136:137], v22 offset:0
    v_mfma_f32_16x16x32_bf16 v[188:191], v[80:83], v[60:63], v[188:191]
    ds_read_b64_tr_b16 v[138:139], v22 offset:512
    v_mfma_f32_16x16x32_bf16 v[196:199], v[80:83], v[68:71], v[196:199]
    ds_read_b64_tr_b16 v[124:125], v20 offset:12288
    v_mfma_f32_16x16x32_bf16 v[216:219], v[88:91], v[56:59], v[216:219]
    ds_read_b64_tr_b16 v[126:127], v20 offset:12800
    v_mfma_f32_16x16x32_bf16 v[224:227], v[88:91], v[64:67], v[224:227]
    ds_read_b64_tr_b16 v[132:133], v21 offset:12288
    v_mfma_f32_16x16x32_bf16 v[220:223], v[88:91], v[60:63], v[220:223]
    ds_read_b64_tr_b16 v[134:135], v21 offset:12800
    v_mfma_f32_16x16x32_bf16 v[228:231], v[88:91], v[68:71], v[228:231]
    ds_read_b128 v[104:107], v13 offset:0
    v_mfma_f32_16x16x32_bf16 v[168:171], v[76:79], v[56:59], v[168:171]
    ds_read_b128 v[112:115], v13 offset:4096
    v_mfma_f32_16x16x32_bf16 v[176:179], v[76:79], v[64:67], v[176:179]
    ds_read_b128 v[108:111], v14 offset:0
    v_mfma_f32_16x16x32_bf16 v[172:175], v[76:79], v[60:63], v[172:175]
    ds_read_b128 v[116:119], v14 offset:4096
    v_mfma_f32_16x16x32_bf16 v[180:183], v[76:79], v[68:71], v[180:183]
    ds_read_b64_tr_b16 v[140:141], v22 offset:12288
    v_mfma_f32_16x16x32_bf16 v[200:203], v[84:87], v[56:59], v[200:203]
    ds_read_b64_tr_b16 v[142:143], v22 offset:12800
    v_mfma_f32_16x16x32_bf16 v[208:211], v[84:87], v[64:67], v[208:211]
    v_mfma_f32_16x16x32_bf16 v[204:207], v[84:87], v[60:63], v[204:207]
    s_add_u32 s65, s65, 24576
    s_cmp_eq_u32 s65, 155648
    s_cselect_b32 s65, 32768, s65
    v_mfma_f32_16x16x32_bf16 v[212:215], v[84:87], v[68:71], v[212:215]
    v_mfma_f32_16x16x32_bf16 v[232:235], v[92:95], v[56:59], v[232:235]
    v_mfma_f32_16x16x32_bf16 v[240:243], v[92:95], v[64:67], v[240:243]
    v_mfma_f32_16x16x32_bf16 v[236:239], v[92:95], v[60:63], v[236:239]
    v_mfma_f32_16x16x32_bf16 v[244:247], v[92:95], v[68:71], v[244:247]
    s_waitcnt vmcnt(0) lgkmcnt(0)
    s_barrier
    s_cmp_ge_u32 s59, 8
    s_cbranch_scc1 L_GB_nod
    s_add_u32 m0, s66, 0
    s_add_u32 s70, s62, 20480
    buffer_load_dwordx4 v6, s[36:39], s62 offen lds
    s_add_u32 m0, s66, 1024
    s_add_u32 s70, s62, 20480
    buffer_load_dwordx4 v7, s[36:39], s62 offen lds
    s_add_u32 m0, s66, 2048
    s_add_u32 s70, s62, 20480
    buffer_load_dwordx4 v6, s[36:39], s70 offen lds
    s_add_u32 m0, s66, 3072
    s_add_u32 s70, s62, 20480
    buffer_load_dwordx4 v7, s[36:39], s70 offen lds
    s_xor_b32 s66, s66, 16384
    s_add_u32 s62, s62, 128
    s_cmp_eq_u32 s62, 1280
    s_cselect_b32 s62, 0, s62
    s_add_u32 m0, s64, 0
    s_nop 0
    buffer_load_dwordx4 v8, s[40:43], s60 offen offset:0 lds
    s_add_u32 m0, s64, 3968
    s_nop 0
    buffer_load_dwordx4 v8, s[40:43], s60 offen offset:128 lds
    s_add_u32 m0, s64, 7936
    s_nop 0
    buffer_load_dwordx4 v8, s[40:43], s60 offen offset:256 lds
    s_add_u32 m0, s64, 12288
    s_nop 0
    buffer_load_dwordx4 v9, s[52:55], s60 offen offset:0 lds
    s_add_u32 m0, s64, 16256
    s_nop 0
    buffer_load_dwordx4 v9, s[52:55], s60 offen offset:128 lds
    s_add_u32 m0, s64, 20224
    s_nop 0
    buffer_load_dwordx4 v9, s[52:55], s60 offen offset:256 lds
    v_mfma_f32_16x16x32_bf16 v[152:155], v[120:123], v[104:107], v[152:155]
    v_xor_b32 v11, 16384, v11
    v_xor_b32 v12, 16384, v12
    v_add_u32 v20, s65, v15
    v_add_u32 v21, s65, v16
    v_add_u32 v22, s65, v17
    s_add_u32 s64, s64, 49152
    s_cmp_ge_u32 s64, s74
    s_cselect_b32 s70, 122880, 0
    s_sub_u32 s64, s64, s70
    s_add_u32 s60, s60, 221184
    s_cmp_ge_u32 s60, 2211840
    s_cselect_b32 s70, 2211840, 0
    s_sub_u32 s60, s60, s70
    v_mfma_f32_16x16x32_bf16 v[160:163], v[120:123], v[112:115], v[160:163]
    ds_read_b64_tr_b16 v[72:73], v20 offset:0
    v_mfma_f32_16x16x32_bf16 v[156:159], v[120:123], v[108:111], v[156:159]
    ds_read_b64_tr_b16 v[74:75], v20 offset:512
    v_mfma_f32_16x16x32_bf16 v[164:167], v[120:123], v[116:119], v[164:167]
    ds_read_b64_tr_b16 v[80:81], v21 offset:0
    v_mfma_f32_16x16x32_bf16 v[184:187], v[128:131], v[104:107], v[184:187]
    ds_read_b64_tr_b16 v[82:83], v21 offset:512
    v_mfma_f32_16x16x32_bf16 v[192:195], v[128:131], v[112:115], v[192:195]
    ds_read_b64_tr_b16 v[88:89], v22 offset:0
    v_mfma_f32_16x16x32_bf16 v[188:191], v[128:131], v[108:111], v[188:191]
    ds_read_b64_tr_b16 v[90:91], v22 offset:512
    v_mfma_f32_16x16x32_bf16 v[196:199], v[128:131], v[116:119], v[196:199]
    ds_read_b64_tr_b16 v[76:77], v20 offset:12288
    v_mfma_f32_16x16x32_bf16 v[216:219], v[136:139], v[104:107], v[216:219]
    ds_read_b64_tr_b16 v[78:79], v20 offset:12800
    v_mfma_f32_16x16x32_bf16 v[224:227], v[136:139], v[112:115], v[224:227]
    ds_read_b64_tr_b16 v[84:85], v21 offset:12288
    v_mfma_f32_16x16x32_bf16 v[220:223], v[136:139], v[108:111], v[220:223]
    ds_read_b64_tr_b16 v[86:87], v21 offset:12800
    v_mfma_f32_16x16x32_bf16 v[228:231], v[136:139], v[116:119], v[228:231]
    ds_read_b128 v[56:59], v11 offset:0
    v_mfma_f32_16x16x32_bf16 v[168:171], v[124:127], v[104:107], v[168:171]
    ds_read_b128 v[64:67], v11 offset:4096
    v_mfma_f32_16x16x32_bf16 v[176:179], v[124:127], v[112:115], v[176:179]
    ds_read_b128 v[60:63], v12 offset:0
    v_mfma_f32_16x16x32_bf16 v[172:175], v[124:127], v[108:111], v[172:175]
    ds_read_b128 v[68:71], v12 offset:4096
    v_mfma_f32_16x16x32_bf16 v[180:183], v[124:127], v[116:119], v[180:183]
    ds_read_b64_tr_b16 v[92:93], v22 offset:12288
    v_mfma_f32_16x16x32_bf16 v[200:203], v[132:135], v[104:107], v[200:203]
    ds_read_b64_tr_b16 v[94:95], v22 offset:12800
    v_mfma_f32_16x16x32_bf16 v[208:211], v[132:135], v[112:115], v[208:211]
    s_add_u32 s65, s65, 24576
    s_cmp_eq_u32 s65, 155648
    s_cselect_b32 s65, 32768, s65
    v_xor_b32 v13, 16384, v13
    v_mfma_f32_16x16x32_bf16 v[204:207], v[132:135], v[108:111], v[204:207]
    v_xor_b32 v14, 16384, v14
    v_mfma_f32_16x16x32_bf16 v[212:215], v[132:135], v[116:119], v[212:215]
    v_mfma_f32_16x16x32_bf16 v[232:235], v[140:143], v[104:107], v[232:235]
    v_mfma_f32_16x16x32_bf16 v[240:243], v[140:143], v[112:115], v[240:243]
    v_mfma_f32_16x16x32_bf16 v[236:239], v[140:143], v[108:111], v[236:239]
    s_add_u32 s59, s59, 1
    s_cmp_lt_u32 s59, 10
    v_mfma_f32_16x16x32_bf16 v[244:247], v[140:143], v[116:119], v[244:247]
L_GB_end:
    s_waitcnt lgkmcnt(0)
    s_cbranch_scc1 L_GB_loop
    s_branch L_G_epi
L_GB_nod:
    s_cmp_eq_u32 s59, 9
    s_cbranch_scc1 L_GB_nod9
    s_lshr_b32 s4, s2, 3
    s_and_b32 s4, s4, 7
    s_mul_i32 s4, s4, 378880
    s_and_b32 s5, s56, 3
    s_mul_i32 s5, s5, 7168
    s_add_u32 s4, s4, s5
    s_add_u32 s4, s4, 10786816
    s_add_u32 s5, s5, 57344
    v_lshlrev_b32 v2, 4, v1
    s_add_u32 m0, s5, 0
    s_add_u32 s6, s4, 0
    buffer_load_dwordx4 v2, s[44:47], s6 offen offset:0 sc1 lds
    buffer_load_dwordx4 v2, s[44:47], s6 offen offset:1024 sc1 lds
    buffer_load_dwordx4 v2, s[44:47], s6 offen offset:2048 sc1 lds
    buffer_load_dwordx4 v2, s[44:47], s6 offen offset:3072 sc1 lds
    s_add_u32 m0, s5, 4096
    s_add_u32 s6, s4, 4096
    buffer_load_dwordx4 v2, s[44:47], s6 offen offset:0 sc1 lds
    buffer_load_dwordx4 v2, s[44:47], s6 offen offset:1024 sc1 lds
    buffer_load_dwordx4 v2, s[44:47], s6 offen offset:2048 sc1 lds
    s_branch L_GB_nod2
L_GB_nod9:
    s_lshr_b32 s4, s2, 3
    s_and_b32 s4, s4, 7
    s_mul_i32 s4, s4, 378880
    s_and_b32 s5, s56, 3
    s_mul_i32 s5, s5, 7168
    s_add_u32 s4, s4, s5
    s_add_u32 s4, s4, 10835968
    s_add_u32 s5, s5, 106496
    v_lshlrev_b32 v2, 4, v1
    s_add_u32 m0, s5, 0
    s_add_u32 s6, s4, 0
    buffer_load_dwordx4 v2, s[44:47], s6 offen offset:0 sc1 lds
    buffer_load_dwordx4 v2, s[44:47], s6 offen offset:1024 sc1 lds
    buffer_load_dwordx4 v2, s[44:47], s6 offen offset:2048 sc1 lds
    buffer_load_dwordx4 v2, s[44:47], s6 offen offset:3072 sc1 lds
    s_add_u32 m0, s5, 4096
    s_add_u32 s6, s4, 4096
    buffer_load_dwordx4 v2, s[44:47], s6 offen offset:0 sc1 lds
    buffer_load_dwordx4 v2, s[44:47], s6 offen offset:1024 sc1 lds
    buffer_load_dwordx4 v2, s[44:47], s6 offen offset:2048 sc1 lds
L_GB_nod2:
    v_mfma_f32_16x16x32_bf16 v[152:155], v[120:123], v[104:107], v[152:155]
    v_xor_b32 v11, 16384, v11
    v_xor_b32 v12, 16384, v12
    v_add_u32 v20, s65, v15
    v_add_u32 v21, s65, v16
    v_add_u32 v22, s65, v17
    v_mfma_f32_16x16x32_bf16 v[160:163], v[120:123], v[112:115], v[160:163]
    ds_read_b64_tr_b16 v[72:73], v20 offset:0
    v_mfma_f32_16x16x32_bf16 v[156:159], v[120:123], v[108:111], v[156:159]
    ds_read_b64_tr_b16 v[74:75], v20 offset:512
    v_mfma_f32_16x16x32_bf16 v[164:167], v[120:123], v[116:119], v[164:167]
    ds_read_b64_tr_b16 v[80:81], v21 offset:0
    v_mfma_f32_16x16x32_bf16 v[184:187], v[128:131], v[104:107], v[184:187]
    ds_read_b64_tr_b16 v[82:83], v21 offset:512
    v_mfma_f32_16x16x32_bf16 v[192:195], v[128:131], v[112:115], v[192:195]
    ds_read_b64_tr_b16 v[88:89], v22 offset:0
    v_mfma_f32_16x16x32_bf16 v[188:191], v[128:131], v[108:111], v[188:191]
    ds_read_b64_tr_b16 v[90:91], v22 offset:512
    v_mfma_f32_16x16x32_bf16 v[196:199], v[128:131], v[116:119], v[196:199]
    ds_read_b64_tr_b16 v[76:77], v20 offset:12288
    v_mfma_f32_16x16x32_bf16 v[216:219], v[136:139], v[104:107], v[216:219]
    ds_read_b64_tr_b16 v[78:79], v20 offset:12800
    v_mfma_f32_16x16x32_bf16 v[224:227], v[136:139], v[112:115], v[224:227]
    ds_read_b64_tr_b16 v[84:85], v21 offset:12288
    v_mfma_f32_16x16x32_bf16 v[220:223], v[136:139], v[108:111], v[220:223]
    ds_read_b64_tr_b16 v[86:87], v21 offset:12800
    v_mfma_f32_16x16x32_bf16 v[228:231], v[136:139], v[116:119], v[228:231]
    ds_read_b128 v[56:59], v11 offset:0
    v_mfma_f32_16x16x32_bf16 v[168:171], v[124:127], v[104:107], v[168:171]
    ds_read_b128 v[64:67], v11 offset:4096
    v_mfma_f32_16x16x32_bf16 v[176:179], v[124:127], v[112:115], v[176:179]
    ds_read_b128 v[60:63], v12 offset:0
    v_mfma_f32_16x16x32_bf16 v[172:175], v[124:127], v[108:111], v[172:175]
    ds_read_b128 v[68:71], v12 offset:4096
    v_mfma_f32_16x16x32_bf16 v[180:183], v[124:127], v[116:119], v[180:183]
    ds_read_b64_tr_b16 v[92:93], v22 offset:12288
    v_mfma_f32_16x16x32_bf16 v[200:203], v[132:135], v[104:107], v[200:203]
    ds_read_b64_tr_b16 v[94:95], v22 offset:12800
    v_mfma_f32_16x16x32_bf16 v[208:211], v[132:135], v[112:115], v[208:211]
    s_add_u32 s65, s65, 24576
    s_cmp_eq_u32 s65, 155648
    s_cselect_b32 s65, 32768, s65
    v_xor_b32 v13, 16384, v13
    v_mfma_f32_16x16x32_bf16 v[204:207], v[132:135], v[108:111], v[204:207]
    v_xor_b32 v14, 16384, v14
    v_mfma_f32_16x16x32_bf16 v[212:215], v[132:135], v[116:119], v[212:215]
    v_mfma_f32_16x16x32_bf16 v[232:235], v[140:143], v[104:107], v[232:235]
    v_mfma_f32_16x16x32_bf16 v[240:243], v[140:143], v[112:115], v[240:243]
    v_mfma_f32_16x16x32_bf16 v[236:239], v[140:143], v[108:111], v[236:239]
    s_add_u32 s59, s59, 1
    s_cmp_lt_u32 s59, 10
    v_mfma_f32_16x16x32_bf16 v[244:247], v[140:143], v[116:119], v[244:247]
    s_branch L_GB_end
L_G_epi:
    s_setprio 0
    v_lshlrev_b32 v5, 4, v1
    v_lshrrev_b32 v2, 4, v1
    v_lshlrev_b32 v2, 4, v2
    s_mul_i32 s70, s73, 384
    s_add_u32 s70, s70, 155648
    v_add_u32 v2, s70, v2
    v_and_b32 v3, 15, v1
    s_lshl_b32 s70, s72, 9
    s_add_u32 s70, s70, 157696
    v_lshl_add_u32 v3, v3, 3, s70
    buffer_load_dwordx4 v[8:11], v5, s[44:47], s19 offen offset:0 sc1
    ds_read_b64 v[56:57], v3 offset:0
    ds_read_b64 v[64:65], v3 offset:128
    ds_read_b64 v[72:73], v3 offset:256
    ds_read_b64 v[80:81], v3 offset:384
    ds_read_b128 v[88:91], v2 offset:0
    ds_read_b128 v[92:95], v2 offset:64
    ds_read_b128 v[96:99], v2 offset:128
    ds_read_b128 v[100:103], v2 offset:192
    ds_read_b128 v[48:51], v2 offset:256
    ds_read_b128 v[52:55], v2 offset:320
    s_waitcnt lgkmcnt(6)
    v_rsq_f32 v104, v57
    v_mov_b32 v58, v57
    v_rsq_f32 v105, v65
    v_mov_b32 v66, v65
    v_rsq_f32 v106, v73
    v_mov_b32 v74, v73
    v_rsq_f32 v107, v81
    v_mov_b32 v82, v81
    v_mul_f32 v60, 0xc0135761, v104
    v_mul_f32 v108, v104, v104
    v_mul_f32 v68, 0xc0135761, v105
    v_mul_f32 v109, v105, v105
    v_mul_f32 v76, 0xc0135761, v106
    v_mul_f32 v110, v106, v106
    v_mul_f32 v84, 0xc0135761, v107
    v_mul_f32 v111, v107, v107
    v_mul_f32 v108, v108, v104
    buffer_load_dwordx4 v[12:15], v5, s[44:47], s19 offen offset:1024 sc1
    v_mul_f32 v109, v109, v105
    v_mul_f32 v110, v110, v106
    v_mul_f32 v111, v111, v107
    v_mul_f32 v62, 0xbdd2d3e8, v108
    v_mul_f32 v70, 0xbdd2d3e8, v109
    v_mul_f32 v78, 0xbdd2d3e8, v110
    v_mul_f32 v86, 0xbdd2d3e8, v111
    v_bfe_u32 v3, v1, 4, 1
    v_lshlrev_b32 v3, 10, v3
    v_lshrrev_b32 v4, 5, v1
    v_lshl_add_u32 v3, v4, 8, v3
    v_and_b32 v4, 15, v1
    v_lshl_add_u32 v3, v4, 4, v3
    s_waitcnt lgkmcnt(0)
    s_mul_i32 s70, s58, 12
    s_mul_i32 s71, s73, 3
    s_add_u32 s70, s70, s71
    s_add_u32 s70, s70, 0
    s_lshl_b32 s71, s57, 1
    s_add_u32 s71, s71, s72
    s_mul_i32 s71, s71, 54
    s_lshr_b32 s75, s70, 1
    s_add_u32 s71, s71, s75
    s_lshl_b32 s71, s71, 12
    s_and_b32 s70, s70, 1
    s_lshl_b32 s70, s70, 9
    s_add_u32 s70, s70, s71
    v_pk_fma_f32 v[152:153], v[56:57], v[88:89], v[152:153] op_sel:[0,0,0] op_sel_hi:[0,1,1] neg_lo:[1,0,0] neg_hi:[1,0,0]
    v_pk_fma_f32 v[154:155], v[56:57], v[90:91], v[154:155] op_sel:[0,0,0] op_sel_hi:[0,1,1] neg_lo:[1,0,0] neg_hi:[1,0,0]
    buffer_load_dwordx4 v[16:19], v5, s[44:47], s19 offen offset:2048 sc1
    v_pk_fma_f32 v[156:157], v[64:65], v[88:89], v[156:157] op_sel:[0,0,0] op_sel_hi:[0,1,1] neg_lo:[1,0,0] neg_hi:[1,0,0]
    v_pk_fma_f32 v[158:159], v[64:65], v[90:91], v[158:159] op_sel:[0,0,0] op_sel_hi:[0,1,1] neg_lo:[1,0,0] neg_hi:[1,0,0]
    v_pk_fma_f32 v[160:161], v[72:73], v[88:89], v[160:161] op_sel:[0,0,0] op_sel_hi:[0,1,1] neg_lo:[1,0,0] neg_hi:[1,0,0]
    v_pk_fma_f32 v[162:163], v[72:73], v[90:91], v[162:163] op_sel:[0,0,0] op_sel_hi:[0,1,1] neg_lo:[1,0,0] neg_hi:[1,0,0]
    v_pk_fma_f32 v[164:165], v[80:81], v[88:89], v[164:165] op_sel:[0,0,0] op_sel_hi:[0,1,1] neg_lo:[1,0,0] neg_hi:[1,0,0]
    v_pk_fma_f32 v[166:167], v[80:81], v[90:91], v[166:167] op_sel:[0,0,0] op_sel_hi:[0,1,1] neg_lo:[1,0,0] neg_hi:[1,0,0]
    v_pk_mul_f32 v[104:105], v[152:153], v[152:153] op_sel:[0,0] op_sel_hi:[1,1]
    v_pk_mul_f32 v[106:107], v[154:155], v[154:155] op_sel:[0,0] op_sel_hi:[1,1]
    v_pk_mul_f32 v[108:109], v[156:157], v[156:157] op_sel:[0,0] op_sel_hi:[1,1]
    v_pk_mul_f32 v[110:111], v[158:159], v[158:159] op_sel:[0,0] op_sel_hi:[1,1]
    v_pk_mul_f32 v[112:113], v[160:161], v[160:161] op_sel:[0,0] op_sel_hi:[1,1]
    v_pk_mul_f32 v[114:115], v[162:163], v[162:163] op_sel:[0,0] op_sel_hi:[1,1]
    v_pk_mul_f32 v[116:117], v[164:165], v[164:165] op_sel:[0,0] op_sel_hi:[1,1]
    v_pk_mul_f32 v[118:119], v[166:167], v[166:167] op_sel:[0,0] op_sel_hi:[1,1]
    v_pk_fma_f32 v[104:105], v[104:105], v[62:63], v[60:61] op_sel:[0,0,0] op_sel_hi:[1,0,0]
    v_pk_fma_f32 v[106:107], v[106:107], v[62:63], v[60:61] op_sel:[0,0,0] op_sel_hi:[1,0,0]
    v_pk_fma_f32 v[108:109], v[108:109], v[70:71], v[68:69] op_sel:[0,0,0] op_sel_hi:[1,0,0]
    v_pk_fma_f32 v[110:111], v[110:111], v[70:71], v[68:69] op_sel:[0,0,0] op_sel_hi:[1,0,0]
    v_pk_fma_f32 v[112:113], v[112:113], v[78:79], v[76:77] op_sel:[0,0,0] op_sel_hi:[1,0,0]
    v_pk_fma_f32 v[114:115], v[114:115], v[78:79], v[76:77] op_sel:[0,0,0] op_sel_hi:[1,0,0]
    v_pk_fma_f32 v[116:117], v[116:117], v[86:87], v[84:85] op_sel:[0,0,0] op_sel_hi:[1,0,0]
    v_pk_fma_f32 v[118:119], v[118:119], v[86:87], v[84:85] op_sel:[0,0,0] op_sel_hi:[1,0,0]
    v_pk_mul_f32 v[104:105], v[104:105], v[152:153] op_sel:[0,0] op_sel_hi:[1,1]
    v_pk_mul_f32 v[106:107], v[106:107], v[154:155] op_sel:[0,0] op_sel_hi:[1,1]
    v_pk_mul_f32 v[108:109], v[108:109], v[156:157] op_sel:[0,0] op_sel_hi:[1,1]
    v_pk_mul_f32 v[110:111], v[110:111], v[158:159] op_sel:[0,0] op_sel_hi:[1,1]
    v_pk_mul_f32 v[112:113], v[112:113], v[160:161] op_sel:[0,0] op_sel_hi:[1,1]
    v_pk_mul_f32 v[114:115], v[114:115], v[162:163] op_sel:[0,0] op_sel_hi:[1,1]
    buffer_load_dwordx4 v[20:23], v5, s[44:47], s19 offen offset:3072 sc1
    v_pk_mul_f32 v[116:117], v[116:117], v[164:165] op_sel:[0,0] op_sel_hi:[1,1]
    v_pk_mul_f32 v[118:119], v[118:119], v[166:167] op_sel:[0,0] op_sel_hi:[1,1]
    v_exp_f32 v104, v104
    v_exp_f32 v105, v105
    v_pk_fma_f32 v[168:169], v[56:57], v[92:93], v[168:169] op_sel:[0,0,0] op_sel_hi:[0,1,1] neg_lo:[1,0,0] neg_hi:[1,0,0]
    v_exp_f32 v106, v106
    v_exp_f32 v107, v107
    v_pk_fma_f32 v[170:171], v[56:57], v[94:95], v[170:171] op_sel:[0,0,0] op_sel_hi:[0,1,1] neg_lo:[1,0,0] neg_hi:[1,0,0]
    v_exp_f32 v108, v108
    v_exp_f32 v109, v109
    v_pk_fma_f32 v[172:173], v[64:65], v[92:93], v[172:173] op_sel:[0,0,0] op_sel_hi:[0,1,1] neg_lo:[1,0,0] neg_hi:[1,0,0]
    v_exp_f32 v110, v110
    v_exp_f32 v111, v111
    v_pk_fma_f32 v[174:175], v[64:65], v[94:95], v[174:175] op_sel:[0,0,0] op_sel_hi:[0,1,1] neg_lo:[1,0,0] neg_hi:[1,0,0]
    v_exp_f32 v112, v112
    v_exp_f32 v113, v113
    v_pk_fma_f32 v[176:177], v[72:73], v[92:93], v[176:177] op_sel:[0,0,0] op_sel_hi:[0,1,1] neg_lo:[1,0,0] neg_hi:[1,0,0]
    v_exp_f32 v114, v114
    v_exp_f32 v115, v115
    v_pk_fma_f32 v[178:179], v[72:73], v[94:95], v[178:179] op_sel:[0,0,0] op_sel_hi:[0,1,1] neg_lo:[1,0,0] neg_hi:[1,0,0]
    v_exp_f32 v116, v116
    v_exp_f32 v117, v117
    v_pk_fma_f32 v[180:181], v[80:81], v[92:93], v[180:181] op_sel:[0,0,0] op_sel_hi:[0,1,1] neg_lo:[1,0,0] neg_hi:[1,0,0]
    v_exp_f32 v118, v118
    v_exp_f32 v119, v119
    v_pk_fma_f32 v[182:183], v[80:81], v[94:95], v[182:183] op_sel:[0,0,0] op_sel_hi:[0,1,1] neg_lo:[1,0,0] neg_hi:[1,0,0]
    v_pk_fma_f32 v[104:105], v[104:105], v[58:59], v[58:59] op_sel:[0,0,0] op_sel_hi:[1,0,0]
    v_pk_fma_f32 v[106:107], v[106:107], v[58:59], v[58:59] op_sel:[0,0,0] op_sel_hi:[1,0,0]
    v_pk_fma_f32 v[108:109], v[108:109], v[66:67], v[66:67] op_sel:[0,0,0] op_sel_hi:[1,0,0]
    s_add_u32 s3, s19, 4096
    buffer_load_dwordx4 v[24:27], v5, s[44:47], s3 offen sc1
    s_add_u32 s19, s19, 5120
    s_cmp_eq_u32 s19, s25
    s_cselect_b32 s19, s24, s19
    v_pk_fma_f32 v[110:111], v[110:111], v[66:67], v[66:67] op_sel:[0,0,0] op_sel_hi:[1,0,0]
    v_pk_fma_f32 v[112:113], v[112:113], v[74:75], v[74:75] op_sel:[0,0,0] op_sel_hi:[1,0,0]
    v_pk_fma_f32 v[114:115], v[114:115], v[74:75], v[74:75] op_sel:[0,0,0] op_sel_hi:[1,0,0]
    v_pk_fma_f32 v[116:117], v[116:117], v[82:83], v[82:83] op_sel:[0,0,0] op_sel_hi:[1,0,0]
    v_pk_fma_f32 v[118:119], v[118:119], v[82:83], v[82:83] op_sel:[0,0,0] op_sel_hi:[1,0,0]
    v_rcp_f32 v104, v104
    v_rcp_f32 v105, v105
    v_pk_mul_f32 v[152:153], v[152:153], v[168:169] op_sel:[0,0] op_sel_hi:[1,1]
    v_rcp_f32 v106, v106
    v_rcp_f32 v107, v107
    v_pk_mul_f32 v[154:155], v[154:155], v[170:171] op_sel:[0,0] op_sel_hi:[1,1]
    v_rcp_f32 v108, v108
    v_rcp_f32 v109, v109
    v_pk_mul_f32 v[156:157], v[156:157], v[172:173] op_sel:[0,0] op_sel_hi:[1,1]
    v_rcp_f32 v110, v110
    v_rcp_f32 v111, v111
    v_pk_mul_f32 v[158:159], v[158:159], v[174:175] op_sel:[0,0] op_sel_hi:[1,1]
    v_rcp_f32 v112, v112
    v_rcp_f32 v113, v113
    v_pk_mul_f32 v[160:161], v[160:161], v[176:177] op_sel:[0,0] op_sel_hi:[1,1]
    v_rcp_f32 v114, v114
    v_rcp_f32 v115, v115
    v_pk_mul_f32 v[162:163], v[162:163], v[178:179] op_sel:[0,0] op_sel_hi:[1,1]
    v_rcp_f32 v116, v116
    v_rcp_f32 v117, v117
    v_pk_mul_f32 v[164:165], v[164:165], v[180:181] op_sel:[0,0] op_sel_hi:[1,1]
    v_rcp_f32 v118, v118
    v_rcp_f32 v119, v119
    v_pk_mul_f32 v[166:167], v[166:167], v[182:183] op_sel:[0,0] op_sel_hi:[1,1]
    buffer_load_dwordx4 v[28:31], v5, s[44:47], s19 offen offset:0 sc1
    v_pk_mul_f32 v[152:153], v[152:153], v[104:105] op_sel:[0,0] op_sel_hi:[1,1]
    v_pk_mul_f32 v[154:155], v[154:155], v[106:107] op_sel:[0,0] op_sel_hi:[1,1]
    v_pk_mul_f32 v[156:157], v[156:157], v[108:109] op_sel:[0,0] op_sel_hi:[1,1]
    v_pk_mul_f32 v[158:159], v[158:159], v[110:111] op_sel:[0,0] op_sel_hi:[1,1]
    v_pk_mul_f32 v[160:161], v[160:161], v[112:113] op_sel:[0,0] op_sel_hi:[1,1]
    v_pk_mul_f32 v[162:163], v[162:163], v[114:115] op_sel:[0,0] op_sel_hi:[1,1]
    v_pk_mul_f32 v[164:165], v[164:165], v[116:117] op_sel:[0,0] op_sel_hi:[1,1]
    v_pk_mul_f32 v[166:167], v[166:167], v[118:119] op_sel:[0,0] op_sel_hi:[1,1]
    v_cvt_pk_bf16_f32 v168, v152, v153
    v_cvt_pk_bf16_f32 v169, v154, v155
    v_cvt_pk_bf16_f32 v170, v156, v157
    v_cvt_pk_bf16_f32 v171, v158, v159
    v_cvt_pk_bf16_f32 v176, v160, v161
    v_cvt_pk_bf16_f32 v177, v162, v163
    v_cvt_pk_bf16_f32 v178, v164, v165
    v_cvt_pk_bf16_f32 v179, v166, v167
    v_permlane16_swap_b32 v168, v170
    v_permlane16_swap_b32 v169, v171
    v_permlane16_swap_b32 v176, v178
    v_permlane16_swap_b32 v177, v179
    buffer_store_dwordx4 v[168:171], v3, s[44:47], s70 offen offset:0 sc1
    buffer_store_dwordx4 v[176:179], v3, s[44:47], s70 offen offset:2048 sc1
    s_mul_i32 s70, s58, 12
    s_mul_i32 s71, s73, 3
    s_add_u32 s70, s70, s71
    s_add_u32 s70, s70, 1
    s_lshl_b32 s71, s57, 1
    s_add_u32 s71, s71, s72
    buffer_load_dwordx4 v[32:35], v5, s[44:47], s19 offen offset:1024 sc1
    s_mul_i32 s71, s71, 54
    s_lshr_b32 s75, s70, 1
    s_add_u32 s71, s71, s75
    s_lshl_b32 s71, s71, 12
    s_and_b32 s70, s70, 1
    s_lshl_b32 s70, s70, 9
    s_add_u32 s70, s70, s71
    v_pk_fma_f32 v[184:185], v[56:57], v[96:97], v[184:185] op_sel:[0,0,0] op_sel_hi:[0,1,1] neg_lo:[1,0,0] neg_hi:[1,0,0]
    v_pk_fma_f32 v[186:187], v[56:57], v[98:99], v[186:187] op_sel:[0,0,0] op_sel_hi:[0,1,1] neg_lo:[1,0,0] neg_hi:[1,0,0]
    v_pk_fma_f32 v[188:189], v[64:65], v[96:97], v[188:189] op_sel:[0,0,0] op_sel_hi:[0,1,1] neg_lo:[1,0,0] neg_hi:[1,0,0]
    v_pk_fma_f32 v[190:191], v[64:65], v[98:99], v[190:191] op_sel:[0,0,0] op_sel_hi:[0,1,1] neg_lo:[1,0,0] neg_hi:[1,0,0]
    v_pk_fma_f32 v[192:193], v[72:73], v[96:97], v[192:193] op_sel:[0,0,0] op_sel_hi:[0,1,1] neg_lo:[1,0,0] neg_hi:[1,0,0]
    v_pk_fma_f32 v[194:195], v[72:73], v[98:99], v[194:195] op_sel:[0,0,0] op_sel_hi:[0,1,1] neg_lo:[1,0,0] neg_hi:[1,0,0]
    v_pk_fma_f32 v[196:197], v[80:81], v[96:97], v[196:197] op_sel:[0,0,0] op_sel_hi:[0,1,1] neg_lo:[1,0,0] neg_hi:[1,0,0]
    v_pk_fma_f32 v[198:199], v[80:81], v[98:99], v[198:199] op_sel:[0,0,0] op_sel_hi:[0,1,1] neg_lo:[1,0,0] neg_hi:[1,0,0]
    v_pk_mul_f32 v[104:105], v[184:185], v[184:185] op_sel:[0,0] op_sel_hi:[1,1]
    v_pk_mul_f32 v[106:107], v[186:187], v[186:187] op_sel:[0,0] op_sel_hi:[1,1]
    v_pk_mul_f32 v[108:109], v[188:189], v[188:189] op_sel:[0,0] op_sel_hi:[1,1]
    v_pk_mul_f32 v[110:111], v[190:191], v[190:191] op_sel:[0,0] op_sel_hi:[1,1]
    v_pk_mul_f32 v[112:113], v[192:193], v[192:193] op_sel:[0,0] op_sel_hi:[1,1]
    v_pk_mul_f32 v[114:115], v[194:195], v[194:195] op_sel:[0,0] op_sel_hi:[1,1]
    v_pk_mul_f32 v[116:117], v[196:197], v[196:197] op_sel:[0,0] op_sel_hi:[1,1]
    v_pk_mul_f32 v[118:119], v[198:199], v[198:199] op_sel:[0,0] op_sel_hi:[1,1]
    v_pk_fma_f32 v[104:105], v[104:105], v[62:63], v[60:61] op_sel:[0,0,0] op_sel_hi:[1,0,0]
    v_pk_fma_f32 v[106:107], v[106:107], v[62:63], v[60:61] op_sel:[0,0,0] op_sel_hi:[1,0,0]
    v_pk_fma_f32 v[108:109], v[108:109], v[70:71], v[68:69] op_sel:[0,0,0] op_sel_hi:[1,0,0]
    v_pk_fma_f32 v[110:111], v[110:111], v[70:71], v[68:69] op_sel:[0,0,0] op_sel_hi:[1,0,0]
    v_pk_fma_f32 v[112:113], v[112:113], v[78:79], v[76:77] op_sel:[0,0,0] op_sel_hi:[1,0,0]
    v_pk_fma_f32 v[114:115], v[114:115], v[78:79], v[76:77] op_sel:[0,0,0] op_sel_hi:[1,0,0]
    buffer_load_dwordx4 v[36:39], v5, s[44:47], s19 offen offset:2048 sc1
    v_pk_fma_f32 v[116:117], v[116:117], v[86:87], v[84:85] op_sel:[0,0,0] op_sel_hi:[1,0,0]
    v_pk_fma_f32 v[118:119], v[118:119], v[86:87], v[84:85] op_sel:[0,0,0] op_sel_hi:[1,0,0]
    v_pk_mul_f32 v[104:105], v[104:105], v[184:185] op_sel:[0,0] op_sel_hi:[1,1]
    v_pk_mul_f32 v[106:107], v[106:107], v[186:187] op_sel:[0,0] op_sel_hi:[1,1]
    v_pk_mul_f32 v[108:109], v[108:109], v[188:189] op_sel:[0,0] op_sel_hi:[1,1]
    v_pk_mul_f32 v[110:111], v[110:111], v[190:191] op_sel:[0,0] op_sel_hi:[1,1]
    v_pk_mul_f32 v[112:113], v[112:113], v[192:193] op_sel:[0,0] op_sel_hi:[1,1]
    v_pk_mul_f32 v[114:115], v[114:115], v[194:195] op_sel:[0,0] op_sel_hi:[1,1]
    v_pk_mul_f32 v[116:117], v[116:117], v[196:197] op_sel:[0,0] op_sel_hi:[1,1]
    v_pk_mul_f32 v[118:119], v[118:119], v[198:199] op_sel:[0,0] op_sel_hi:[1,1]
    v_exp_f32 v104, v104
    v_exp_f32 v105, v105
    v_pk_fma_f32 v[200:201], v[56:57], v[100:101], v[200:201] op_sel:[0,0,0] op_sel_hi:[0,1,1] neg_lo:[1,0,0] neg_hi:[1,0,0]
    v_exp_f32 v106, v106
    v_exp_f32 v107, v107
    v_pk_fma_f32 v[202:203], v[56:57], v[102:103], v[202:203] op_sel:[0,0,0] op_sel_hi:[0,1,1] neg_lo:[1,0,0] neg_hi:[1,0,0]
    v_exp_f32 v108, v108
    v_exp_f32 v109, v109
    v_pk_fma_f32 v[204:205], v[64:65], v[100:101], v[204:205] op_sel:[0,0,0] op_sel_hi:[0,1,1] neg_lo:[1,0,0] neg_hi:[1,0,0]
    v_exp_f32 v110, v110
    v_exp_f32 v111, v111
    v_pk_fma_f32 v[206:207], v[64:65], v[102:103], v[206:207] op_sel:[0,0,0] op_sel_hi:[0,1,1] neg_lo:[1,0,0] neg_hi:[1,0,0]
    v_exp_f32 v112, v112
    v_exp_f32 v113, v113
    v_pk_fma_f32 v[208:209], v[72:73], v[100:101], v[208:209] op_sel:[0,0,0] op_sel_hi:[0,1,1] neg_lo:[1,0,0] neg_hi:[1,0,0]
    v_exp_f32 v114, v114
    v_exp_f32 v115, v115
    v_pk_fma_f32 v[210:211], v[72:73], v[102:103], v[210:211] op_sel:[0,0,0] op_sel_hi:[0,1,1] neg_lo:[1,0,0] neg_hi:[1,0,0]
    buffer_load_dwordx4 v[40:43], v5, s[44:47], s19 offen offset:3072 sc1
    v_exp_f32 v116, v116
    v_exp_f32 v117, v117
    v_pk_fma_f32 v[212:213], v[80:81], v[100:101], v[212:213] op_sel:[0,0,0] op_sel_hi:[0,1,1] neg_lo:[1,0,0] neg_hi:[1,0,0]
    v_exp_f32 v118, v118
    v_exp_f32 v119, v119
    v_pk_fma_f32 v[214:215], v[80:81], v[102:103], v[214:215] op_sel:[0,0,0] op_sel_hi:[0,1,1] neg_lo:[1,0,0] neg_hi:[1,0,0]
    v_pk_fma_f32 v[104:105], v[104:105], v[58:59], v[58:59] op_sel:[0,0,0] op_sel_hi:[1,0,0]
    v_pk_fma_f32 v[106:107], v[106:107], v[58:59], v[58:59] op_sel:[0,0,0] op_sel_hi:[1,0,0]
    v_pk_fma_f32 v[108:109], v[108:109], v[66:67], v[66:67] op_sel:[0,0,0] op_sel_hi:[1,0,0]
    v_pk_fma_f32 v[110:111], v[110:111], v[66:67], v[66:67] op_sel:[0,0,0] op_sel_hi:[1,0,0]
    v_pk_fma_f32 v[112:113], v[112:113], v[74:75], v[74:75] op_sel:[0,0,0] op_sel_hi:[1,0,0]
    v_pk_fma_f32 v[114:115], v[114:115], v[74:75], v[74:75] op_sel:[0,0,0] op_sel_hi:[1,0,0]
    v_pk_fma_f32 v[116:117], v[116:117], v[82:83], v[82:83] op_sel:[0,0,0] op_sel_hi:[1,0,0]
    v_pk_fma_f32 v[118:119], v[118:119], v[82:83], v[82:83] op_sel:[0,0,0] op_sel_hi:[1,0,0]
    v_rcp_f32 v104, v104
    v_rcp_f32 v105, v105
    v_pk_mul_f32 v[184:185], v[184:185], v[200:201] op_sel:[0,0] op_sel_hi:[1,1]
    v_rcp_f32 v106, v106
    v_rcp_f32 v107, v107
    v_pk_mul_f32 v[186:187], v[186:187], v[202:203] op_sel:[0,0] op_sel_hi:[1,1]
    v_rcp_f32 v108, v108
    v_rcp_f32 v109, v109
    v_pk_mul_f32 v[188:189], v[188:189], v[204:205] op_sel:[0,0] op_sel_hi:[1,1]
    v_rcp_f32 v110, v110
    v_rcp_f32 v111, v111
    v_pk_mul_f32 v[190:191], v[190:191], v[206:207] op_sel:[0,0] op_sel_hi:[1,1]
    v_rcp_f32 v112, v112
    v_rcp_f32 v113, v113
    v_pk_mul_f32 v[192:193], v[192:193], v[208:209] op_sel:[0,0] op_sel_hi:[1,1]
    s_add_u32 s3, s19, 4096
    buffer_load_dwordx4 v[44:47], v5, s[44:47], s3 offen sc1
    s_add_u32 s19, s19, 5120
    s_cmp_eq_u32 s19, s25
    s_cselect_b32 s19, s24, s19
    v_rcp_f32 v114, v114
    v_rcp_f32 v115, v115
    v_pk_mul_f32 v[194:195], v[194:195], v[210:211] op_sel:[0,0] op_sel_hi:[1,1]
    v_rcp_f32 v116, v116
    v_rcp_f32 v117, v117
    v_pk_mul_f32 v[196:197], v[196:197], v[212:213] op_sel:[0,0] op_sel_hi:[1,1]
    v_rcp_f32 v118, v118
    v_rcp_f32 v119, v119
    v_pk_mul_f32 v[198:199], v[198:199], v[214:215] op_sel:[0,0] op_sel_hi:[1,1]
    v_pk_mul_f32 v[184:185], v[184:185], v[104:105] op_sel:[0,0] op_sel_hi:[1,1]
    v_pk_mul_f32 v[186:187], v[186:187], v[106:107] op_sel:[0,0] op_sel_hi:[1,1]
    v_pk_mul_f32 v[188:189], v[188:189], v[108:109] op_sel:[0,0] op_sel_hi:[1,1]
    v_pk_mul_f32 v[190:191], v[190:191], v[110:111] op_sel:[0,0] op_sel_hi:[1,1]
    v_pk_mul_f32 v[192:193], v[192:193], v[112:113] op_sel:[0,0] op_sel_hi:[1,1]
    v_pk_mul_f32 v[194:195], v[194:195], v[114:115] op_sel:[0,0] op_sel_hi:[1,1]
    v_pk_mul_f32 v[196:197], v[196:197], v[116:117] op_sel:[0,0] op_sel_hi:[1,1]
    v_pk_mul_f32 v[198:199], v[198:199], v[118:119] op_sel:[0,0] op_sel_hi:[1,1]
    v_cvt_pk_bf16_f32 v200, v184, v185
    v_cvt_pk_bf16_f32 v201, v186, v187
    v_cvt_pk_bf16_f32 v202, v188, v189
    v_cvt_pk_bf16_f32 v203, v190, v191
    v_cvt_pk_bf16_f32 v208, v192, v193
    v_cvt_pk_bf16_f32 v209, v194, v195
    v_cvt_pk_bf16_f32 v210, v196, v197
    v_cvt_pk_bf16_f32 v211, v198, v199
    v_permlane16_swap_b32 v200, v202
    v_permlane16_swap_b32 v201, v203
    v_permlane16_swap_b32 v208, v210
    v_permlane16_swap_b32 v209, v211
    buffer_store_dwordx4 v[200:203], v3, s[44:47], s70 offen offset:0 sc1
    buffer_store_dwordx4 v[208:211], v3, s[44:47], s70 offen offset:2048 sc1
    s_mul_i32 s70, s58, 12
    s_mul_i32 s71, s73, 3
    s_add_u32 s70, s70, s71
    s_add_u32 s70, s70, 2
    s_lshl_b32 s71, s57, 1
    s_add_u32 s71, s71, s72
    s_mul_i32 s71, s71, 54
    s_lshr_b32 s75, s70, 1
    s_add_u32 s71, s71, s75
    s_lshl_b32 s71, s71, 12
    s_and_b32 s70, s70, 1
    s_lshl_b32 s70, s70, 9
    s_add_u32 s70, s70, s71
    v_pk_fma_f32 v[216:217], v[56:57], v[48:49], v[216:217] op_sel:[0,0,0] op_sel_hi:[0,1,1] neg_lo:[1,0,0] neg_hi:[1,0,0]
    v_pk_fma_f32 v[218:219], v[56:57], v[50:51], v[218:219] op_sel:[0,0,0] op_sel_hi:[0,1,1] neg_lo:[1,0,0] neg_hi:[1,0,0]
    v_pk_fma_f32 v[220:221], v[64:65], v[48:49], v[220:221] op_sel:[0,0,0] op_sel_hi:[0,1,1] neg_lo:[1,0,0] neg_hi:[1,0,0]
    v_pk_fma_f32 v[222:223], v[64:65], v[50:51], v[222:223] op_sel:[0,0,0] op_sel_hi:[0,1,1] neg_lo:[1,0,0] neg_hi:[1,0,0]
    v_pk_fma_f32 v[224:225], v[72:73], v[48:49], v[224:225] op_sel:[0,0,0] op_sel_hi:[0,1,1] neg_lo:[1,0,0] neg_hi:[1,0,0]
    v_pk_fma_f32 v[226:227], v[72:73], v[50:51], v[226:227] op_sel:[0,0,0] op_sel_hi:[0,1,1] neg_lo:[1,0,0] neg_hi:[1,0,0]
    v_pk_fma_f32 v[228:229], v[80:81], v[48:49], v[228:229] op_sel:[0,0,0] op_sel_hi:[0,1,1] neg_lo:[1,0,0] neg_hi:[1,0,0]
    v_pk_fma_f32 v[230:231], v[80:81], v[50:51], v[230:231] op_sel:[0,0,0] op_sel_hi:[0,1,1] neg_lo:[1,0,0] neg_hi:[1,0,0]
    v_pk_mul_f32 v[104:105], v[216:217], v[216:217] op_sel:[0,0] op_sel_hi:[1,1]
    v_pk_mul_f32 v[106:107], v[218:219], v[218:219] op_sel:[0,0] op_sel_hi:[1,1]
    v_pk_mul_f32 v[108:109], v[220:221], v[220:221] op_sel:[0,0] op_sel_hi:[1,1]
    v_pk_mul_f32 v[110:111], v[222:223], v[222:223] op_sel:[0,0] op_sel_hi:[1,1]
    v_pk_mul_f32 v[112:113], v[224:225], v[224:225] op_sel:[0,0] op_sel_hi:[1,1]
    v_pk_mul_f32 v[114:115], v[226:227], v[226:227] op_sel:[0,0] op_sel_hi:[1,1]
    v_pk_mul_f32 v[116:117], v[228:229], v[228:229] op_sel:[0,0] op_sel_hi:[1,1]
    v_pk_mul_f32 v[118:119], v[230:231], v[230:231] op_sel:[0,0] op_sel_hi:[1,1]
    v_pk_fma_f32 v[104:105], v[104:105], v[62:63], v[60:61] op_sel:[0,0,0] op_sel_hi:[1,0,0]
    v_pk_fma_f32 v[106:107], v[106:107], v[62:63], v[60:61] op_sel:[0,0,0] op_sel_hi:[1,0,0]
    v_pk_fma_f32 v[108:109], v[108:109], v[70:71], v[68:69] op_sel:[0,0,0] op_sel_hi:[1,0,0]
    v_pk_fma_f32 v[110:111], v[110:111], v[70:71], v[68:69] op_sel:[0,0,0] op_sel_hi:[1,0,0]
    v_pk_fma_f32 v[112:113], v[112:113], v[78:79], v[76:77] op_sel:[0,0,0] op_sel_hi:[1,0,0]
    v_pk_fma_f32 v[114:115], v[114:115], v[78:79], v[76:77] op_sel:[0,0,0] op_sel_hi:[1,0,0]
    v_pk_fma_f32 v[116:117], v[116:117], v[86:87], v[84:85] op_sel:[0,0,0] op_sel_hi:[1,0,0]
    v_pk_fma_f32 v[118:119], v[118:119], v[86:87], v[84:85] op_sel:[0,0,0] op_sel_hi:[1,0,0]
    v_pk_mul_f32 v[104:105], v[104:105], v[216:217] op_sel:[0,0] op_sel_hi:[1,1]
    v_pk_mul_f32 v[106:107], v[106:107], v[218:219] op_sel:[0,0] op_sel_hi:[1,1]
    v_pk_mul_f32 v[108:109], v[108:109], v[220:221] op_sel:[0,0] op_sel_hi:[1,1]
    v_pk_mul_f32 v[110:111], v[110:111], v[222:223] op_sel:[0,0] op_sel_hi:[1,1]
    v_pk_mul_f32 v[112:113], v[112:113], v[224:225] op_sel:[0,0] op_sel_hi:[1,1]
    v_pk_mul_f32 v[114:115], v[114:115], v[226:227] op_sel:[0,0] op_sel_hi:[1,1]
    v_pk_mul_f32 v[116:117], v[116:117], v[228:229] op_sel:[0,0] op_sel_hi:[1,1]
    v_pk_mul_f32 v[118:119], v[118:119], v[230:231] op_sel:[0,0] op_sel_hi:[1,1]
    v_exp_f32 v104, v104
    v_exp_f32 v105, v105
    v_pk_fma_f32 v[232:233], v[56:57], v[52:53], v[232:233] op_sel:[0,0,0] op_sel_hi:[0,1,1] neg_lo:[1,0,0] neg_hi:[1,0,0]
    v_exp_f32 v106, v106
    v_exp_f32 v107, v107
    v_pk_fma_f32 v[234:235], v[56:57], v[54:55], v[234:235] op_sel:[0,0,0] op_sel_hi:[0,1,1] neg_lo:[1,0,0] neg_hi:[1,0,0]
    v_exp_f32 v108, v108
    v_exp_f32 v109, v109
    v_pk_fma_f32 v[236:237], v[64:65], v[52:53], v[236:237] op_sel:[0,0,0] op_sel_hi:[0,1,1] neg_lo:[1,0,0] neg_hi:[1,0,0]
    v_exp_f32 v110, v110
    v_exp_f32 v111, v111
    v_pk_fma_f32 v[238:239], v[64:65], v[54:55], v[238:239] op_sel:[0,0,0] op_sel_hi:[0,1,1] neg_lo:[1,0,0] neg_hi:[1,0,0]
    v_exp_f32 v112, v112
    v_exp_f32 v113, v113
    v_pk_fma_f32 v[240:241], v[72:73], v[52:53], v[240:241] op_sel:[0,0,0] op_sel_hi:[0,1,1] neg_lo:[1,0,0] neg_hi:[1,0,0]
    v_exp_f32 v114, v114
    v_exp_f32 v115, v115
    v_pk_fma_f32 v[242:243], v[72:73], v[54:55], v[242:243] op_sel:[0,0,0] op_sel_hi:[0,1,1] neg_lo:[1,0,0] neg_hi:[1,0,0]
    v_exp_f32 v116, v116
    v_exp_f32 v117, v117
    v_pk_fma_f32 v[244:245], v[80:81], v[52:53], v[244:245] op_sel:[0,0,0] op_sel_hi:[0,1,1] neg_lo:[1,0,0] neg_hi:[1,0,0]
    v_exp_f32 v118, v118
    v_exp_f32 v119, v119
    v_pk_fma_f32 v[246:247], v[80:81], v[54:55], v[246:247] op_sel:[0,0,0] op_sel_hi:[0,1,1] neg_lo:[1,0,0] neg_hi:[1,0,0]
    v_pk_fma_f32 v[104:105], v[104:105], v[58:59], v[58:59] op_sel:[0,0,0] op_sel_hi:[1,0,0]
    v_pk_fma_f32 v[106:107], v[106:107], v[58:59], v[58:59] op_sel:[0,0,0] op_sel_hi:[1,0,0]
    v_pk_fma_f32 v[108:109], v[108:109], v[66:67], v[66:67] op_sel:[0,0,0] op_sel_hi:[1,0,0]
    v_pk_fma_f32 v[110:111], v[110:111], v[66:67], v[66:67] op_sel:[0,0,0] op_sel_hi:[1,0,0]
    v_pk_fma_f32 v[112:113], v[112:113], v[74:75], v[74:75] op_sel:[0,0,0] op_sel_hi:[1,0,0]
    v_pk_fma_f32 v[114:115], v[114:115], v[74:75], v[74:75] op_sel:[0,0,0] op_sel_hi:[1,0,0]
    v_pk_fma_f32 v[116:117], v[116:117], v[82:83], v[82:83] op_sel:[0,0,0] op_sel_hi:[1,0,0]
    v_pk_fma_f32 v[118:119], v[118:119], v[82:83], v[82:83] op_sel:[0,0,0] op_sel_hi:[1,0,0]
    v_rcp_f32 v104, v104
    v_rcp_f32 v105, v105
    v_pk_mul_f32 v[216:217], v[216:217], v[232:233] op_sel:[0,0] op_sel_hi:[1,1]
    v_rcp_f32 v106, v106
    v_rcp_f32 v107, v107
    v_pk_mul_f32 v[218:219], v[218:219], v[234:235] op_sel:[0,0] op_sel_hi:[1,1]
    v_rcp_f32 v108, v108
    v_rcp_f32 v109, v109
    v_pk_mul_f32 v[220:221], v[220:221], v[236:237] op_sel:[0,0] op_sel_hi:[1,1]
    v_rcp_f32 v110, v110
    v_rcp_f32 v111, v111
    v_pk_mul_f32 v[222:223], v[222:223], v[238:239] op_sel:[0,0] op_sel_hi:[1,1]
    v_rcp_f32 v112, v112
    v_rcp_f32 v113, v113
    v_pk_mul_f32 v[224:225], v[224:225], v[240:241] op_sel:[0,0] op_sel_hi:[1,1]
    v_rcp_f32 v114, v114
    v_rcp_f32 v115, v115
    v_pk_mul_f32 v[226:227], v[226:227], v[242:243] op_sel:[0,0] op_sel_hi:[1,1]
    v_rcp_f32 v116, v116
    v_rcp_f32 v117, v117
    v_pk_mul_f32 v[228:229], v[228:229], v[244:245] op_sel:[0,0] op_sel_hi:[1,1]
    v_rcp_f32 v118, v118
    v_rcp_f32 v119, v119
    v_pk_mul_f32 v[230:231], v[230:231], v[246:247] op_sel:[0,0] op_sel_hi:[1,1]
    v_pk_mul_f32 v[216:217], v[216:217], v[104:105] op_sel:[0,0] op_sel_hi:[1,1]
    v_pk_mul_f32 v[218:219], v[218:219], v[106:107] op_sel:[0,0] op_sel_hi:[1,1]
    v_pk_mul_f32 v[220:221], v[220:221], v[108:109] op_sel:[0,0] op_sel_hi:[1,1]
    v_pk_mul_f32 v[222:223], v[222:223], v[110:111] op_sel:[0,0] op_sel_hi:[1,1]
    v_pk_mul_f32 v[224:225], v[224:225], v[112:113] op_sel:[0,0] op_sel_hi:[1,1]
    v_pk_mul_f32 v[226:227], v[226:227], v[114:115] op_sel:[0,0] op_sel_hi:[1,1]
    v_pk_mul_f32 v[228:229], v[228:229], v[116:117] op_sel:[0,0] op_sel_hi:[1,1]
    v_pk_mul_f32 v[230:231], v[230:231], v[118:119] op_sel:[0,0] op_sel_hi:[1,1]
    v_cvt_pk_bf16_f32 v232, v216, v217
    v_cvt_pk_bf16_f32 v233, v218, v219
    v_cvt_pk_bf16_f32 v234, v220, v221
    v_cvt_pk_bf16_f32 v235, v222, v223
    v_cvt_pk_bf16_f32 v240, v224, v225
    v_cvt_pk_bf16_f32 v241, v226, v227
    v_cvt_pk_bf16_f32 v242, v228, v229
    v_cvt_pk_bf16_f32 v243, v230, v231
    v_permlane16_swap_b32 v232, v234
    v_permlane16_swap_b32 v233, v235
    v_permlane16_swap_b32 v240, v242
    v_permlane16_swap_b32 v241, v243
    buffer_store_dwordx4 v[232:235], v3, s[44:47], s70 offen offset:0 sc1
    buffer_store_dwordx4 v[240:243], v3, s[44:47], s70 offen offset:2048 sc1
    s_mov_b32 s65, 3
    v_mov_b32 v6, 1073741824
    s_lshl_b32 s70, s57, 8
    s_add_u32 s70, s70, 14221312
    v_writelane_b32 v6, s70, 0
    s_lshl_b32 s70, 1, s58
    v_mov_b32 v7, s70
    s_branch L_p2
L_typeQ:
    s_lshr_b32 s72, s56, 1
    s_and_b32 s73, s56, 1
    s_mov_b32 s40, s18
    s_and_b32 s41, s19, 0xffff
    s_mov_b32 s42, 2457600
    s_mov_b32 s43, 0x20000
    s_and_b32 s71, s56, 3
    v_lshrrev_b32 v2, 3, v1
    s_lshl_b32 s75, s71, 3
    v_add_u32 v2, s75, v2
    v_mul_u32_u24 v2, 3840, v2
    v_and_b32 v3, 7, v1
    v_lshrrev_b32 v4, 2, v1
    v_and_b32 v4, 4, v4
    v_xor_b32 v3, v3, v4
    s_sub_u32 s75, s58, 13
    s_mul_i32 s75, s75, 640
    v_add_u32 v2, s75, v2
    v_lshl_add_u32 v8, v3, 4, v2
    s_lshr_b32 s70, s56, 2
    s_lshl_b32 s71, s71, 10
    s_add_u32 s74, s71, 155648
    s_mul_i32 s64, s70, 24576
    s_add_u32 s64, s64, s71
    s_add_u32 s64, s64, 32768
    s_mul_i32 s60, s76, 245760
    s_mul_i32 s70, s70, 122880
    s_add_u32 s60, s60, s70
    s_mov_b32 s61, 0
    s_cmp_lt_u32 s56, 4
    s_cbranch_scc1 L_Q_p1
    s_add_u32 m0, s66, 0
    s_add_u32 s70, s62, 20480
    buffer_load_dwordx4 v6, s[36:39], s62 offen lds
    s_add_u32 m0, s66, 1024
    s_add_u32 s70, s62, 20480
    buffer_load_dwordx4 v7, s[36:39], s62 offen lds
    s_add_u32 m0, s66, 2048
    s_add_u32 s70, s62, 20480
    buffer_load_dwordx4 v6, s[36:39], s70 offen lds
    s_add_u32 m0, s66, 3072
    s_add_u32 s70, s62, 20480
    buffer_load_dwordx4 v7, s[36:39], s70 offen lds
    s_xor_b32 s66, s66, 16384
    s_add_u32 s62, s62, 128
    s_cmp_eq_u32 s62, 1280
    s_cselect_b32 s62, 0, s62
    s_branch L_Q_p2
L_Q_p1:
    s_add_u32 m0, s64, 0
    s_nop 0
    buffer_load_dwordx4 v8, s[40:43], s60 offen offset:0 lds
    s_add_u32 m0, s64, 3968
    s_nop 0
    buffer_load_dwordx4 v8, s[40:43], s60 offen offset:128 lds
    s_add_u32 m0, s64, 7936
    s_nop 0
    buffer_load_dwordx4 v8, s[40:43], s60 offen offset:256 lds
    s_add_u32 m0, s64, 11904
    s_nop 0
    buffer_load_dwordx4 v8, s[40:43], s60 offen offset:384 lds
    s_add_u32 m0, s64, 15872
    s_nop 0
    buffer_load_dwordx4 v8, s[40:43], s60 offen offset:512 lds
    s_add_u32 s64, s64, 49152
    s_cmp_ge_u32 s64, s74
    s_cselect_b32 s70, 122880, 0
    s_sub_u32 s64, s64, s70
    s_add_u32 s60, s60, 245760
    s_cmp_ge_u32 s60, 2457600
    s_cselect_b32 s70, 2457600, 0
    s_sub_u32 s60, s60, s70
L_Q_p2:
    v_and_b32 v2, 31, v1
    v_lshrrev_b32 v3, 5, v1
    v_bfe_u32 v4, v1, 1, 3
    v_xor_b32 v3, v3, v4
    s_lshl_b32 s70, s72, 12
    v_lshl_add_u32 v2, v2, 7, s70
    v_xor_b32 v4, 0, v3
    v_lshl_add_u32 v11, v4, 4, v2
    v_xor_b32 v4, 2, v3
    v_lshl_add_u32 v12, v4, 4, v2
    v_xor_b32 v4, 4, v3
    v_lshl_add_u32 v13, v4, 4, v2
    v_xor_b32 v4, 6, v3
    v_lshl_add_u32 v14, v4, 4, v2
    v_lshrrev_b32 v2, 5, v1
    v_lshlrev_b32 v2, 10, v2
    v_bfe_u32 v3, v1, 2, 2
    v_lshl_add_u32 v2, v3, 7, v2
    v_and_b32 v4, 3, v1
    v_lshlrev_b32 v5, 1, v4
    v_lshrrev_b32 v4, 1, v4
    v_and_b32 v5, 2, v5
    v_or_b32 v4, v4, v5
    v_lshl_add_u32 v2, v4, 3, v2
    v_and_b32 v3, 2, v3
    v_bfe_u32 v4, v1, 4, 1
    v_xor_b32 v3, v3, v4
    s_mul_i32 s70, s73, 5
    s_add_u32 s70, s70, 0
    s_lshr_b32 s71, s70, 1
    s_lshl_b32 s71, s71, 12
    s_and_b32 s70, s70, 1
    s_lshl_b32 s70, s70, 1
    v_xor_b32 v4, s70, v3
    v_lshl_add_u32 v4, v4, 5, v2
    v_add_u32 v15, s71, v4
    s_mul_i32 s70, s73, 5
    s_add_u32 s70, s70, 1
    s_lshr_b32 s71, s70, 1
    s_lshl_b32 s71, s71, 12
    s_and_b32 s70, s70, 1
    s_lshl_b32 s70, s70, 1
    v_xor_b32 v4, s70, v3
    v_lshl_add_u32 v4, v4, 5, v2
    v_add_u32 v16, s71, v4
    s_mul_i32 s70, s73, 5
    s_add_u32 s70, s70, 2
    s_lshr_b32 s71, s70, 1
    s_lshl_b32 s71, s71, 12
    s_and_b32 s70, s70, 1
    s_lshl_b32 s70, s70, 1
    v_xor_b32 v4, s70, v3
    v_lshl_add_u32 v4, v4, 5, v2
    v_add_u32 v17, s71, v4
    s_mul_i32 s70, s73, 5
    s_add_u32 s70, s70, 3
    s_lshr_b32 s71, s70, 1
    s_lshl_b32 s71, s71, 12
    s_and_b32 s70, s70, 1
    s_lshl_b32 s70, s70, 1
    v_xor_b32 v4, s70, v3
    v_lshl_add_u32 v4, v4, 5, v2
    v_add_u32 v18, s71, v4
    s_mul_i32 s70, s73, 5
    s_add_u32 s70, s70, 4
    s_lshr_b32 s71, s70, 1
    s_lshl_b32 s71, s71, 12
    s_and_b32 s70, s70, 1
    s_lshl_b32 s70, s70, 1
    v_xor_b32 v4, s70, v3
    v_lshl_add_u32 v4, v4, 5, v2
    v_add_u32 v19, s71, v4
    s_mov_b32 s65, 32768
    v_and_b32 v25, 15, v1
    v_lshlrev_b32 v25, 8, v25
    v_add_u32 v25, 14221440, v25
    v_and_b32 v2, 15, v1
    v_bfe_u32 v3, v1, 4, 1
    v_cmp_eq_u32 vcc, v2, v3
    v_mov_b32 v4, 0x3f803f80
    s_nop 0
    v_cndmask_b32 v52, 0, v4, vcc
    v_mov_b32 v53, v52
    v_mov_b32 v54, v52
    v_mov_b32 v55, v52
    v_mov_b32 v32, 0
    v_mov_b32 v33, 0
    v_mov_b32 v34, 0
    v_mov_b32 v35, 0
    v_mov_b32 v36, 0
    v_mov_b32 v37, 0
    v_mov_b32 v38, 0
    v_mov_b32 v39, 0
    v_mov_b32 v40, 0
    v_mov_b32 v41, 0
    v_mov_b32 v42, 0
    v_mov_b32 v43, 0
    v_mov_b32 v44, 0
    v_mov_b32 v45, 0
    v_mov_b32 v46, 0
    v_mov_b32 v47, 0
    v_mov_b32 v48, 0
    v_mov_b32 v49, 0
    v_mov_b32 v50, 0
    v_mov_b32 v51, 0
    v_mov_b32 v152, 0
    v_mov_b32 v153, 0
    v_mov_b32 v154, 0
    v_mov_b32 v155, 0
    v_mov_b32 v156, 0
    v_mov_b32 v157, 0
    v_mov_b32 v158, 0
    v_mov_b32 v159, 0
    v_mov_b32 v160, 0
    v_mov_b32 v161, 0
    v_mov_b32 v162, 0
    v_mov_b32 v163, 0
    v_mov_b32 v164, 0
    v_mov_b32 v165, 0
    v_mov_b32 v166, 0
    v_mov_b32 v167, 0
    v_mov_b32 v168, 0
    v_mov_b32 v169, 0
    v_mov_b32 v170, 0
    v_mov_b32 v171, 0
    v_mov_b32 v172, 0
    v_mov_b32 v173, 0
    v_mov_b32 v174, 0
    v_mov_b32 v175, 0
    v_mov_b32 v176, 0
    v_mov_b32 v177, 0
    v_mov_b32 v178, 0
    v_mov_b32 v179, 0
    v_mov_b32 v180, 0
    v_mov_b32 v181, 0
    v_mov_b32 v182, 0
    v_mov_b32 v183, 0
    v_mov_b32 v184, 0
    v_mov_b32 v185, 0
    v_mov_b32 v186, 0
    v_mov_b32 v187, 0
    v_mov_b32 v188, 0
    v_mov_b32 v189, 0
    v_mov_b32 v190, 0
    v_mov_b32 v191, 0
    v_mov_b32 v192, 0
    v_mov_b32 v193, 0
    v_mov_b32 v194, 0
    v_mov_b32 v195, 0
    v_mov_b32 v196, 0
    v_mov_b32 v197, 0
    v_mov_b32 v198, 0
    v_mov_b32 v199, 0
    v_mov_b32 v200, 0
    v_mov_b32 v201, 0
    v_mov_b32 v202, 0
    v_mov_b32 v203, 0
    v_mov_b32 v204, 0
    v_mov_b32 v205, 0
    v_mov_b32 v206, 0
    v_mov_b32 v207, 0
    v_mov_b32 v208, 0
    v_mov_b32 v209, 0
    v_mov_b32 v210, 0
    v_mov_b32 v211, 0
    v_mov_b32 v212, 0
    v_mov_b32 v213, 0
    v_mov_b32 v214, 0
    v_mov_b32 v215, 0
    v_mov_b32 v216, 0
    v_mov_b32 v217, 0
    v_mov_b32 v218, 0
    v_mov_b32 v219, 0
    v_mov_b32 v220, 0
    v_mov_b32 v221, 0
    v_mov_b32 v222, 0
    v_mov_b32 v223, 0
    v_mov_b32 v224, 0
    v_mov_b32 v225, 0
    v_mov_b32 v226, 0
    v_mov_b32 v227, 0
    v_mov_b32 v228, 0
    v_mov_b32 v229, 0
    v_mov_b32 v230, 0
    v_mov_b32 v231, 0
    s_mov_b32 s80, 2
    s_bitcmp1_b32 0x88ff, s57
    s_cselect_b32 s68, 0, 99
    s_cmp_eq_u32 s72, 0
    s_cselect_b32 s68, s68, 99
    s_mov_b32 s70, 0xe
    s_cmp_eq_u32 s56, 0
    s_cselect_b32 s69, s70, 0
    s_cmp_eq_u32 s56, 3
    s_cselect_b32 s70, 0xc0, 0
    s_or_b32 s69, s69, s70
    s_or_b32 s69, s69, 0x300
    s_mov_b32 s59, 0
    s_mov_b32 s78, 0
    s_and_b32 s3, s2, 7
    s_lshr_b32 s4, s2, 3
    s_and_b32 s17, s4, 7
    s_lshr_b32 s4, s4, 3
    s_lshl_b32 s3, s3, 2
    s_add_u32 s16, s3, s4
    s_sub_u32 s3, s56, 4
    s_mul_i32 s4, s3, 14
    s_cmp_eq_u32 s3, 3
    s_cselect_b32 s5, 1, 0
    s_sub_u32 s4, s4, s5
    s_cmp_ge_u32 s3, 2
    s_cselect_b32 s5, 13, 14
    s_cselect_b32 s26, 1073741824, 0
    s_and_b32 s6, s16, 3
    s_lshl_b32 s6, s6, 1
    s_add_u32 s6, s6, s17
    s_mul_i32 s6, s6, 7
    s_lshr_b32 s6, s6, 2
    s_sub_u32 s7, s6, s5
    s_cmp_ge_u32 s6, s5
    s_cselect_b32 s6, s7, s6
    s_mul_i32 s22, s16, 54
    s_add_u32 s22, s22, s4
    s_lshl_b32 s22, s22, 12
    s_lshl_b32 s7, s5, 12
    s_add_u32 s23, s22, s7
    s_lshl_b32 s7, s6, 12
    s_add_u32 s18, s22, s7
    s_mul_i32 s24, s17, 74
    s_add_u32 s24, s24, s4
    s_mul_i32 s24, s24, 5120
    s_add_u32 s24, s24, 10485760
    s_mul_i32 s7, s5, 5120
    s_add_u32 s25, s24, s7
    s_mul_i32 s7, s6, 5120
    s_add_u32 s19, s24, s7
    s_cmp_lt_u32 s56, 4
    s_cselect_b32 s19, 1073741824, s19
    s_cmp_ge_u32 s56, 4
    s_cbranch_scc1 L_Q_roleB
    s_waitcnt vmcnt(5)
    v_lshlrev_b32 v64, 16, v56
    v_and_b32 v65, 0xffff0000, v56
    v_lshlrev_b32 v66, 16, v57
    v_and_b32 v67, 0xffff0000, v57
    v_lshlrev_b32 v68, 16, v58
    v_and_b32 v69, 0xffff0000, v58
    v_lshlrev_b32 v70, 16, v59
    v_and_b32 v71, 0xffff0000, v59
    v_lshlrev_b32 v72, 16, v60
    v_and_b32 v73, 0xffff0000, v60
    v_add_f32 v76, v64, v65
    v_add_f32 v76, v76, v66
    v_add_f32 v76, v76, v67
    v_add_f32 v76, v76, v68
    v_add_f32 v76, v76, v69
    v_add_f32 v76, v76, v70
    v_add_f32 v76, v76, v71
    v_add_f32 v76, v76, v72
    v_add_f32 v76, v76, v73
    s_nop 1
    v_add_f32_dpp v76, v76, v76 quad_perm:[1,0,3,2] row_mask:0xf bank_mask:0xf
    s_nop 1
    v_add_f32_dpp v76, v76, v76 quad_perm:[2,3,0,1] row_mask:0xf bank_mask:0xf
    s_nop 1
    v_add_f32_dpp v76, v76, v76 row_half_mirror row_mask:0xf bank_mask:0xf
    s_nop 1
    v_add_f32_dpp v76, v76, v76 row_mirror row_mask:0xf bank_mask:0xf
    s_nop 0
    v_readlane_b32 s4, v76, 0
    v_readlane_b32 s5, v76, 16
    v_readlane_b32 s6, v76, 32
    v_readlane_b32 s7, v76, 48
    v_mov_b32 v76, s4
    v_mov_b32 v77, s6
    v_add_f32 v76, s5, v76
    v_add_f32 v77, s7, v77
    v_add_f32 v76, v76, v77
    v_mul_f32 v76, 0x3acccccd, v76
    v_sub_f32 v64, v64, v76
    v_sub_f32 v65, v65, v76
    v_sub_f32 v66, v66, v76
    v_sub_f32 v67, v67, v76
    v_sub_f32 v68, v68, v76
    v_sub_f32 v69, v69, v76
    v_sub_f32 v70, v70, v76
    v_sub_f32 v71, v71, v76
    v_sub_f32 v72, v72, v76
    v_sub_f32 v73, v73, v76
    v_mul_f32 v77, v64, v64
    v_fmac_f32 v77, v65, v65
    v_fmac_f32 v77, v66, v66
    v_fmac_f32 v77, v67, v67
    v_fmac_f32 v77, v68, v68
    v_fmac_f32 v77, v69, v69
    v_fmac_f32 v77, v70, v70
    v_fmac_f32 v77, v71, v71
    v_fmac_f32 v77, v72, v72
    v_fmac_f32 v77, v73, v73
    s_nop 1
    v_add_f32_dpp v77, v77, v77 quad_perm:[1,0,3,2] row_mask:0xf bank_mask:0xf
    s_nop 1
    v_add_f32_dpp v77, v77, v77 quad_perm:[2,3,0,1] row_mask:0xf bank_mask:0xf
    s_nop 1
    v_add_f32_dpp v77, v77, v77 row_half_mirror row_mask:0xf bank_mask:0xf
    s_nop 1
    v_add_f32_dpp v77, v77, v77 row_mirror row_mask:0xf bank_mask:0xf
    s_nop 0
    v_readlane_b32 s4, v77, 0
    v_readlane_b32 s5, v77, 16
    v_readlane_b32 s6, v77, 32
    v_readlane_b32 s7, v77, 48
    v_mov_b32 v77, s4
    v_mov_b32 v78, s6
    v_add_f32 v77, s5, v77
    v_add_f32 v78, s7, v78
    v_add_f32 v77, v77, v78
    v_mov_b32 v78, 0x3727c5ac
    v_fmac_f32 v78, 0x3acccccd, v77
    v_mov_b32 v77, v78
    v_cmp_eq_u32 vcc, 0, v1
    v_mov_b32 v4, 1073741824
    s_nop 0
    v_cndmask_b32 v2, v4, v1, vcc
    s_lshl_b32 s70, s77, 3
    s_add_u32 s70, s70, 13631488
    buffer_store_dwordx2 v[76:77], v2, s[44:47], s70 offen sc1
    s_waitcnt vmcnt(1)
    s_barrier
    v_add_u32 v20, s65, v15
    v_add_u32 v21, s65, v16
    v_add_u32 v22, s65, v17
    v_add_u32 v23, s65, v18
    v_add_u32 v24, s65, v19
    ds_read_b64_tr_b16 v[64:65], v20 offset:0
    ds_read_b64_tr_b16 v[66:67], v20 offset:512
    ds_read_b64_tr_b16 v[72:73], v21 offset:0
    ds_read_b64_tr_b16 v[74:75], v21 offset:512
    ds_read_b64_tr_b16 v[80:81], v22 offset:0
    ds_read_b64_tr_b16 v[82:83], v22 offset:512
    ds_read_b64_tr_b16 v[88:89], v23 offset:0
    ds_read_b64_tr_b16 v[90:91], v23 offset:512
    ds_read_b64_tr_b16 v[96:97], v24 offset:0
    ds_read_b64_tr_b16 v[98:99], v24 offset:512
    ds_read_b128 v[56:59], v11 offset:0
    ds_read_b64_tr_b16 v[68:69], v20 offset:2048
    ds_read_b64_tr_b16 v[70:71], v20 offset:2560
    ds_read_b64_tr_b16 v[76:77], v21 offset:2048
    ds_read_b64_tr_b16 v[78:79], v21 offset:2560
    ds_read_b64_tr_b16 v[84:85], v22 offset:2048
    ds_read_b64_tr_b16 v[86:87], v22 offset:2560
    ds_read_b64_tr_b16 v[92:93], v23 offset:2048
    ds_read_b64_tr_b16 v[94:95], v23 offset:2560
    ds_read_b64_tr_b16 v[100:101], v24 offset:2048
    ds_read_b64_tr_b16 v[102:103], v24 offset:2560
    ds_read_b128 v[60:63], v12 offset:0
    s_add_u32 s65, s65, 24576
    s_cmp_eq_u32 s65, 155648
    s_cselect_b32 s65, 32768, s65
    s_setprio 1
    s_waitcnt lgkmcnt(0)
    v_mfma_f32_32x32x16_bf16 v[152:167], v[64:67], v[56:59], v[152:167]
    v_mfma_f32_32x32x16_bf16 v[168:183], v[72:75], v[56:59], v[168:183]
    v_mfma_f32_32x32x16_bf16 v[184:199], v[80:83], v[56:59], v[184:199]
    v_mfma_f32_32x32x16_bf16 v[200:215], v[88:91], v[56:59], v[200:215]
    v_mfma_f32_32x32x16_bf16 v[216:231], v[96:99], v[56:59], v[216:231]
    v_mfma_f32_32x32x16_bf16 v[152:167], v[68:71], v[60:63], v[152:167]
    v_mfma_f32_32x32x16_bf16 v[168:183], v[76:79], v[60:63], v[168:183]
    v_mfma_f32_32x32x16_bf16 v[184:199], v[84:87], v[60:63], v[184:199]
    v_mfma_f32_32x32x16_bf16 v[200:215], v[92:95], v[60:63], v[200:215]
    v_mfma_f32_32x32x16_bf16 v[216:231], v[100:103], v[60:63], v[216:231]
    s_cmp_lg_u32 s68, 0
    s_cbranch_scc1 L_QA_pc0
    v_mfma_f32_16x16x32_bf16 v[32:35], v[64:67], v[52:55], v[32:35]
    v_mfma_f32_16x16x32_bf16 v[36:39], v[72:75], v[52:55], v[36:39]
    v_mfma_f32_16x16x32_bf16 v[40:43], v[80:83], v[52:55], v[40:43]
    v_mfma_f32_16x16x32_bf16 v[44:47], v[88:91], v[52:55], v[44:47]
    v_mfma_f32_16x16x32_bf16 v[48:51], v[96:99], v[52:55], v[48:51]
    v_mfma_f32_16x16x32_bf16 v[32:35], v[68:71], v[52:55], v[32:35]
    v_mfma_f32_16x16x32_bf16 v[36:39], v[76:79], v[52:55], v[36:39]
    v_mfma_f32_16x16x32_bf16 v[40:43], v[84:87], v[52:55], v[40:43]
    v_mfma_f32_16x16x32_bf16 v[44:47], v[92:95], v[52:55], v[44:47]
    v_mfma_f32_16x16x32_bf16 v[48:51], v[100:103], v[52:55], v[48:51]
L_QA_pc0:
    s_add_u32 m0, s64, 0
    s_nop 0
    buffer_load_dwordx4 v8, s[40:43], s60 offen offset:0 lds
    s_add_u32 m0, s64, 3968
    s_nop 0
    buffer_load_dwordx4 v8, s[40:43], s60 offen offset:128 lds
    s_add_u32 m0, s64, 7936
    s_nop 0
    buffer_load_dwordx4 v8, s[40:43], s60 offen offset:256 lds
    s_add_u32 m0, s64, 11904
    s_nop 0
    buffer_load_dwordx4 v8, s[40:43], s60 offen offset:384 lds
    s_add_u32 m0, s64, 15872
    s_nop 0
    buffer_load_dwordx4 v8, s[40:43], s60 offen offset:512 lds
    s_add_u32 s64, s64, 49152
    s_cmp_ge_u32 s64, s74
    s_cselect_b32 s70, 122880, 0
    s_sub_u32 s64, s64, s70
    s_add_u32 s60, s60, 245760
    s_cmp_ge_u32 s60, 2457600
    s_cselect_b32 s70, 2457600, 0
    s_sub_u32 s60, s60, s70
    s_sub_u32 s81, s56, 1
    s_cmp_gt_u32 s81, 1
    s_cbranch_scc1 L_QA_nou
    s_lshl_b32 s92, s58, 4
    s_add_u32 s92, s92, s57
    s_lshl_b32 s92, s92, 1
    s_add_u32 s92, s92, s81
    s_lshl_b32 s82, s81, 12
    s_add_u32 s82, s82, 155648
    s_mul_i32 s93, s92, 205
    s_lshr_b32 s93, s93, 11
    s_mul_i32 s94, s93, 10
    s_sub_u32 s94, s92, s94
    s_cmp_lt_u32 s93, 54
    s_cselect_b32 s88, s28, s20
    s_cselect_b32 s89, s29, s21
    s_mov_b32 s90, 819200
    s_cselect_b32 s90, 2211840, s90
    s_cselect_b32 s70, 0, 54
    s_and_b32 s89, s89, 0xffff
    s_mov_b32 s91, 0x20000
    s_sub_u32 s70, s93, s70
    s_mul_i32 s70, s70, 40960
    s_lshl_b32 s71, s94, 7
    s_add_u32 s70, s70, s71
    v_lshrrev_b32 v2, 3, v1
    v_mul_u32_u24 v2, 1280, v2
    v_and_b32 v3, 7, v1
    v_lshl_add_u32 v2, v3, 4, v2
    s_add_u32 m0, s82, 0
    s_nop 0
    buffer_load_dwordx4 v2, s[88:91], s70 offen lds
    s_add_u32 s70, s70, 10240
    s_add_u32 m0, s82, 1024
    s_nop 0
    buffer_load_dwordx4 v2, s[88:91], s70 offen lds
    s_add_u32 s70, s70, 10240
    s_add_u32 m0, s82, 2048
    s_nop 0
    buffer_load_dwordx4 v2, s[88:91], s70 offen lds
    s_add_u32 s70, s70, 10240
    s_add_u32 m0, s82, 3072
    s_nop 0
    buffer_load_dwordx4 v2, s[88:91], s70 offen lds
    s_add_u32 s70, s70, 10240
L_QA_nou:
    s_barrier
    v_add_u32 v20, s65, v15
    v_add_u32 v21, s65, v16
    v_add_u32 v22, s65, v17
    v_add_u32 v23, s65, v18
    v_add_u32 v24, s65, v19
    ds_read_b64_tr_b16 v[112:113], v20 offset:0
    ds_read_b64_tr_b16 v[114:115], v20 offset:512
    ds_read_b64_tr_b16 v[120:121], v21 offset:0
    ds_read_b64_tr_b16 v[122:123], v21 offset:512
    ds_read_b64_tr_b16 v[128:129], v22 offset:0
    ds_read_b64_tr_b16 v[130:131], v22 offset:512
    ds_read_b64_tr_b16 v[136:137], v23 offset:0
    ds_read_b64_tr_b16 v[138:139], v23 offset:512
    ds_read_b64_tr_b16 v[144:145], v24 offset:0
    ds_read_b64_tr_b16 v[146:147], v24 offset:512
    ds_read_b128 v[104:107], v13 offset:0
    ds_read_b64_tr_b16 v[116:117], v20 offset:2048
    ds_read_b64_tr_b16 v[118:119], v20 offset:2560
    ds_read_b64_tr_b16 v[124:125], v21 offset:2048
    ds_read_b64_tr_b16 v[126:127], v21 offset:2560
    ds_read_b64_tr_b16 v[132:133], v22 offset:2048
    ds_read_b64_tr_b16 v[134:135], v22 offset:2560
    ds_read_b64_tr_b16 v[140:141], v23 offset:2048
    ds_read_b64_tr_b16 v[142:143], v23 offset:2560
    ds_read_b64_tr_b16 v[148:149], v24 offset:2048
    ds_read_b64_tr_b16 v[150:151], v24 offset:2560
    ds_read_b128 v[108:111], v14 offset:0
    s_add_u32 s65, s65, 24576
    s_cmp_eq_u32 s65, 155648
    s_cselect_b32 s65, 32768, s65
    s_waitcnt lgkmcnt(0)
    v_mfma_f32_32x32x16_bf16 v[152:167], v[112:115], v[104:107], v[152:167]
    v_mfma_f32_32x32x16_bf16 v[168:183], v[120:123], v[104:107], v[168:183]
    v_mfma_f32_32x32x16_bf16 v[184:199], v[128:131], v[104:107], v[184:199]
    v_mfma_f32_32x32x16_bf16 v[200:215], v[136:139], v[104:107], v[200:215]
    v_mfma_f32_32x32x16_bf16 v[216:231], v[144:147], v[104:107], v[216:231]
    v_mfma_f32_32x32x16_bf16 v[152:167], v[116:119], v[108:111], v[152:167]
    v_mfma_f32_32x32x16_bf16 v[168:183], v[124:127], v[108:111], v[168:183]
    v_mfma_f32_32x32x16_bf16 v[184:199], v[132:135], v[108:111], v[184:199]
    v_mfma_f32_32x32x16_bf16 v[200:215], v[140:143], v[108:111], v[200:215]
    v_mfma_f32_32x32x16_bf16 v[216:231], v[148:151], v[108:111], v[216:231]
    s_add_u32 m0, s64, 0
    s_nop 0
    buffer_load_dwordx4 v8, s[40:43], s60 offen offset:0 lds
    s_add_u32 m0, s64, 3968
    s_nop 0
    buffer_load_dwordx4 v8, s[40:43], s60 offen offset:128 lds
    s_add_u32 m0, s64, 7936
    s_nop 0
    buffer_load_dwordx4 v8, s[40:43], s60 offen offset:256 lds
    s_add_u32 m0, s64, 11904
    s_nop 0
    buffer_load_dwordx4 v8, s[40:43], s60 offen offset:384 lds
    s_add_u32 m0, s64, 15872
    s_nop 0
    buffer_load_dwordx4 v8, s[40:43], s60 offen offset:512 lds
    s_add_u32 s64, s64, 49152
    s_cmp_ge_u32 s64, s74
    s_cselect_b32 s70, 122880, 0
    s_sub_u32 s64, s64, s70
    s_add_u32 s60, s60, 245760
    s_cmp_ge_u32 s60, 2457600
    s_cselect_b32 s70, 2457600, 0
    s_sub_u32 s60, s60, s70
    s_cmp_eq_u32 s68, 0
    s_cbranch_scc1 L_QA_cs1
    s_waitcnt vmcnt(5)
L_QA_pc1:
    s_cmp_gt_u32 s81, 1
    s_cbranch_scc1 L_QA_pc2
    s_mul_i32 s93, s92, 205
    s_lshr_b32 s93, s93, 11
    s_mul_i32 s94, s93, 10
    s_sub_u32 s94, s92, s94
    v_bfe_u32 v2, v1, 2, 2
    v_lshlrev_b32 v2, 7, v2
    v_and_b32 v3, 3, v1
    v_lshl_add_u32 v2, v3, 3, v2
    v_lshrrev_b32 v3, 4, v1
    s_cmp_lt_u32 s93, 54
    s_cselect_b32 s70, 10, 9
    s_movk_i32 s71, 512
    s_cselect_b32 s71, s71, 2048
    v_lshlrev_b32 v3, s70, v3
    v_add3_u32 v2, v2, v3, s82
    v_add_u32 v3, s71, v2
    ds_read_b64_tr_b16 v[232:233], v2 offset:0
    ds_read_b64_tr_b16 v[234:235], v3 offset:0
    ds_read_b64_tr_b16 v[236:237], v2 offset:32
    ds_read_b64_tr_b16 v[238:239], v3 offset:32
    ds_read_b64_tr_b16 v[240:241], v2 offset:64
    ds_read_b64_tr_b16 v[242:243], v3 offset:64
    ds_read_b64_tr_b16 v[244:245], v2 offset:96
    ds_read_b64_tr_b16 v[246:247], v3 offset:96
    v_lshlrev_b32 v4, 4, v1
    s_waitcnt lgkmcnt(0)
    s_lshl_b32 s70, s94, 2
    s_add_u32 s70, s70, 0
    s_mul_i32 s71, s70, 205
    s_lshr_b32 s71, s71, 10
    s_mul_i32 s75, s71, 365
    s_add_u32 s70, s70, s75
    s_mul_i32 s75, s93, 5
    s_add_u32 s70, s70, s75
    s_lshl_b32 s70, s70, 10
    s_add_u32 s70, s70, 10485760
    s_cmp_lt_u32 s92, 740
    s_cselect_b32 s70, s70, 1073741824
    buffer_store_dwordx4 v[232:235], v4, s[44:47], s70 offen sc1
    s_lshl_b32 s70, s94, 2
    s_add_u32 s70, s70, 1
    s_mul_i32 s71, s70, 205
    s_lshr_b32 s71, s71, 10
    s_mul_i32 s75, s71, 365
    s_add_u32 s70, s70, s75
    s_mul_i32 s75, s93, 5
    s_add_u32 s70, s70, s75
    s_lshl_b32 s70, s70, 10
    s_add_u32 s70, s70, 10485760
    s_cmp_lt_u32 s92, 740
    s_cselect_b32 s70, s70, 1073741824
    buffer_store_dwordx4 v[236:239], v4, s[44:47], s70 offen sc1
    s_lshl_b32 s70, s94, 2
    s_add_u32 s70, s70, 2
    s_mul_i32 s71, s70, 205
    s_lshr_b32 s71, s71, 10
    s_mul_i32 s75, s71, 365
    s_add_u32 s70, s70, s75
    s_mul_i32 s75, s93, 5
    s_add_u32 s70, s70, s75
    s_lshl_b32 s70, s70, 10
    s_add_u32 s70, s70, 10485760
    s_cmp_lt_u32 s92, 740
    s_cselect_b32 s70, s70, 1073741824
    buffer_store_dwordx4 v[240:243], v4, s[44:47], s70 offen sc1
    s_lshl_b32 s70, s94, 2
    s_add_u32 s70, s70, 3
    s_mul_i32 s71, s70, 205
    s_lshr_b32 s71, s71, 10
    s_mul_i32 s75, s71, 365
    s_add_u32 s70, s70, s75
    s_mul_i32 s75, s93, 5
    s_add_u32 s70, s70, s75
    s_lshl_b32 s70, s70, 10
    s_add_u32 s70, s70, 10485760
    s_cmp_lt_u32 s92, 740
    s_cselect_b32 s70, s70, 1073741824
    buffer_store_dwordx4 v[244:247], v4, s[44:47], s70 offen sc1
L_QA_pc2:
    s_barrier
    v_xor_b32 v11, 16384, v11
    v_xor_b32 v12, 16384, v12
    v_xor_b32 v13, 16384, v13
    v_xor_b32 v14, 16384, v14
    v_add_u32 v20, s65, v15
    v_add_u32 v21, s65, v16
    v_add_u32 v22, s65, v17
    v_add_u32 v23, s65, v18
    v_add_u32 v24, s65, v19
    ds_read_b64_tr_b16 v[64:65], v20 offset:0
    ds_read_b64_tr_b16 v[66:67], v20 offset:512
    ds_read_b64_tr_b16 v[72:73], v21 offset:0
    ds_read_b64_tr_b16 v[74:75], v21 offset:512
    ds_read_b64_tr_b16 v[80:81], v22 offset:0
    ds_read_b64_tr_b16 v[82:83], v22 offset:512
    ds_read_b64_tr_b16 v[88:89], v23 offset:0
    ds_read_b64_tr_b16 v[90:91], v23 offset:512
    ds_read_b64_tr_b16 v[96:97], v24 offset:0
    ds_read_b64_tr_b16 v[98:99], v24 offset:512
    ds_read_b128 v[56:59], v11 offset:0
    ds_read_b64_tr_b16 v[68:69], v20 offset:2048
    ds_read_b64_tr_b16 v[70:71], v20 offset:2560
    ds_read_b64_tr_b16 v[76:77], v21 offset:2048
    ds_read_b64_tr_b16 v[78:79], v21 offset:2560
    ds_read_b64_tr_b16 v[84:85], v22 offset:2048
    ds_read_b64_tr_b16 v[86:87], v22 offset:2560
    ds_read_b64_tr_b16 v[92:93], v23 offset:2048
    ds_read_b64_tr_b16 v[94:95], v23 offset:2560
    ds_read_b64_tr_b16 v[100:101], v24 offset:2048
    ds_read_b64_tr_b16 v[102:103], v24 offset:2560
    ds_read_b128 v[60:63], v12 offset:0
    s_add_u32 s65, s65, 24576
    s_cmp_eq_u32 s65, 155648
    s_cselect_b32 s65, 32768, s65
    s_mov_b32 s59, 1
    s_waitcnt lgkmcnt(0)
.p2align 6
L_QA_loop:
    v_mfma_f32_32x32x16_bf16 v[152:167], v[64:67], v[56:59], v[152:167]
    v_add_u32 v20, s65, v15
    v_add_u32 v21, s65, v16
    v_add_u32 v22, s65, v17
    v_add_u32 v23, s65, v18
    v_add_u32 v24, s65, v19
    v_mfma_f32_32x32x16_bf16 v[168:183], v[72:75], v[56:59], v[168:183]
    ds_read_b64_tr_b16 v[112:113], v20 offset:0
    ds_read_b64_tr_b16 v[114:115], v20 offset:512
    ds_read_b64_tr_b16 v[120:121], v21 offset:0
    ds_read_b64_tr_b16 v[122:123], v21 offset:512
    v_mfma_f32_32x32x16_bf16 v[184:199], v[80:83], v[56:59], v[184:199]
    ds_read_b64_tr_b16 v[128:129], v22 offset:0
    ds_read_b64_tr_b16 v[130:131], v22 offset:512
    ds_read_b64_tr_b16 v[136:137], v23 offset:0
    ds_read_b64_tr_b16 v[138:139], v23 offset:512
    v_mfma_f32_32x32x16_bf16 v[200:215], v[88:91], v[56:59], v[200:215]
    ds_read_b64_tr_b16 v[144:145], v24 offset:0
    ds_read_b64_tr_b16 v[146:147], v24 offset:512
    ds_read_b128 v[104:107], v13 offset:0
    v_mfma_f32_32x32x16_bf16 v[216:231], v[96:99], v[56:59], v[216:231]
    ds_read_b64_tr_b16 v[116:117], v20 offset:2048
    ds_read_b64_tr_b16 v[118:119], v20 offset:2560
    ds_read_b64_tr_b16 v[124:125], v21 offset:2048
    ds_read_b64_tr_b16 v[126:127], v21 offset:2560
    v_mfma_f32_32x32x16_bf16 v[152:167], v[68:71], v[60:63], v[152:167]
    ds_read_b64_tr_b16 v[132:133], v22 offset:2048
    ds_read_b64_tr_b16 v[134:135], v22 offset:2560
    ds_read_b64_tr_b16 v[140:141], v23 offset:2048
    ds_read_b64_tr_b16 v[142:143], v23 offset:2560
    v_mfma_f32_32x32x16_bf16 v[168:183], v[76:79], v[60:63], v[168:183]
    ds_read_b64_tr_b16 v[148:149], v24 offset:2048
    ds_read_b64_tr_b16 v[150:151], v24 offset:2560
    ds_read_b128 v[108:111], v14 offset:0
    v_mfma_f32_32x32x16_bf16 v[184:199], v[84:87], v[60:63], v[184:199]
    v_mfma_f32_32x32x16_bf16 v[200:215], v[92:95], v[60:63], v[200:215]
    s_add_u32 s65, s65, 24576
    s_cmp_eq_u32 s65, 155648
    s_cselect_b32 s65, 32768, s65
    v_mfma_f32_32x32x16_bf16 v[216:231], v[100:103], v[60:63], v[216:231]
    s_bitcmp1_b32 s69, s59
    s_cbranch_scc1 L_QA_spec
L_QA_specr:
    s_add_u32 m0, s64, 0
    s_nop 0
    buffer_load_dwordx4 v8, s[40:43], s60 offen offset:0 lds
    s_add_u32 m0, s64, 3968
    s_nop 0
    buffer_load_dwordx4 v8, s[40:43], s60 offen offset:128 lds
    s_add_u32 m0, s64, 7936
    s_nop 0
    buffer_load_dwordx4 v8, s[40:43], s60 offen offset:256 lds
    s_add_u32 m0, s64, 11904
    s_nop 0
    buffer_load_dwordx4 v8, s[40:43], s60 offen offset:384 lds
    s_add_u32 m0, s64, 15872
    s_nop 0
    buffer_load_dwordx4 v8, s[40:43], s60 offen offset:512 lds
    s_add_u32 s64, s64, 49152
    s_cmp_ge_u32 s64, s74
    s_cselect_b32 s70, 122880, 0
    s_sub_u32 s64, s64, s70
    s_add_u32 s60, s60, 245760
    s_cmp_ge_u32 s60, 2457600
    s_cselect_b32 s70, 2457600, 0
    s_sub_u32 s60, s60, s70
    s_waitcnt vmcnt(5) lgkmcnt(0)
L_QA_bar:
    s_barrier
    v_mfma_f32_32x32x16_bf16 v[152:167], v[112:115], v[104:107], v[152:167]
    v_xor_b32 v11, 16384, v11
    v_xor_b32 v12, 16384, v12
    v_add_u32 v20, s65, v15
    v_add_u32 v21, s65, v16
    v_add_u32 v22, s65, v17
    v_add_u32 v23, s65, v18
    v_add_u32 v24, s65, v19
    v_mfma_f32_32x32x16_bf16 v[168:183], v[120:123], v[104:107], v[168:183]
    ds_read_b64_tr_b16 v[64:65], v20 offset:0
    ds_read_b64_tr_b16 v[66:67], v20 offset:512
    ds_read_b64_tr_b16 v[72:73], v21 offset:0
    ds_read_b64_tr_b16 v[74:75], v21 offset:512
    v_mfma_f32_32x32x16_bf16 v[184:199], v[128:131], v[104:107], v[184:199]
    ds_read_b64_tr_b16 v[80:81], v22 offset:0
    ds_read_b64_tr_b16 v[82:83], v22 offset:512
    ds_read_b64_tr_b16 v[88:89], v23 offset:0
    ds_read_b64_tr_b16 v[90:91], v23 offset:512
    v_mfma_f32_32x32x16_bf16 v[200:215], v[136:139], v[104:107], v[200:215]
    ds_read_b64_tr_b16 v[96:97], v24 offset:0
    ds_read_b64_tr_b16 v[98:99], v24 offset:512
    ds_read_b128 v[56:59], v11 offset:0
    v_mfma_f32_32x32x16_bf16 v[216:231], v[144:147], v[104:107], v[216:231]
    ds_read_b64_tr_b16 v[68:69], v20 offset:2048
    ds_read_b64_tr_b16 v[70:71], v20 offset:2560
    ds_read_b64_tr_b16 v[76:77], v21 offset:2048
    ds_read_b64_tr_b16 v[78:79], v21 offset:2560
    v_mfma_f32_32x32x16_bf16 v[152:167], v[116:119], v[108:111], v[152:167]
    ds_read_b64_tr_b16 v[84:85], v22 offset:2048
    ds_read_b64_tr_b16 v[86:87], v22 offset:2560
    ds_read_b64_tr_b16 v[92:93], v23 offset:2048
    ds_read_b64_tr_b16 v[94:95], v23 offset:2560
    v_mfma_f32_32x32x16_bf16 v[168:183], v[124:127], v[108:111], v[168:183]
    ds_read_b64_tr_b16 v[100:101], v24 offset:2048
    ds_read_b64_tr_b16 v[102:103], v24 offset:2560
    ds_read_b128 v[60:63], v12 offset:0
    v_mfma_f32_32x32x16_bf16 v[184:199], v[132:135], v[108:111], v[184:199]
    s_add_u32 s65, s65, 24576
    s_cmp_eq_u32 s65, 155648
    s_cselect_b32 s65, 32768, s65
    v_xor_b32 v13, 16384, v13
    v_xor_b32 v14, 16384, v14
    v_mfma_f32_32x32x16_bf16 v[200:215], v[140:143], v[108:111], v[200:215]
    s_add_u32 s59, s59, 1
    s_cmp_lt_u32 s59, 10
    v_mfma_f32_32x32x16_bf16 v[216:231], v[148:151], v[108:111], v[216:231]
    s_waitcnt lgkmcnt(0)
    s_cbranch_scc1 L_QA_loop
    s_branch L_Q_epi
L_QA_cs1:
    v_mfma_f32_16x16x32_bf16 v[32:35], v[112:115], v[52:55], v[32:35]
    v_mfma_f32_16x16x32_bf16 v[36:39], v[120:123], v[52:55], v[36:39]
    v_mfma_f32_16x16x32_bf16 v[40:43], v[128:131], v[52:55], v[40:43]
    v_mfma_f32_16x16x32_bf16 v[44:47], v[136:139], v[52:55], v[44:47]
    v_mfma_f32_16x16x32_bf16 v[48:51], v[144:147], v[52:55], v[48:51]
    v_mfma_f32_16x16x32_bf16 v[32:35], v[116:119], v[52:55], v[32:35]
    v_mfma_f32_16x16x32_bf16 v[36:39], v[124:127], v[52:55], v[36:39]
    v_mfma_f32_16x16x32_bf16 v[40:43], v[132:135], v[52:55], v[40:43]
    v_mfma_f32_16x16x32_bf16 v[44:47], v[140:143], v[52:55], v[44:47]
    v_mfma_f32_16x16x32_bf16 v[48:51], v[148:151], v[52:55], v[48:51]
    v_and_b32 v2, 15, v1
    v_lshrrev_b32 v3, 4, v1
    v_lshlrev_b32 v3, 4, v3
    v_lshl_add_u32 v3, v2, 6, v3
    v_cmp_gt_u32 vcc, 2, v2
    v_mov_b32 v4, 1073741824
    s_nop 0
    v_cndmask_b32 v3, v4, v3, vcc
    s_mul_i32 s70, s58, 10
    s_add_u32 s70, s70, s76
    s_mul_i32 s70, s70, 1536
    s_mul_i32 s71, s73, 640
    s_add_u32 s70, s70, s71
    s_add_u32 s70, s70, 13697024
    buffer_store_dwordx4 v[32:35], v3, s[44:47], s70 offen offset:0 sc1
    buffer_store_dwordx4 v[36:39], v3, s[44:47], s70 offen offset:128 sc1
    buffer_store_dwordx4 v[40:43], v3, s[44:47], s70 offen offset:256 sc1
    buffer_store_dwordx4 v[44:47], v3, s[44:47], s70 offen offset:384 sc1
    buffer_store_dwordx4 v[48:51], v3, s[44:47], s70 offen offset:512 sc1
    s_waitcnt vmcnt(10)
    s_branch L_QA_pc1
L_QA_spec:
    s_cmp_eq_u32 s59, 9
    s_cbranch_scc1 L_QA_sum
    s_cmp_eq_u32 s59, 8
    s_cbranch_scc1 L_QA_go
    s_cmp_eq_u32 s59, 7
    s_cbranch_scc1 L_QA_chk
    s_cmp_eq_u32 s59, 6
    s_cbranch_scc1 L_QA_poll0
L_QA_pub:
    s_cmp_lg_u32 s59, 2
    s_cbranch_scc1 L_QA_pub1
    s_branch L_QA_wz_c
L_QA_wz:
    s_sleep 4
    buffer_load_dword v30, off, s[48:51], 0 sc1
L_QA_wz_c:
    s_waitcnt vmcnt(0)
    v_readfirstlane_b32 s70, v30
    s_add_u32 s78, s78, 1
    s_cmp_gt_u32 s78, 1048576
    s_cbranch_scc1 L_QA_wz_ok
    s_cmp_lt_u32 s70, 16
    s_cbranch_scc1 L_QA_wz
L_QA_wz_ok:
L_QA_pub1:
    s_add_u32 m0, s64, 0
    s_nop 0
    buffer_load_dwordx4 v8, s[40:43], s60 offen offset:0 lds
    s_add_u32 m0, s64, 3968
    s_nop 0
    buffer_load_dwordx4 v8, s[40:43], s60 offen offset:128 lds
    s_add_u32 m0, s64, 7936
    s_nop 0
    buffer_load_dwordx4 v8, s[40:43], s60 offen offset:256 lds
    s_add_u32 m0, s64, 11904
    s_nop 0
    buffer_load_dwordx4 v8, s[40:43], s60 offen offset:384 lds
    s_add_u32 m0, s64, 15872
    s_nop 0
    buffer_load_dwordx4 v8, s[40:43], s60 offen offset:512 lds
    s_add_u32 s64, s64, 49152
    s_cmp_ge_u32 s64, s74
    s_cselect_b32 s70, 122880, 0
    s_sub_u32 s64, s64, s70
    s_add_u32 s60, s60, 245760
    s_cmp_ge_u32 s60, 2457600
    s_cselect_b32 s70, 2457600, 0
    s_sub_u32 s60, s60, s70
    s_cmp_eq_u32 s59, 3
    s_cbranch_scc1 L_QA_pub3
    s_cmp_eq_u32 s59, 2
    s_cbranch_scc1 L_QA_pub2
    buffer_load_dword v30, off, s[48:51], 0 sc1
    s_branch L_QA_pub3
L_QA_pub2:
    s_lshl_b32 s70, s57, 8
    s_add_u32 s70, s70, 14221440
    v_mov_b32 v2, 1073741824
    v_writelane_b32 v2, s70, 0
    v_mov_b32 v3, 1
    buffer_atomic_add v3, v2, s[44:47], 0 offen sc1
L_QA_pub3:
    s_waitcnt vmcnt(6) lgkmcnt(0)
    s_branch L_QA_bar
L_QA_poll0:
    s_add_u32 m0, s64, 0
    s_nop 0
    buffer_load_dwordx4 v8, s[40:43], s60 offen offset:0 lds
    s_add_u32 m0, s64, 3968
    s_nop 0
    buffer_load_dwordx4 v8, s[40:43], s60 offen offset:128 lds
    s_add_u32 m0, s64, 7936
    s_nop 0
    buffer_load_dwordx4 v8, s[40:43], s60 offen offset:256 lds
    s_add_u32 m0, s64, 11904
    s_nop 0
    buffer_load_dwordx4 v8, s[40:43], s60 offen offset:384 lds
    s_add_u32 m0, s64, 15872
    s_nop 0
    buffer_load_dwordx4 v8, s[40:43], s60 offen offset:512 lds
    s_add_u32 s64, s64, 49152
    s_cmp_ge_u32 s64, s74
    s_cselect_b32 s70, 122880, 0
    s_sub_u32 s64, s64, s70
    s_add_u32 s60, s60, 245760
    s_cmp_ge_u32 s60, 2457600
    s_cselect_b32 s70, 2457600, 0
    s_sub_u32 s60, s60, s70
    buffer_load_dword v30, v25, s[44:47], 0 offen sc1
    s_waitcnt vmcnt(6) lgkmcnt(0)
    s_branch L_QA_bar
L_QA_poll:
    s_sleep 8
    buffer_load_dword v30, v25, s[44:47], 0 offen sc1
L_QA_chk:
    s_waitcnt vmcnt(0)
    v_cmp_gt_u32 vcc, 16, v30
    s_add_u32 s78, s78, 1
    s_cmp_gt_u32 s78, 1048576
    s_cbranch_scc1 L_QA_specr
    s_cmp_lg_u64 vcc, 0
    s_cbranch_scc1 L_QA_poll
    s_branch L_QA_specr
L_QA_go:
    v_lshlrev_b32 v2, 3, v0
    v_cmp_gt_u32 vcc, 160, v0
    v_mov_b32 v4, 1073741824
    s_nop 0
    v_cndmask_b32 v2, v4, v2, vcc
    s_mul_i32 s70, s58, 15360
    s_add_u32 s70, s70, 13697024
    buffer_load_dwordx2 v[32:33], v2, s[44:47], s70 offen offset:0 sc1
    buffer_load_dwordx2 v[34:35], v2, s[44:47], s70 offen offset:1536 sc1
    s_add_u32 s70, s70, 3072
    buffer_load_dwordx2 v[36:37], v2, s[44:47], s70 offen offset:0 sc1
    buffer_load_dwordx2 v[38:39], v2, s[44:47], s70 offen offset:1536 sc1
    s_add_u32 s70, s70, 3072
    buffer_load_dwordx2 v[40:41], v2, s[44:47], s70 offen offset:0 sc1
    buffer_load_dwordx2 v[42:43], v2, s[44:47], s70 offen offset:1536 sc1
    s_add_u32 s70, s70, 3072
    buffer_load_dwordx2 v[44:45], v2, s[44:47], s70 offen offset:0 sc1
    buffer_load_dwordx2 v[46:47], v2, s[44:47], s70 offen offset:1536 sc1
    s_add_u32 s70, s70, 3072
    buffer_load_dwordx2 v[48:49], v2, s[44:47], s70 offen offset:0 sc1
    buffer_load_dwordx2 v[50:51], v2, s[44:47], s70 offen offset:1536 sc1
    s_lshl_b32 s70, s57, 10
    s_add_u32 s70, s70, 13631488
    v_lshlrev_b32 v3, 2, v0
    buffer_load_dword v31, v3, s[44:47], s70 offen sc1
    s_lshr_b32 s4, s2, 3
    s_and_b32 s4, s4, 7
    s_mul_i32 s4, s4, 378880
    s_and_b32 s5, s56, 3
    s_mul_i32 s5, s5, 6144
    s_add_u32 s4, s4, s5
    s_add_u32 s4, s4, 10762240
    s_add_u32 s5, s5, 32768
    v_lshlrev_b32 v2, 4, v1
    s_add_u32 m0, s5, 0
    s_add_u32 s6, s4, 0
    buffer_load_dwordx4 v2, s[44:47], s6 offen offset:0 sc1 lds
    buffer_load_dwordx4 v2, s[44:47], s6 offen offset:1024 sc1 lds
    buffer_load_dwordx4 v2, s[44:47], s6 offen offset:2048 sc1 lds
    buffer_load_dwordx4 v2, s[44:47], s6 offen offset:3072 sc1 lds
    s_add_u32 m0, s5, 4096
    s_add_u32 s6, s4, 4096
    buffer_load_dwordx4 v2, s[44:47], s6 offen offset:0 sc1 lds
    buffer_load_dwordx4 v2, s[44:47], s6 offen offset:1024 sc1 lds
    s_waitcnt vmcnt(17) lgkmcnt(0)
    s_branch L_QA_bar
L_QA_sum:
    s_waitcnt vmcnt(6)
    v_add_f32 v32, v32, v34
    v_add_f32 v33, v33, v35
    v_add_f32 v32, v32, v36
    v_add_f32 v33, v33, v37
    v_add_f32 v32, v32, v38
    v_add_f32 v33, v33, v39
    v_add_f32 v32, v32, v40
    v_add_f32 v33, v33, v41
    v_add_f32 v32, v32, v42
    v_add_f32 v33, v33, v43
    v_add_f32 v32, v32, v44
    v_add_f32 v33, v33, v45
    v_add_f32 v32, v32, v46
    v_add_f32 v33, v33, v47
    v_add_f32 v32, v32, v48
    v_add_f32 v33, v33, v49
    v_add_f32 v32, v32, v50
    v_add_f32 v33, v33, v51
    v_lshlrev_b32 v2, 3, v0
    v_add_u32 v2, 155648, v2
    ds_write_b64 v2, v[32:33]
    v_lshlrev_b32 v3, 2, v0
    v_add_u32 v3, 157696, v3
    ds_write_b32 v3, v31
    s_lshr_b32 s4, s2, 3
    s_and_b32 s4, s4, 7
    s_mul_i32 s4, s4, 378880
    s_and_b32 s5, s56, 3
    s_mul_i32 s5, s5, 5120
    s_add_u32 s4, s4, s5
    s_add_u32 s4, s4, 10815488
    s_add_u32 s5, s5, 86016
    v_lshlrev_b32 v2, 4, v1
    s_add_u32 m0, s5, 0
    s_add_u32 s6, s4, 0
    buffer_load_dwordx4 v2, s[44:47], s6 offen offset:0 sc1 lds
    buffer_load_dwordx4 v2, s[44:47], s6 offen offset:1024 sc1 lds
    buffer_load_dwordx4 v2, s[44:47], s6 offen offset:2048 sc1 lds
    buffer_load_dwordx4 v2, s[44:47], s6 offen offset:3072 sc1 lds
    s_add_u32 m0, s5, 4096
    s_add_u32 s6, s4, 4096
    buffer_load_dwordx4 v2, s[44:47], s6 offen offset:0 sc1 lds
    s_waitcnt lgkmcnt(0)
    s_branch L_QA_bar
L_Q_roleB:
    s_add_u32 m0, s64, 0
    s_nop 0
    buffer_load_dwordx4 v8, s[40:43], s60 offen offset:0 lds
    s_add_u32 m0, s64, 3968
    s_nop 0
    buffer_load_dwordx4 v8, s[40:43], s60 offen offset:128 lds
    s_add_u32 m0, s64, 7936
    s_nop 0
    buffer_load_dwordx4 v8, s[40:43], s60 offen offset:256 lds
    s_add_u32 m0, s64, 11904
    s_nop 0
    buffer_load_dwordx4 v8, s[40:43], s60 offen offset:384 lds
    s_add_u32 m0, s64, 15872
    s_nop 0
    buffer_load_dwordx4 v8, s[40:43], s60 offen offset:512 lds
    s_add_u32 s64, s64, 49152
    s_cmp_ge_u32 s64, s74
    s_cselect_b32 s70, 122880, 0
    s_sub_u32 s64, s64, s70
    s_add_u32 s60, s60, 245760
    s_cmp_ge_u32 s60, 2457600
    s_cselect_b32 s70, 2457600, 0
    s_sub_u32 s60, s60, s70
    s_waitcnt vmcnt(9)
    v_lshlrev_b32 v64, 16, v56
    v_and_b32 v65, 0xffff0000, v56
    v_lshlrev_b32 v66, 16, v57
    v_and_b32 v67, 0xffff0000, v57
    v_lshlrev_b32 v68, 16, v58
    v_and_b32 v69, 0xffff0000, v58
    v_lshlrev_b32 v70, 16, v59
    v_and_b32 v71, 0xffff0000, v59
    v_lshlrev_b32 v72, 16, v60
    v_and_b32 v73, 0xffff0000, v60
    v_add_f32 v76, v64, v65
    v_add_f32 v76, v76, v66
    v_add_f32 v76, v76, v67
    v_add_f32 v76, v76, v68
    v_add_f32 v76, v76, v69
    v_add_f32 v76, v76, v70
    v_add_f32 v76, v76, v71
    v_add_f32 v76, v76, v72
    v_add_f32 v76, v76, v73
    s_nop 1
    v_add_f32_dpp v76, v76, v76 quad_perm:[1,0,3,2] row_mask:0xf bank_mask:0xf
    s_nop 1
    v_add_f32_dpp v76, v76, v76 quad_perm:[2,3,0,1] row_mask:0xf bank_mask:0xf
    s_nop 1
    v_add_f32_dpp v76, v76, v76 row_half_mirror row_mask:0xf bank_mask:0xf
    s_nop 1
    v_add_f32_dpp v76, v76, v76 row_mirror row_mask:0xf bank_mask:0xf
    s_nop 0
    v_readlane_b32 s4, v76, 0
    v_readlane_b32 s5, v76, 16
    v_readlane_b32 s6, v76, 32
    v_readlane_b32 s7, v76, 48
    v_mov_b32 v76, s4
    v_mov_b32 v77, s6
    v_add_f32 v76, s5, v76
    v_add_f32 v77, s7, v77
    v_add_f32 v76, v76, v77
    v_mul_f32 v76, 0x3acccccd, v76
    v_sub_f32 v64, v64, v76
    v_sub_f32 v65, v65, v76
    v_sub_f32 v66, v66, v76
    v_sub_f32 v67, v67, v76
    v_sub_f32 v68, v68, v76
    v_sub_f32 v69, v69, v76
    v_sub_f32 v70, v70, v76
    v_sub_f32 v71, v71, v76
    v_sub_f32 v72, v72, v76
    v_sub_f32 v73, v73, v76
    v_mul_f32 v77, v64, v64
    v_fmac_f32 v77, v65, v65
    v_fmac_f32 v77, v66, v66
    v_fmac_f32 v77, v67, v67
    v_fmac_f32 v77, v68, v68
    v_fmac_f32 v77, v69, v69
    v_fmac_f32 v77, v70, v70
    v_fmac_f32 v77, v71, v71
    v_fmac_f32 v77, v72, v72
    v_fmac_f32 v77, v73, v73
    s_nop 1
    v_add_f32_dpp v77, v77, v77 quad_perm:[1,0,3,2] row_mask:0xf bank_mask:0xf
    s_nop 1
    v_add_f32_dpp v77, v77, v77 quad_perm:[2,3,0,1] row_mask:0xf bank_mask:0xf
    s_nop 1
    v_add_f32_dpp v77, v77, v77 row_half_mirror row_mask:0xf bank_mask:0xf
    s_nop 1
    v_add_f32_dpp v77, v77, v77 row_mirror row_mask:0xf bank_mask:0xf
    s_nop 0
    v_readlane_b32 s4, v77, 0
    v_readlane_b32 s5, v77, 16
    v_readlane_b32 s6, v77, 32
    v_readlane_b32 s7, v77, 48
    v_mov_b32 v77, s4
    v_mov_b32 v78, s6
    v_add_f32 v77, s5, v77
    v_add_f32 v78, s7, v78
    v_add_f32 v77, v77, v78
    v_mov_b32 v78, 0x3727c5ac
    v_fmac_f32 v78, 0x3acccccd, v77
    v_mov_b32 v77, v78
    v_cmp_eq_u32 vcc, 0, v1
    v_mov_b32 v4, 1073741824
    s_nop 0
    v_cndmask_b32 v2, v4, v1, vcc
    s_lshl_b32 s70, s77, 3
    s_add_u32 s70, s70, 13631488
    buffer_store_dwordx2 v[76:77], v2, s[44:47], s70 offen sc1
    s_waitcnt vmcnt(6)
    s_barrier
    v_add_u32 v20, s65, v15
    v_add_u32 v21, s65, v16
    v_add_u32 v22, s65, v17
    v_add_u32 v23, s65, v18
    v_add_u32 v24, s65, v19
    ds_read_b64_tr_b16 v[64:65], v20 offset:0
    ds_read_b64_tr_b16 v[66:67], v20 offset:512
    ds_read_b64_tr_b16 v[72:73], v21 offset:0
    ds_read_b64_tr_b16 v[74:75], v21 offset:512
    ds_read_b64_tr_b16 v[80:81], v22 offset:0
    ds_read_b64_tr_b16 v[82:83], v22 offset:512
    ds_read_b64_tr_b16 v[88:89], v23 offset:0
    ds_read_b64_tr_b16 v[90:91], v23 offset:512
    ds_read_b64_tr_b16 v[96:97], v24 offset:0
    ds_read_b64_tr_b16 v[98:99], v24 offset:512
    ds_read_b128 v[56:59], v11 offset:0
    ds_read_b64_tr_b16 v[68:69], v20 offset:2048
    ds_read_b64_tr_b16 v[70:71], v20 offset:2560
    ds_read_b64_tr_b16 v[76:77], v21 offset:2048
    ds_read_b64_tr_b16 v[78:79], v21 offset:2560
    ds_read_b64_tr_b16 v[84:85], v22 offset:2048
    ds_read_b64_tr_b16 v[86:87], v22 offset:2560
    ds_read_b64_tr_b16 v[92:93], v23 offset:2048
    ds_read_b64_tr_b16 v[94:95], v23 offset:2560
    ds_read_b64_tr_b16 v[100:101], v24 offset:2048
    ds_read_b64_tr_b16 v[102:103], v24 offset:2560
    ds_read_b128 v[60:63], v12 offset:0
    s_add_u32 s65, s65, 24576
    s_cmp_eq_u32 s65, 155648
    s_cselect_b32 s65, 32768, s65
    s_add_u32 m0, s66, 0
    s_add_u32 s70, s62, 20480
    buffer_load_dwordx4 v6, s[36:39], s62 offen lds
    s_add_u32 m0, s66, 1024
    s_add_u32 s70, s62, 20480
    buffer_load_dwordx4 v7, s[36:39], s62 offen lds
    s_add_u32 m0, s66, 2048
    s_add_u32 s70, s62, 20480
    buffer_load_dwordx4 v6, s[36:39], s70 offen lds
    s_add_u32 m0, s66, 3072
    s_add_u32 s70, s62, 20480
    buffer_load_dwordx4 v7, s[36:39], s70 offen lds
    s_xor_b32 s66, s66, 16384
    s_add_u32 s62, s62, 128
    s_cmp_eq_u32 s62, 1280
    s_cselect_b32 s62, 0, s62
    s_waitcnt lgkmcnt(0)
    v_mfma_f32_32x32x16_bf16 v[152:167], v[64:67], v[56:59], v[152:167]
    v_mfma_f32_32x32x16_bf16 v[168:183], v[72:75], v[56:59], v[168:183]
    v_mfma_f32_32x32x16_bf16 v[184:199], v[80:83], v[56:59], v[184:199]
    v_mfma_f32_32x32x16_bf16 v[200:215], v[88:91], v[56:59], v[200:215]
    v_mfma_f32_32x32x16_bf16 v[216:231], v[96:99], v[56:59], v[216:231]
    v_mfma_f32_32x32x16_bf16 v[152:167], v[68:71], v[60:63], v[152:167]
    v_mfma_f32_32x32x16_bf16 v[168:183], v[76:79], v[60:63], v[168:183]
    v_mfma_f32_32x32x16_bf16 v[184:199], v[84:87], v[60:63], v[184:199]
    v_mfma_f32_32x32x16_bf16 v[200:215], v[92:95], v[60:63], v[200:215]
    v_mfma_f32_32x32x16_bf16 v[216:231], v[100:103], v[60:63], v[216:231]
    s_waitcnt vmcnt(5)
    s_barrier
    v_add_u32 v20, s65, v15
    v_add_u32 v21, s65, v16
    v_add_u32 v22, s65, v17
    v_add_u32 v23, s65, v18
    v_add_u32 v24, s65, v19
    ds_read_b64_tr_b16 v[112:113], v20 offset:0
    ds_read_b64_tr_b16 v[114:115], v20 offset:512
    ds_read_b64_tr_b16 v[120:121], v21 offset:0
    ds_read_b64_tr_b16 v[122:123], v21 offset:512
    ds_read_b64_tr_b16 v[128:129], v22 offset:0
    ds_read_b64_tr_b16 v[130:131], v22 offset:512
    ds_read_b64_tr_b16 v[136:137], v23 offset:0
    ds_read_b64_tr_b16 v[138:139], v23 offset:512
    ds_read_b64_tr_b16 v[144:145], v24 offset:0
    ds_read_b64_tr_b16 v[146:147], v24 offset:512
    ds_read_b128 v[104:107], v13 offset:0
    ds_read_b64_tr_b16 v[116:117], v20 offset:2048
    ds_read_b64_tr_b16 v[118:119], v20 offset:2560
    ds_read_b64_tr_b16 v[124:125], v21 offset:2048
    ds_read_b64_tr_b16 v[126:127], v21 offset:2560
    ds_read_b64_tr_b16 v[132:133], v22 offset:2048
    ds_read_b64_tr_b16 v[134:135], v22 offset:2560
    ds_read_b64_tr_b16 v[140:141], v23 offset:2048
    ds_read_b64_tr_b16 v[142:143], v23 offset:2560
    ds_read_b64_tr_b16 v[148:149], v24 offset:2048
    ds_read_b64_tr_b16 v[150:151], v24 offset:2560
    ds_read_b128 v[108:111], v14 offset:0
    s_add_u32 s65, s65, 24576
    s_cmp_eq_u32 s65, 155648
    s_cselect_b32 s65, 32768, s65
    s_add_u32 m0, s64, 0
    s_nop 0
    buffer_load_dwordx4 v8, s[40:43], s60 offen offset:0 lds
    s_add_u32 m0, s64, 3968
    s_nop 0
    buffer_load_dwordx4 v8, s[40:43], s60 offen offset:128 lds
    s_add_u32 m0, s64, 7936
    s_nop 0
    buffer_load_dwordx4 v8, s[40:43], s60 offen offset:256 lds
    s_add_u32 m0, s64, 11904
    s_nop 0
    buffer_load_dwordx4 v8, s[40:43], s60 offen offset:384 lds
    s_add_u32 m0, s64, 15872
    s_nop 0
    buffer_load_dwordx4 v8, s[40:43], s60 offen offset:512 lds
    s_add_u32 s64, s64, 49152
    s_cmp_ge_u32 s64, s74
    s_cselect_b32 s70, 122880, 0
    s_sub_u32 s64, s64, s70
    s_add_u32 s60, s60, 245760
    s_cmp_ge_u32 s60, 2457600
    s_cselect_b32 s70, 2457600, 0
    s_sub_u32 s60, s60, s70
    s_waitcnt lgkmcnt(0)
    v_mfma_f32_32x32x16_bf16 v[152:167], v[112:115], v[104:107], v[152:167]
    v_mfma_f32_32x32x16_bf16 v[168:183], v[120:123], v[104:107], v[168:183]
    v_mfma_f32_32x32x16_bf16 v[184:199], v[128:131], v[104:107], v[184:199]
    v_mfma_f32_32x32x16_bf16 v[200:215], v[136:139], v[104:107], v[200:215]
    v_mfma_f32_32x32x16_bf16 v[216:231], v[144:147], v[104:107], v[216:231]
    v_mfma_f32_32x32x16_bf16 v[152:167], v[116:119], v[108:111], v[152:167]
    v_mfma_f32_32x32x16_bf16 v[168:183], v[124:127], v[108:111], v[168:183]
    v_mfma_f32_32x32x16_bf16 v[184:199], v[132:135], v[108:111], v[184:199]
    v_mfma_f32_32x32x16_bf16 v[200:215], v[140:143], v[108:111], v[200:215]
    v_mfma_f32_32x32x16_bf16 v[216:231], v[148:151], v[108:111], v[216:231]
    s_waitcnt vmcnt(0)
    s_barrier
    s_add_u32 m0, s66, 0
    s_add_u32 s70, s62, 20480
    buffer_load_dwordx4 v6, s[36:39], s62 offen lds
    s_add_u32 m0, s66, 1024
    s_add_u32 s70, s62, 20480
    buffer_load_dwordx4 v7, s[36:39], s62 offen lds
    s_add_u32 m0, s66, 2048
    s_add_u32 s70, s62, 20480
    buffer_load_dwordx4 v6, s[36:39], s70 offen lds
    s_add_u32 m0, s66, 3072
    s_add_u32 s70, s62, 20480
    buffer_load_dwordx4 v7, s[36:39], s70 offen lds
    s_xor_b32 s66, s66, 16384
    s_add_u32 s62, s62, 128
    s_cmp_eq_u32 s62, 1280
    s_cselect_b32 s62, 0, s62
    s_add_u32 m0, s64, 0
    s_nop 0
    buffer_load_dwordx4 v8, s[40:43], s60 offen offset:0 lds
    s_add_u32 m0, s64, 3968
    s_nop 0
    buffer_load_dwordx4 v8, s[40:43], s60 offen offset:128 lds
    s_add_u32 m0, s64, 7936
    s_nop 0
    buffer_load_dwordx4 v8, s[40:43], s60 offen offset:256 lds
    s_add_u32 m0, s64, 11904
    s_nop 0
    buffer_load_dwordx4 v8, s[40:43], s60 offen offset:384 lds
    s_add_u32 m0, s64, 15872
    s_nop 0
    buffer_load_dwordx4 v8, s[40:43], s60 offen offset:512 lds
    s_add_u32 s64, s64, 49152
    s_cmp_ge_u32 s64, s74
    s_cselect_b32 s70, 122880, 0
    s_sub_u32 s64, s64, s70
    s_add_u32 s60, s60, 245760
    s_cmp_ge_u32 s60, 2457600
    s_cselect_b32 s70, 2457600, 0
    s_sub_u32 s60, s60, s70
    v_xor_b32 v11, 16384, v11
    v_xor_b32 v12, 16384, v12
    v_xor_b32 v13, 16384, v13
    v_xor_b32 v14, 16384, v14
    v_add_u32 v20, s65, v15
    v_add_u32 v21, s65, v16
    v_add_u32 v22, s65, v17
    v_add_u32 v23, s65, v18
    v_add_u32 v24, s65, v19
    ds_read_b64_tr_b16 v[64:65], v20 offset:0
    ds_read_b64_tr_b16 v[66:67], v20 offset:512
    ds_read_b64_tr_b16 v[72:73], v21 offset:0
    ds_read_b64_tr_b16 v[74:75], v21 offset:512
    ds_read_b64_tr_b16 v[80:81], v22 offset:0
    ds_read_b64_tr_b16 v[82:83], v22 offset:512
    ds_read_b64_tr_b16 v[88:89], v23 offset:0
    ds_read_b64_tr_b16 v[90:91], v23 offset:512
    ds_read_b64_tr_b16 v[96:97], v24 offset:0
    ds_read_b64_tr_b16 v[98:99], v24 offset:512
    ds_read_b128 v[56:59], v11 offset:0
    ds_read_b64_tr_b16 v[68:69], v20 offset:2048
    ds_read_b64_tr_b16 v[70:71], v20 offset:2560
    ds_read_b64_tr_b16 v[76:77], v21 offset:2048
    ds_read_b64_tr_b16 v[78:79], v21 offset:2560
    ds_read_b64_tr_b16 v[84:85], v22 offset:2048
    ds_read_b64_tr_b16 v[86:87], v22 offset:2560
    ds_read_b64_tr_b16 v[92:93], v23 offset:2048
    ds_read_b64_tr_b16 v[94:95], v23 offset:2560
    ds_read_b64_tr_b16 v[100:101], v24 offset:2048
    ds_read_b64_tr_b16 v[102:103], v24 offset:2560
    ds_read_b128 v[60:63], v12 offset:0
    s_add_u32 s65, s65, 24576
    s_cmp_eq_u32 s65, 155648
    s_cselect_b32 s65, 32768, s65
    s_mov_b32 s59, 1
    s_waitcnt lgkmcnt(0)
.p2align 6
L_QB_loop:
    v_mfma_f32_32x32x16_bf16 v[152:167], v[64:67], v[56:59], v[152:167]
    v_add_u32 v20, s65, v15
    v_add_u32 v21, s65, v16
    v_add_u32 v22, s65, v17
    v_add_u32 v23, s65, v18
    v_add_u32 v24, s65, v19
    v_mfma_f32_32x32x16_bf16 v[168:183], v[72:75], v[56:59], v[168:183]
    ds_read_b64_tr_b16 v[112:113], v20 offset:0
    ds_read_b64_tr_b16 v[114:115], v20 offset:512
    ds_read_b64_tr_b16 v[120:121], v21 offset:0
    ds_read_b64_tr_b16 v[122:123], v21 offset:512
    v_mfma_f32_32x32x16_bf16 v[184:199], v[80:83], v[56:59], v[184:199]
    ds_read_b64_tr_b16 v[128:129], v22 offset:0
    ds_read_b64_tr_b16 v[130:131], v22 offset:512
    ds_read_b64_tr_b16 v[136:137], v23 offset:0
    ds_read_b64_tr_b16 v[138:139], v23 offset:512
    v_mfma_f32_32x32x16_bf16 v[200:215], v[88:91], v[56:59], v[200:215]
    ds_read_b64_tr_b16 v[144:145], v24 offset:0
    ds_read_b64_tr_b16 v[146:147], v24 offset:512
    ds_read_b128 v[104:107], v13 offset:0
    v_mfma_f32_32x32x16_bf16 v[216:231], v[96:99], v[56:59], v[216:231]
    ds_read_b64_tr_b16 v[116:117], v20 offset:2048
    ds_read_b64_tr_b16 v[118:119], v20 offset:2560
    ds_read_b64_tr_b16 v[124:125], v21 offset:2048
    ds_read_b64_tr_b16 v[126:127], v21 offset:2560
    v_mfma_f32_32x32x16_bf16 v[152:167], v[68:71], v[60:63], v[152:167]
    ds_read_b64_tr_b16 v[132:133], v22 offset:2048
    ds_read_b64_tr_b16 v[134:135], v22 offset:2560
    ds_read_b64_tr_b16 v[140:141], v23 offset:2048
    ds_read_b64_tr_b16 v[142:143], v23 offset:2560
    v_mfma_f32_32x32x16_bf16 v[168:183], v[76:79], v[60:63], v[168:183]
    ds_read_b64_tr_b16 v[148:149], v24 offset:2048
    ds_read_b64_tr_b16 v[150:151], v24 offset:2560
    ds_read_b128 v[108:111], v14 offset:0
    v_mfma_f32_32x32x16_bf16 v[184:199], v[84:87], v[60:63], v[184:199]
    v_mfma_f32_32x32x16_bf16 v[200:215], v[92:95], v[60:63], v[200:215]
    s_add_u32 s65, s65, 24576
    s_cmp_eq_u32 s65, 155648
    s_cselect_b32 s65, 32768, s65
    v_mfma_f32_32x32x16_bf16 v[216:231], v[100:103], v[60:63], v[216:231]
    s_waitcnt vmcnt(0) lgkmcnt(0)
    s_barrier
    s_cmp_ge_u32 s59, 8
    s_cbranch_scc1 L_QB_nod
    s_add_u32 m0, s66, 0
    s_add_u32 s70, s62, 20480
    buffer_load_dwordx4 v6, s[36:39], s62 offen lds
    s_add_u32 m0, s66, 1024
    s_add_u32 s70, s62, 20480
    buffer_load_dwordx4 v7, s[36:39], s62 offen lds
    s_add_u32 m0, s66, 2048
    s_add_u32 s70, s62, 20480
    buffer_load_dwordx4 v6, s[36:39], s70 offen lds
    s_add_u32 m0, s66, 3072
    s_add_u32 s70, s62, 20480
    buffer_load_dwordx4 v7, s[36:39], s70 offen lds
    s_xor_b32 s66, s66, 16384
    s_add_u32 s62, s62, 128
    s_cmp_eq_u32 s62, 1280
    s_cselect_b32 s62, 0, s62
    s_add_u32 m0, s64, 0
    s_nop 0
    buffer_load_dwordx4 v8, s[40:43], s60 offen offset:0 lds
    s_add_u32 m0, s64, 3968
    s_nop 0
    buffer_load_dwordx4 v8, s[40:43], s60 offen offset:128 lds
    s_add_u32 m0, s64, 7936
    s_nop 0
    buffer_load_dwordx4 v8, s[40:43], s60 offen offset:256 lds
    s_add_u32 m0, s64, 11904
    s_nop 0
    buffer_load_dwordx4 v8, s[40:43], s60 offen offset:384 lds
    s_add_u32 m0, s64, 15872
    s_nop 0
    buffer_load_dwordx4 v8, s[40:43], s60 offen offset:512 lds
    s_add_u32 s64, s64, 49152
    s_cmp_ge_u32 s64, s74
    s_cselect_b32 s70, 122880, 0
    s_sub_u32 s64, s64, s70
    s_add_u32 s60, s60, 245760
    s_cmp_ge_u32 s60, 2457600
    s_cselect_b32 s70, 2457600, 0
    s_sub_u32 s60, s60, s70
    v_mfma_f32_32x32x16_bf16 v[152:167], v[112:115], v[104:107], v[152:167]
    v_xor_b32 v11, 16384, v11
    v_xor_b32 v12, 16384, v12
    v_add_u32 v20, s65, v15
    v_add_u32 v21, s65, v16
    v_add_u32 v22, s65, v17
    v_add_u32 v23, s65, v18
    v_add_u32 v24, s65, v19
    v_mfma_f32_32x32x16_bf16 v[168:183], v[120:123], v[104:107], v[168:183]
    ds_read_b64_tr_b16 v[64:65], v20 offset:0
    ds_read_b64_tr_b16 v[66:67], v20 offset:512
    ds_read_b64_tr_b16 v[72:73], v21 offset:0
    ds_read_b64_tr_b16 v[74:75], v21 offset:512
    v_mfma_f32_32x32x16_bf16 v[184:199], v[128:131], v[104:107], v[184:199]
    ds_read_b64_tr_b16 v[80:81], v22 offset:0
    ds_read_b64_tr_b16 v[82:83], v22 offset:512
    ds_read_b64_tr_b16 v[88:89], v23 offset:0
    ds_read_b64_tr_b16 v[90:91], v23 offset:512
    v_mfma_f32_32x32x16_bf16 v[200:215], v[136:139], v[104:107], v[200:215]
    ds_read_b64_tr_b16 v[96:97], v24 offset:0
    ds_read_b64_tr_b16 v[98:99], v24 offset:512
    ds_read_b128 v[56:59], v11 offset:0
    v_mfma_f32_32x32x16_bf16 v[216:231], v[144:147], v[104:107], v[216:231]
    ds_read_b64_tr_b16 v[68:69], v20 offset:2048
    ds_read_b64_tr_b16 v[70:71], v20 offset:2560
    ds_read_b64_tr_b16 v[76:77], v21 offset:2048
    ds_read_b64_tr_b16 v[78:79], v21 offset:2560
    v_mfma_f32_32x32x16_bf16 v[152:167], v[116:119], v[108:111], v[152:167]
    ds_read_b64_tr_b16 v[84:85], v22 offset:2048
    ds_read_b64_tr_b16 v[86:87], v22 offset:2560
    ds_read_b64_tr_b16 v[92:93], v23 offset:2048
    ds_read_b64_tr_b16 v[94:95], v23 offset:2560
    v_mfma_f32_32x32x16_bf16 v[168:183], v[124:127], v[108:111], v[168:183]
    ds_read_b64_tr_b16 v[100:101], v24 offset:2048
    ds_read_b64_tr_b16 v[102:103], v24 offset:2560
    ds_read_b128 v[60:63], v12 offset:0
    v_mfma_f32_32x32x16_bf16 v[184:199], v[132:135], v[108:111], v[184:199]
    s_add_u32 s65, s65, 24576
    s_cmp_eq_u32 s65, 155648
    s_cselect_b32 s65, 32768, s65
    v_xor_b32 v13, 16384, v13
    v_xor_b32 v14, 16384, v14
    v_mfma_f32_32x32x16_bf16 v[200:215], v[140:143], v[108:111], v[200:215]
    s_add_u32 s59, s59, 1
    s_cmp_lt_u32 s59, 10
    v_mfma_f32_32x32x16_bf16 v[216:231], v[148:151], v[108:111], v[216:231]
L_QB_end:
    s_waitcnt lgkmcnt(0)
    s_cbranch_scc1 L_QB_loop
    s_branch L_Q_epi
L_QB_nod:
    s_cmp_eq_u32 s59, 9
    s_cbranch_scc1 L_QB_nod9
    s_lshr_b32 s4, s2, 3
    s_and_b32 s4, s4, 7
    s_mul_i32 s4, s4, 378880
    s_and_b32 s5, s56, 3
    s_mul_i32 s5, s5, 7168
    s_add_u32 s4, s4, s5
    s_add_u32 s4, s4, 10786816
    s_add_u32 s5, s5, 57344
    v_lshlrev_b32 v2, 4, v1
    s_add_u32 m0, s5, 0
    s_add_u32 s6, s4, 0
    buffer_load_dwordx4 v2, s[44:47], s6 offen offset:0 sc1 lds
    buffer_load_dwordx4 v2, s[44:47], s6 offen offset:1024 sc1 lds
    buffer_load_dwordx4 v2, s[44:47], s6 offen offset:2048 sc1 lds
    buffer_load_dwordx4 v2, s[44:47], s6 offen offset:3072 sc1 lds
    s_add_u32 m0, s5, 4096
    s_add_u32 s6, s4, 4096
    buffer_load_dwordx4 v2, s[44:47], s6 offen offset:0 sc1 lds
    buffer_load_dwordx4 v2, s[44:47], s6 offen offset:1024 sc1 lds
    buffer_load_dwordx4 v2, s[44:47], s6 offen offset:2048 sc1 lds
    s_branch L_QB_nod2
L_QB_nod9:
    s_lshr_b32 s4, s2, 3
    s_and_b32 s4, s4, 7
    s_mul_i32 s4, s4, 378880
    s_and_b32 s5, s56, 3
    s_mul_i32 s5, s5, 7168
    s_add_u32 s4, s4, s5
    s_add_u32 s4, s4, 10835968
    s_add_u32 s5, s5, 106496
    v_lshlrev_b32 v2, 4, v1
    s_add_u32 m0, s5, 0
    s_add_u32 s6, s4, 0
    buffer_load_dwordx4 v2, s[44:47], s6 offen offset:0 sc1 lds
    buffer_load_dwordx4 v2, s[44:47], s6 offen offset:1024 sc1 lds
    buffer_load_dwordx4 v2, s[44:47], s6 offen offset:2048 sc1 lds
    buffer_load_dwordx4 v2, s[44:47], s6 offen offset:3072 sc1 lds
    s_add_u32 m0, s5, 4096
    s_add_u32 s6, s4, 4096
    buffer_load_dwordx4 v2, s[44:47], s6 offen offset:0 sc1 lds
    buffer_load_dwordx4 v2, s[44:47], s6 offen offset:1024 sc1 lds
    buffer_load_dwordx4 v2, s[44:47], s6 offen offset:2048 sc1 lds
L_QB_nod2:
    v_mfma_f32_32x32x16_bf16 v[152:167], v[112:115], v[104:107], v[152:167]
    v_xor_b32 v11, 16384, v11
    v_xor_b32 v12, 16384, v12
    v_add_u32 v20, s65, v15
    v_add_u32 v21, s65, v16
    v_add_u32 v22, s65, v17
    v_add_u32 v23, s65, v18
    v_add_u32 v24, s65, v19
    v_mfma_f32_32x32x16_bf16 v[168:183], v[120:123], v[104:107], v[168:183]
    ds_read_b64_tr_b16 v[64:65], v20 offset:0
    ds_read_b64_tr_b16 v[66:67], v20 offset:512
    ds_read_b64_tr_b16 v[72:73], v21 offset:0
    ds_read_b64_tr_b16 v[74:75], v21 offset:512
    v_mfma_f32_32x32x16_bf16 v[184:199], v[128:131], v[104:107], v[184:199]
    ds_read_b64_tr_b16 v[80:81], v22 offset:0
    ds_read_b64_tr_b16 v[82:83], v22 offset:512
    ds_read_b64_tr_b16 v[88:89], v23 offset:0
    ds_read_b64_tr_b16 v[90:91], v23 offset:512
    v_mfma_f32_32x32x16_bf16 v[200:215], v[136:139], v[104:107], v[200:215]
    ds_read_b64_tr_b16 v[96:97], v24 offset:0
    ds_read_b64_tr_b16 v[98:99], v24 offset:512
    ds_read_b128 v[56:59], v11 offset:0
    v_mfma_f32_32x32x16_bf16 v[216:231], v[144:147], v[104:107], v[216:231]
    ds_read_b64_tr_b16 v[68:69], v20 offset:2048
    ds_read_b64_tr_b16 v[70:71], v20 offset:2560
    ds_read_b64_tr_b16 v[76:77], v21 offset:2048
    ds_read_b64_tr_b16 v[78:79], v21 offset:2560
    v_mfma_f32_32x32x16_bf16 v[152:167], v[116:119], v[108:111], v[152:167]
    ds_read_b64_tr_b16 v[84:85], v22 offset:2048
    ds_read_b64_tr_b16 v[86:87], v22 offset:2560
    ds_read_b64_tr_b16 v[92:93], v23 offset:2048
    ds_read_b64_tr_b16 v[94:95], v23 offset:2560
    v_mfma_f32_32x32x16_bf16 v[168:183], v[124:127], v[108:111], v[168:183]
    ds_read_b64_tr_b16 v[100:101], v24 offset:2048
    ds_read_b64_tr_b16 v[102:103], v24 offset:2560
    ds_read_b128 v[60:63], v12 offset:0
    v_mfma_f32_32x32x16_bf16 v[184:199], v[132:135], v[108:111], v[184:199]
    s_add_u32 s65, s65, 24576
    s_cmp_eq_u32 s65, 155648
    s_cselect_b32 s65, 32768, s65
    v_xor_b32 v13, 16384, v13
    v_xor_b32 v14, 16384, v14
    v_mfma_f32_32x32x16_bf16 v[200:215], v[140:143], v[108:111], v[200:215]
    s_add_u32 s59, s59, 1
    s_cmp_lt_u32 s59, 10
    v_mfma_f32_32x32x16_bf16 v[216:231], v[148:151], v[108:111], v[216:231]
    s_branch L_QB_end
L_Q_epi:
    s_setprio 0
    v_lshlrev_b32 v5, 4, v1
    v_lshrrev_b32 v2, 5, v1
    v_lshlrev_b32 v2, 4, v2
    s_mul_i32 s70, s73, 640
    s_add_u32 s70, s70, 155648
    v_add_u32 v2, s70, v2
    v_and_b32 v3, 31, v1
    s_lshl_b32 s70, s72, 8
    s_add_u32 s70, s70, 157696
    v_lshl_add_u32 v3, v3, 3, s70
    ds_read_b64 v[56:57], v3
    buffer_load_dwordx4 v[8:11], v5, s[44:47], s19 offen offset:0 sc1
    ds_read_b128 v[64:67], v2 offset:0
    ds_read_b128 v[68:71], v2 offset:32
    ds_read_b128 v[72:75], v2 offset:64
    ds_read_b128 v[76:79], v2 offset:96
    s_waitcnt lgkmcnt(4)
    v_rsq_f32 v58, v57
    v_mov_b32 v62, 0x358637bd
    v_mul_f32 v60, 0x3fb8aa3b, v58
    v_bfe_u32 v3, v1, 4, 1
    v_lshlrev_b32 v3, 10, v3
    v_lshrrev_b32 v4, 5, v1
    v_lshl_add_u32 v3, v4, 8, v3
    v_and_b32 v4, 15, v1
    v_lshl_add_u32 v3, v4, 4, v3
    s_lshl_b32 s70, s57, 1
    s_lshr_b32 s71, s72, 1
    s_add_u32 s70, s70, s71
    s_mul_i32 s70, s70, 20
    s_sub_u32 s71, s58, 13
    s_mul_i32 s71, s71, 10
    s_add_u32 s70, s70, s71
    s_mul_i32 s71, s73, 5
    s_add_u32 s70, s70, s71
    s_lshl_b32 s70, s70, 12
    s_and_b32 s71, s72, 1
    s_lshl_b32 s71, s71, 11
    s_add_u32 s70, s70, s71
    s_add_u32 s70, s70, 7340032
    ds_read_b128 v[80:83], v2 offset:128
    buffer_load_dwordx4 v[12:15], v5, s[44:47], s19 offen offset:1024 sc1
    ds_read_b128 v[84:87], v2 offset:160
    ds_read_b128 v[88:91], v2 offset:192
    ds_read_b128 v[92:95], v2 offset:224
    s_waitcnt lgkmcnt(4)
    v_pk_fma_f32 v[152:153], v[56:57], v[64:65], v[152:153] op_sel:[0,0,0] op_sel_hi:[0,1,1] neg_lo:[1,0,0] neg_hi:[1,0,0]
    v_pk_fma_f32 v[154:155], v[56:57], v[66:67], v[154:155] op_sel:[0,0,0] op_sel_hi:[0,1,1] neg_lo:[1,0,0] neg_hi:[1,0,0]
    v_pk_fma_f32 v[156:157], v[56:57], v[68:69], v[156:157] op_sel:[0,0,0] op_sel_hi:[0,1,1] neg_lo:[1,0,0] neg_hi:[1,0,0]
    v_pk_fma_f32 v[158:159], v[56:57], v[70:71], v[158:159] op_sel:[0,0,0] op_sel_hi:[0,1,1] neg_lo:[1,0,0] neg_hi:[1,0,0]
    v_pk_fma_f32 v[160:161], v[56:57], v[72:73], v[160:161] op_sel:[0,0,0] op_sel_hi:[0,1,1] neg_lo:[1,0,0] neg_hi:[1,0,0]
    v_pk_fma_f32 v[162:163], v[56:57], v[74:75], v[162:163] op_sel:[0,0,0] op_sel_hi:[0,1,1] neg_lo:[1,0,0] neg_hi:[1,0,0]
    v_pk_fma_f32 v[164:165], v[56:57], v[76:77], v[164:165] op_sel:[0,0,0] op_sel_hi:[0,1,1] neg_lo:[1,0,0] neg_hi:[1,0,0]
    v_pk_fma_f32 v[166:167], v[56:57], v[78:79], v[166:167] op_sel:[0,0,0] op_sel_hi:[0,1,1] neg_lo:[1,0,0] neg_hi:[1,0,0]
    v_pk_mul_f32 v[96:97], v[152:153], v[60:61] op_sel:[0,0] op_sel_hi:[1,0]
    v_pk_mul_f32 v[98:99], v[154:155], v[60:61] op_sel:[0,0] op_sel_hi:[1,0]
    v_pk_mul_f32 v[100:101], v[156:157], v[60:61] op_sel:[0,0] op_sel_hi:[1,0]
    v_pk_mul_f32 v[102:103], v[158:159], v[60:61] op_sel:[0,0] op_sel_hi:[1,0]
    v_pk_mul_f32 v[104:105], v[160:161], v[60:61] op_sel:[0,0] op_sel_hi:[1,0]
    v_pk_mul_f32 v[106:107], v[162:163], v[60:61] op_sel:[0,0] op_sel_hi:[1,0]
    v_pk_mul_f32 v[108:109], v[164:165], v[60:61] op_sel:[0,0] op_sel_hi:[1,0]
    v_pk_mul_f32 v[110:111], v[166:167], v[60:61] op_sel:[0,0] op_sel_hi:[1,0]
    v_exp_f32 v96, v96 clamp
    v_exp_f32 v97, v97 clamp
    v_pk_fma_f32 v[152:153], v[152:153], v[58:59], v[62:63] op_sel:[0,0,0] op_sel_hi:[1,0,0]
    v_exp_f32 v98, v98 clamp
    v_exp_f32 v99, v99 clamp
    v_pk_fma_f32 v[154:155], v[154:155], v[58:59], v[62:63] op_sel:[0,0,0] op_sel_hi:[1,0,0]
    v_exp_f32 v100, v100 clamp
    v_exp_f32 v101, v101 clamp
    v_pk_fma_f32 v[156:157], v[156:157], v[58:59], v[62:63] op_sel:[0,0,0] op_sel_hi:[1,0,0]
    v_exp_f32 v102, v102 clamp
    buffer_load_dwordx4 v[16:19], v5, s[44:47], s19 offen offset:2048 sc1
    v_exp_f32 v103, v103 clamp
    v_pk_fma_f32 v[158:159], v[158:159], v[58:59], v[62:63] op_sel:[0,0,0] op_sel_hi:[1,0,0]
    v_exp_f32 v104, v104 clamp
    v_exp_f32 v105, v105 clamp
    v_pk_fma_f32 v[160:161], v[160:161], v[58:59], v[62:63] op_sel:[0,0,0] op_sel_hi:[1,0,0]
    v_exp_f32 v106, v106 clamp
    v_exp_f32 v107, v107 clamp
    v_pk_fma_f32 v[162:163], v[162:163], v[58:59], v[62:63] op_sel:[0,0,0] op_sel_hi:[1,0,0]
    v_exp_f32 v108, v108 clamp
    v_exp_f32 v109, v109 clamp
    v_pk_fma_f32 v[164:165], v[164:165], v[58:59], v[62:63] op_sel:[0,0,0] op_sel_hi:[1,0,0]
    v_exp_f32 v110, v110 clamp
    v_exp_f32 v111, v111 clamp
    v_pk_fma_f32 v[166:167], v[166:167], v[58:59], v[62:63] op_sel:[0,0,0] op_sel_hi:[1,0,0]
    v_max_f32 v152, v152, v62
    v_max_f32 v153, v153, v62
    v_max_f32 v154, v154, v62
    v_max_f32 v155, v155, v62
    v_max_f32 v156, v156, v62
    v_max_f32 v157, v157, v62
    v_max_f32 v158, v158, v62
    v_max_f32 v159, v159, v62
    v_max_f32 v160, v160, v62
    v_max_f32 v161, v161, v62
    v_max_f32 v162, v162, v62
    v_max_f32 v163, v163, v62
    v_max_f32 v164, v164, v62
    v_max_f32 v165, v165, v62
    v_max_f32 v166, v166, v62
    buffer_load_dwordx4 v[20:23], v5, s[44:47], s19 offen offset:3072 sc1
    v_max_f32 v167, v167, v62
    v_pk_add_f32 v[152:153], v[152:153], v[96:97] op_sel:[0,0] op_sel_hi:[1,1]
    v_pk_add_f32 v[154:155], v[154:155], v[98:99] op_sel:[0,0] op_sel_hi:[1,1]
    v_pk_add_f32 v[156:157], v[156:157], v[100:101] op_sel:[0,0] op_sel_hi:[1,1]
    v_pk_add_f32 v[158:159], v[158:159], v[102:103] op_sel:[0,0] op_sel_hi:[1,1]
    v_pk_add_f32 v[160:161], v[160:161], v[104:105] op_sel:[0,0] op_sel_hi:[1,1]
    v_pk_add_f32 v[162:163], v[162:163], v[106:107] op_sel:[0,0] op_sel_hi:[1,1]
    v_pk_add_f32 v[164:165], v[164:165], v[108:109] op_sel:[0,0] op_sel_hi:[1,1]
    v_pk_add_f32 v[166:167], v[166:167], v[110:111] op_sel:[0,0] op_sel_hi:[1,1]
    v_cvt_pk_bf16_f32 v112, v152, v153
    v_cvt_pk_bf16_f32 v113, v154, v155
    v_cvt_pk_bf16_f32 v114, v156, v157
    v_cvt_pk_bf16_f32 v115, v158, v159
    v_cvt_pk_bf16_f32 v116, v160, v161
    v_cvt_pk_bf16_f32 v117, v162, v163
    v_cvt_pk_bf16_f32 v118, v164, v165
    v_cvt_pk_bf16_f32 v119, v166, v167
    buffer_store_dwordx4 v[112:115], v3, s[44:47], s70 offen sc1
    buffer_store_dwordx4 v[116:119], v3, s[44:47], s70 offen offset:512 sc1
    s_add_u32 s70, s70, 4096
    ds_read_b128 v[64:67], v2 offset:256
    ds_read_b128 v[68:71], v2 offset:288
    ds_read_b128 v[72:75], v2 offset:320
    ds_read_b128 v[76:79], v2 offset:352
    s_waitcnt lgkmcnt(4)
    v_pk_fma_f32 v[168:169], v[56:57], v[80:81], v[168:169] op_sel:[0,0,0] op_sel_hi:[0,1,1] neg_lo:[1,0,0] neg_hi:[1,0,0]
    v_pk_fma_f32 v[170:171], v[56:57], v[82:83], v[170:171] op_sel:[0,0,0] op_sel_hi:[0,1,1] neg_lo:[1,0,0] neg_hi:[1,0,0]
    v_pk_fma_f32 v[172:173], v[56:57], v[84:85], v[172:173] op_sel:[0,0,0] op_sel_hi:[0,1,1] neg_lo:[1,0,0] neg_hi:[1,0,0]
    v_pk_fma_f32 v[174:175], v[56:57], v[86:87], v[174:175] op_sel:[0,0,0] op_sel_hi:[0,1,1] neg_lo:[1,0,0] neg_hi:[1,0,0]
    v_pk_fma_f32 v[176:177], v[56:57], v[88:89], v[176:177] op_sel:[0,0,0] op_sel_hi:[0,1,1] neg_lo:[1,0,0] neg_hi:[1,0,0]
    s_add_u32 s3, s19, 4096
    buffer_load_dwordx4 v[24:27], v5, s[44:47], s3 offen sc1
    s_add_u32 s19, s19, 5120
    s_cmp_eq_u32 s19, s25
    s_cselect_b32 s19, s24, s19
    v_pk_fma_f32 v[178:179], v[56:57], v[90:91], v[178:179] op_sel:[0,0,0] op_sel_hi:[0,1,1] neg_lo:[1,0,0] neg_hi:[1,0,0]
    v_pk_fma_f32 v[180:181], v[56:57], v[92:93], v[180:181] op_sel:[0,0,0] op_sel_hi:[0,1,1] neg_lo:[1,0,0] neg_hi:[1,0,0]
    v_pk_fma_f32 v[182:183], v[56:57], v[94:95], v[182:183] op_sel:[0,0,0] op_sel_hi:[0,1,1] neg_lo:[1,0,0] neg_hi:[1,0,0]
    v_pk_mul_f32 v[96:97], v[168:169], v[60:61] op_sel:[0,0] op_sel_hi:[1,0]
    v_pk_mul_f32 v[98:99], v[170:171], v[60:61] op_sel:[0,0] op_sel_hi:[1,0]
    v_pk_mul_f32 v[100:101], v[172:173], v[60:61] op_sel:[0,0] op_sel_hi:[1,0]
    v_pk_mul_f32 v[102:103], v[174:175], v[60:61] op_sel:[0,0] op_sel_hi:[1,0]
    v_pk_mul_f32 v[104:105], v[176:177], v[60:61] op_sel:[0,0] op_sel_hi:[1,0]
    v_pk_mul_f32 v[106:107], v[178:179], v[60:61] op_sel:[0,0] op_sel_hi:[1,0]
    v_pk_mul_f32 v[108:109], v[180:181], v[60:61] op_sel:[0,0] op_sel_hi:[1,0]
    v_pk_mul_f32 v[110:111], v[182:183], v[60:61] op_sel:[0,0] op_sel_hi:[1,0]
    v_exp_f32 v96, v96 clamp
    v_exp_f32 v97, v97 clamp
    v_pk_fma_f32 v[168:169], v[168:169], v[58:59], v[62:63] op_sel:[0,0,0] op_sel_hi:[1,0,0]
    v_exp_f32 v98, v98 clamp
    v_exp_f32 v99, v99 clamp
    v_pk_fma_f32 v[170:171], v[170:171], v[58:59], v[62:63] op_sel:[0,0,0] op_sel_hi:[1,0,0]
    v_exp_f32 v100, v100 clamp
    v_exp_f32 v101, v101 clamp
    v_pk_fma_f32 v[172:173], v[172:173], v[58:59], v[62:63] op_sel:[0,0,0] op_sel_hi:[1,0,0]
    v_exp_f32 v102, v102 clamp
    v_exp_f32 v103, v103 clamp
    v_pk_fma_f32 v[174:175], v[174:175], v[58:59], v[62:63] op_sel:[0,0,0] op_sel_hi:[1,0,0]
    v_exp_f32 v104, v104 clamp
    v_exp_f32 v105, v105 clamp
    v_pk_fma_f32 v[176:177], v[176:177], v[58:59], v[62:63] op_sel:[0,0,0] op_sel_hi:[1,0,0]
    v_exp_f32 v106, v106 clamp
    v_exp_f32 v107, v107 clamp
    v_pk_fma_f32 v[178:179], v[178:179], v[58:59], v[62:63] op_sel:[0,0,0] op_sel_hi:[1,0,0]
    buffer_load_dwordx4 v[28:31], v5, s[44:47], s19 offen offset:0 sc1
    v_exp_f32 v108, v108 clamp
    v_exp_f32 v109, v109 clamp
    v_pk_fma_f32 v[180:181], v[180:181], v[58:59], v[62:63] op_sel:[0,0,0] op_sel_hi:[1,0,0]
    v_exp_f32 v110, v110 clamp
    v_exp_f32 v111, v111 clamp
    v_pk_fma_f32 v[182:183], v[182:183], v[58:59], v[62:63] op_sel:[0,0,0] op_sel_hi:[1,0,0]
    v_max_f32 v168, v168, v62
    v_max_f32 v169, v169, v62
    v_max_f32 v170, v170, v62
    v_max_f32 v171, v171, v62
    v_max_f32 v172, v172, v62
    v_max_f32 v173, v173, v62
    v_max_f32 v174, v174, v62
    v_max_f32 v175, v175, v62
    v_max_f32 v176, v176, v62
    v_max_f32 v177, v177, v62
    v_max_f32 v178, v178, v62
    v_max_f32 v179, v179, v62
    v_max_f32 v180, v180, v62
    v_max_f32 v181, v181, v62
    v_max_f32 v182, v182, v62
    v_max_f32 v183, v183, v62
    v_pk_add_f32 v[168:169], v[168:169], v[96:97] op_sel:[0,0] op_sel_hi:[1,1]
    v_pk_add_f32 v[170:171], v[170:171], v[98:99] op_sel:[0,0] op_sel_hi:[1,1]
    v_pk_add_f32 v[172:173], v[172:173], v[100:101] op_sel:[0,0] op_sel_hi:[1,1]
    v_pk_add_f32 v[174:175], v[174:175], v[102:103] op_sel:[0,0] op_sel_hi:[1,1]
    v_pk_add_f32 v[176:177], v[176:177], v[104:105] op_sel:[0,0] op_sel_hi:[1,1]
    v_pk_add_f32 v[178:179], v[178:179], v[106:107] op_sel:[0,0] op_sel_hi:[1,1]
    v_pk_add_f32 v[180:181], v[180:181], v[108:109] op_sel:[0,0] op_sel_hi:[1,1]
    v_pk_add_f32 v[182:183], v[182:183], v[110:111] op_sel:[0,0] op_sel_hi:[1,1]
    buffer_load_dwordx4 v[32:35], v5, s[44:47], s19 offen offset:1024 sc1
    v_cvt_pk_bf16_f32 v120, v168, v169
    v_cvt_pk_bf16_f32 v121, v170, v171
    v_cvt_pk_bf16_f32 v122, v172, v173
    v_cvt_pk_bf16_f32 v123, v174, v175
    v_cvt_pk_bf16_f32 v124, v176, v177
    v_cvt_pk_bf16_f32 v125, v178, v179
    v_cvt_pk_bf16_f32 v126, v180, v181
    v_cvt_pk_bf16_f32 v127, v182, v183
    buffer_store_dwordx4 v[120:123], v3, s[44:47], s70 offen sc1
    buffer_store_dwordx4 v[124:127], v3, s[44:47], s70 offen offset:512 sc1
    s_add_u32 s70, s70, 4096
    ds_read_b128 v[80:83], v2 offset:384
    ds_read_b128 v[84:87], v2 offset:416
    ds_read_b128 v[88:91], v2 offset:448
    ds_read_b128 v[92:95], v2 offset:480
    s_waitcnt lgkmcnt(4)
    v_pk_fma_f32 v[184:185], v[56:57], v[64:65], v[184:185] op_sel:[0,0,0] op_sel_hi:[0,1,1] neg_lo:[1,0,0] neg_hi:[1,0,0]
    v_pk_fma_f32 v[186:187], v[56:57], v[66:67], v[186:187] op_sel:[0,0,0] op_sel_hi:[0,1,1] neg_lo:[1,0,0] neg_hi:[1,0,0]
    v_pk_fma_f32 v[188:189], v[56:57], v[68:69], v[188:189] op_sel:[0,0,0] op_sel_hi:[0,1,1] neg_lo:[1,0,0] neg_hi:[1,0,0]
    v_pk_fma_f32 v[190:191], v[56:57], v[70:71], v[190:191] op_sel:[0,0,0] op_sel_hi:[0,1,1] neg_lo:[1,0,0] neg_hi:[1,0,0]
    v_pk_fma_f32 v[192:193], v[56:57], v[72:73], v[192:193] op_sel:[0,0,0] op_sel_hi:[0,1,1] neg_lo:[1,0,0] neg_hi:[1,0,0]
    v_pk_fma_f32 v[194:195], v[56:57], v[74:75], v[194:195] op_sel:[0,0,0] op_sel_hi:[0,1,1] neg_lo:[1,0,0] neg_hi:[1,0,0]
    v_pk_fma_f32 v[196:197], v[56:57], v[76:77], v[196:197] op_sel:[0,0,0] op_sel_hi:[0,1,1] neg_lo:[1,0,0] neg_hi:[1,0,0]
    v_pk_fma_f32 v[198:199], v[56:57], v[78:79], v[198:199] op_sel:[0,0,0] op_sel_hi:[0,1,1] neg_lo:[1,0,0] neg_hi:[1,0,0]
    v_pk_mul_f32 v[96:97], v[184:185], v[60:61] op_sel:[0,0] op_sel_hi:[1,0]
    v_pk_mul_f32 v[98:99], v[186:187], v[60:61] op_sel:[0,0] op_sel_hi:[1,0]
    v_pk_mul_f32 v[100:101], v[188:189], v[60:61] op_sel:[0,0] op_sel_hi:[1,0]
    v_pk_mul_f32 v[102:103], v[190:191], v[60:61] op_sel:[0,0] op_sel_hi:[1,0]
    v_pk_mul_f32 v[104:105], v[192:193], v[60:61] op_sel:[0,0] op_sel_hi:[1,0]
    buffer_load_dwordx4 v[36:39], v5, s[44:47], s19 offen offset:2048 sc1
    v_pk_mul_f32 v[106:107], v[194:195], v[60:61] op_sel:[0,0] op_sel_hi:[1,0]
    v_pk_mul_f32 v[108:109], v[196:197], v[60:61] op_sel:[0,0] op_sel_hi:[1,0]
    v_pk_mul_f32 v[110:111], v[198:199], v[60:61] op_sel:[0,0] op_sel_hi:[1,0]
    v_exp_f32 v96, v96 clamp
    v_exp_f32 v97, v97 clamp
    v_pk_fma_f32 v[184:185], v[184:185], v[58:59], v[62:63] op_sel:[0,0,0] op_sel_hi:[1,0,0]
    v_exp_f32 v98, v98 clamp
    v_exp_f32 v99, v99 clamp
    v_pk_fma_f32 v[186:187], v[186:187], v[58:59], v[62:63] op_sel:[0,0,0] op_sel_hi:[1,0,0]
    v_exp_f32 v100, v100 clamp
    v_exp_f32 v101, v101 clamp
    v_pk_fma_f32 v[188:189], v[188:189], v[58:59], v[62:63] op_sel:[0,0,0] op_sel_hi:[1,0,0]
    v_exp_f32 v102, v102 clamp
    v_exp_f32 v103, v103 clamp
    v_pk_fma_f32 v[190:191], v[190:191], v[58:59], v[62:63] op_sel:[0,0,0] op_sel_hi:[1,0,0]
    v_exp_f32 v104, v104 clamp
    v_exp_f32 v105, v105 clamp
    v_pk_fma_f32 v[192:193], v[192:193], v[58:59], v[62:63] op_sel:[0,0,0] op_sel_hi:[1,0,0]
    v_exp_f32 v106, v106 clamp
    v_exp_f32 v107, v107 clamp
    v_pk_fma_f32 v[194:195], v[194:195], v[58:59], v[62:63] op_sel:[0,0,0] op_sel_hi:[1,0,0]
    v_exp_f32 v108, v108 clamp
    v_exp_f32 v109, v109 clamp
    v_pk_fma_f32 v[196:197], v[196:197], v[58:59], v[62:63] op_sel:[0,0,0] op_sel_hi:[1,0,0]
    v_exp_f32 v110, v110 clamp
    v_exp_f32 v111, v111 clamp
    v_pk_fma_f32 v[198:199], v[198:199], v[58:59], v[62:63] op_sel:[0,0,0] op_sel_hi:[1,0,0]
    v_max_f32 v184, v184, v62
    v_max_f32 v185, v185, v62
    v_max_f32 v186, v186, v62
    buffer_load_dwordx4 v[40:43], v5, s[44:47], s19 offen offset:3072 sc1
    v_max_f32 v187, v187, v62
    v_max_f32 v188, v188, v62
    v_max_f32 v189, v189, v62
    v_max_f32 v190, v190, v62
    v_max_f32 v191, v191, v62
    v_max_f32 v192, v192, v62
    v_max_f32 v193, v193, v62
    v_max_f32 v194, v194, v62
    v_max_f32 v195, v195, v62
    v_max_f32 v196, v196, v62
    v_max_f32 v197, v197, v62
    v_max_f32 v198, v198, v62
    v_max_f32 v199, v199, v62
    v_pk_add_f32 v[184:185], v[184:185], v[96:97] op_sel:[0,0] op_sel_hi:[1,1]
    v_pk_add_f32 v[186:187], v[186:187], v[98:99] op_sel:[0,0] op_sel_hi:[1,1]
    v_pk_add_f32 v[188:189], v[188:189], v[100:101] op_sel:[0,0] op_sel_hi:[1,1]
    v_pk_add_f32 v[190:191], v[190:191], v[102:103] op_sel:[0,0] op_sel_hi:[1,1]
    v_pk_add_f32 v[192:193], v[192:193], v[104:105] op_sel:[0,0] op_sel_hi:[1,1]
    v_pk_add_f32 v[194:195], v[194:195], v[106:107] op_sel:[0,0] op_sel_hi:[1,1]
    v_pk_add_f32 v[196:197], v[196:197], v[108:109] op_sel:[0,0] op_sel_hi:[1,1]
    v_pk_add_f32 v[198:199], v[198:199], v[110:111] op_sel:[0,0] op_sel_hi:[1,1]
    v_cvt_pk_bf16_f32 v112, v184, v185
    v_cvt_pk_bf16_f32 v113, v186, v187
    v_cvt_pk_bf16_f32 v114, v188, v189
    v_cvt_pk_bf16_f32 v115, v190, v191
    v_cvt_pk_bf16_f32 v116, v192, v193
    v_cvt_pk_bf16_f32 v117, v194, v195
    v_cvt_pk_bf16_f32 v118, v196, v197
    v_cvt_pk_bf16_f32 v119, v198, v199
    s_add_u32 s3, s19, 4096
    buffer_load_dwordx4 v[44:47], v5, s[44:47], s3 offen sc1
    s_add_u32 s19, s19, 5120
    s_cmp_eq_u32 s19, s25
    s_cselect_b32 s19, s24, s19
    buffer_store_dwordx4 v[112:115], v3, s[44:47], s70 offen sc1
    buffer_store_dwordx4 v[116:119], v3, s[44:47], s70 offen offset:512 sc1
    s_add_u32 s70, s70, 4096
    ds_read_b128 v[64:67], v2 offset:512
    ds_read_b128 v[68:71], v2 offset:544
    ds_read_b128 v[72:75], v2 offset:576
    ds_read_b128 v[76:79], v2 offset:608
    s_waitcnt lgkmcnt(4)
    v_pk_fma_f32 v[200:201], v[56:57], v[80:81], v[200:201] op_sel:[0,0,0] op_sel_hi:[0,1,1] neg_lo:[1,0,0] neg_hi:[1,0,0]
    v_pk_fma_f32 v[202:203], v[56:57], v[82:83], v[202:203] op_sel:[0,0,0] op_sel_hi:[0,1,1] neg_lo:[1,0,0] neg_hi:[1,0,0]
    v_pk_fma_f32 v[204:205], v[56:57], v[84:85], v[204:205] op_sel:[0,0,0] op_sel_hi:[0,1,1] neg_lo:[1,0,0] neg_hi:[1,0,0]
    v_pk_fma_f32 v[206:207], v[56:57], v[86:87], v[206:207] op_sel:[0,0,0] op_sel_hi:[0,1,1] neg_lo:[1,0,0] neg_hi:[1,0,0]
    v_pk_fma_f32 v[208:209], v[56:57], v[88:89], v[208:209] op_sel:[0,0,0] op_sel_hi:[0,1,1] neg_lo:[1,0,0] neg_hi:[1,0,0]
    v_pk_fma_f32 v[210:211], v[56:57], v[90:91], v[210:211] op_sel:[0,0,0] op_sel_hi:[0,1,1] neg_lo:[1,0,0] neg_hi:[1,0,0]
    v_pk_fma_f32 v[212:213], v[56:57], v[92:93], v[212:213] op_sel:[0,0,0] op_sel_hi:[0,1,1] neg_lo:[1,0,0] neg_hi:[1,0,0]
    v_pk_fma_f32 v[214:215], v[56:57], v[94:95], v[214:215] op_sel:[0,0,0] op_sel_hi:[0,1,1] neg_lo:[1,0,0] neg_hi:[1,0,0]
    v_pk_mul_f32 v[96:97], v[200:201], v[60:61] op_sel:[0,0] op_sel_hi:[1,0]
    v_pk_mul_f32 v[98:99], v[202:203], v[60:61] op_sel:[0,0] op_sel_hi:[1,0]
    v_pk_mul_f32 v[100:101], v[204:205], v[60:61] op_sel:[0,0] op_sel_hi:[1,0]
    v_pk_mul_f32 v[102:103], v[206:207], v[60:61] op_sel:[0,0] op_sel_hi:[1,0]
    v_pk_mul_f32 v[104:105], v[208:209], v[60:61] op_sel:[0,0] op_sel_hi:[1,0]
    v_pk_mul_f32 v[106:107], v[210:211], v[60:61] op_sel:[0,0] op_sel_hi:[1,0]
    v_pk_mul_f32 v[108:109], v[212:213], v[60:61] op_sel:[0,0] op_sel_hi:[1,0]
    v_pk_mul_f32 v[110:111], v[214:215], v[60:61] op_sel:[0,0] op_sel_hi:[1,0]
    v_exp_f32 v96, v96 clamp
    v_exp_f32 v97, v97 clamp
    v_pk_fma_f32 v[200:201], v[200:201], v[58:59], v[62:63] op_sel:[0,0,0] op_sel_hi:[1,0,0]
    v_exp_f32 v98, v98 clamp
    v_exp_f32 v99, v99 clamp
    v_pk_fma_f32 v[202:203], v[202:203], v[58:59], v[62:63] op_sel:[0,0,0] op_sel_hi:[1,0,0]
    v_exp_f32 v100, v100 clamp
    v_exp_f32 v101, v101 clamp
    v_pk_fma_f32 v[204:205], v[204:205], v[58:59], v[62:63] op_sel:[0,0,0] op_sel_hi:[1,0,0]
    v_exp_f32 v102, v102 clamp
    v_exp_f32 v103, v103 clamp
    v_pk_fma_f32 v[206:207], v[206:207], v[58:59], v[62:63] op_sel:[0,0,0] op_sel_hi:[1,0,0]
    v_exp_f32 v104, v104 clamp
    v_exp_f32 v105, v105 clamp
    v_pk_fma_f32 v[208:209], v[208:209], v[58:59], v[62:63] op_sel:[0,0,0] op_sel_hi:[1,0,0]
    v_exp_f32 v106, v106 clamp
    v_exp_f32 v107, v107 clamp
    v_pk_fma_f32 v[210:211], v[210:211], v[58:59], v[62:63] op_sel:[0,0,0] op_sel_hi:[1,0,0]
    v_exp_f32 v108, v108 clamp
    v_exp_f32 v109, v109 clamp
    v_pk_fma_f32 v[212:213], v[212:213], v[58:59], v[62:63] op_sel:[0,0,0] op_sel_hi:[1,0,0]
    v_exp_f32 v110, v110 clamp
    v_exp_f32 v111, v111 clamp
    v_pk_fma_f32 v[214:215], v[214:215], v[58:59], v[62:63] op_sel:[0,0,0] op_sel_hi:[1,0,0]
    v_max_f32 v200, v200, v62
    v_max_f32 v201, v201, v62
    v_max_f32 v202, v202, v62
    v_max_f32 v203, v203, v62
    v_max_f32 v204, v204, v62
    v_max_f32 v205, v205, v62
    v_max_f32 v206, v206, v62
    v_max_f32 v207, v207, v62
    v_max_f32 v208, v208, v62
    v_max_f32 v209, v209, v62
    v_max_f32 v210, v210, v62
    v_max_f32 v211, v211, v62
    v_max_f32 v212, v212, v62
    v_max_f32 v213, v213, v62
    v_max_f32 v214, v214, v62
    v_max_f32 v215, v215, v62
    v_pk_add_f32 v[200:201], v[200:201], v[96:97] op_sel:[0,0] op_sel_hi:[1,1]
    v_pk_add_f32 v[202:203], v[202:203], v[98:99] op_sel:[0,0] op_sel_hi:[1,1]
    v_pk_add_f32 v[204:205], v[204:205], v[100:101] op_sel:[0,0] op_sel_hi:[1,1]
    v_pk_add_f32 v[206:207], v[206:207], v[102:103] op_sel:[0,0] op_sel_hi:[1,1]
    v_pk_add_f32 v[208:209], v[208:209], v[104:105] op_sel:[0,0] op_sel_hi:[1,1]
    v_pk_add_f32 v[210:211], v[210:211], v[106:107] op_sel:[0,0] op_sel_hi:[1,1]
    v_pk_add_f32 v[212:213], v[212:213], v[108:109] op_sel:[0,0] op_sel_hi:[1,1]
    v_pk_add_f32 v[214:215], v[214:215], v[110:111] op_sel:[0,0] op_sel_hi:[1,1]
    v_cvt_pk_bf16_f32 v120, v200, v201
    v_cvt_pk_bf16_f32 v121, v202, v203
    v_cvt_pk_bf16_f32 v122, v204, v205
    v_cvt_pk_bf16_f32 v123, v206, v207
    v_cvt_pk_bf16_f32 v124, v208, v209
    v_cvt_pk_bf16_f32 v125, v210, v211
    v_cvt_pk_bf16_f32 v126, v212, v213
    v_cvt_pk_bf16_f32 v127, v214, v215
    buffer_store_dwordx4 v[120:123], v3, s[44:47], s70 offen sc1
    buffer_store_dwordx4 v[124:127], v3, s[44:47], s70 offen offset:512 sc1
    s_add_u32 s70, s70, 4096
    s_waitcnt lgkmcnt(0)
    v_pk_fma_f32 v[216:217], v[56:57], v[64:65], v[216:217] op_sel:[0,0,0] op_sel_hi:[0,1,1] neg_lo:[1,0,0] neg_hi:[1,0,0]
    v_pk_fma_f32 v[218:219], v[56:57], v[66:67], v[218:219] op_sel:[0,0,0] op_sel_hi:[0,1,1] neg_lo:[1,0,0] neg_hi:[1,0,0]
    v_pk_fma_f32 v[220:221], v[56:57], v[68:69], v[220:221] op_sel:[0,0,0] op_sel_hi:[0,1,1] neg_lo:[1,0,0] neg_hi:[1,0,0]
    v_pk_fma_f32 v[222:223], v[56:57], v[70:71], v[222:223] op_sel:[0,0,0] op_sel_hi:[0,1,1] neg_lo:[1,0,0] neg_hi:[1,0,0]
    v_pk_fma_f32 v[224:225], v[56:57], v[72:73], v[224:225] op_sel:[0,0,0] op_sel_hi:[0,1,1] neg_lo:[1,0,0] neg_hi:[1,0,0]
    v_pk_fma_f32 v[226:227], v[56:57], v[74:75], v[226:227] op_sel:[0,0,0] op_sel_hi:[0,1,1] neg_lo:[1,0,0] neg_hi:[1,0,0]
    v_pk_fma_f32 v[228:229], v[56:57], v[76:77], v[228:229] op_sel:[0,0,0] op_sel_hi:[0,1,1] neg_lo:[1,0,0] neg_hi:[1,0,0]
    v_pk_fma_f32 v[230:231], v[56:57], v[78:79], v[230:231] op_sel:[0,0,0] op_sel_hi:[0,1,1] neg_lo:[1,0,0] neg_hi:[1,0,0]
    v_pk_mul_f32 v[96:97], v[216:217], v[60:61] op_sel:[0,0] op_sel_hi:[1,0]
    v_pk_mul_f32 v[98:99], v[218:219], v[60:61] op_sel:[0,0] op_sel_hi:[1,0]
    v_pk_mul_f32 v[100:101], v[220:221], v[60:61] op_sel:[0,0] op_sel_hi:[1,0]
    v_pk_mul_f32 v[102:103], v[222:223], v[60:61] op_sel:[0,0] op_sel_hi:[1,0]
    v_pk_mul_f32 v[104:105], v[224:225], v[60:61] op_sel:[0,0] op_sel_hi:[1,0]
    v_pk_mul_f32 v[106:107], v[226:227], v[60:61] op_sel:[0,0] op_sel_hi:[1,0]
    v_pk_mul_f32 v[108:109], v[228:229], v[60:61] op_sel:[0,0] op_sel_hi:[1,0]
    v_pk_mul_f32 v[110:111], v[230:231], v[60:61] op_sel:[0,0] op_sel_hi:[1,0]
    v_exp_f32 v96, v96 clamp
    v_exp_f32 v97, v97 clamp
    v_pk_fma_f32 v[216:217], v[216:217], v[58:59], v[62:63] op_sel:[0,0,0] op_sel_hi:[1,0,0]
    v_exp_f32 v98, v98 clamp
    v_exp_f32 v99, v99 clamp
    v_pk_fma_f32 v[218:219], v[218:219], v[58:59], v[62:63] op_sel:[0,0,0] op_sel_hi:[1,0,0]
    v_exp_f32 v100, v100 clamp
    v_exp_f32 v101, v101 clamp
    v_pk_fma_f32 v[220:221], v[220:221], v[58:59], v[62:63] op_sel:[0,0,0] op_sel_hi:[1,0,0]
    v_exp_f32 v102, v102 clamp
    v_exp_f32 v103, v103 clamp
    v_pk_fma_f32 v[222:223], v[222:223], v[58:59], v[62:63] op_sel:[0,0,0] op_sel_hi:[1,0,0]
    v_exp_f32 v104, v104 clamp
    v_exp_f32 v105, v105 clamp
    v_pk_fma_f32 v[224:225], v[224:225], v[58:59], v[62:63] op_sel:[0,0,0] op_sel_hi:[1,0,0]
    v_exp_f32 v106, v106 clamp
    v_exp_f32 v107, v107 clamp
    v_pk_fma_f32 v[226:227], v[226:227], v[58:59], v[62:63] op_sel:[0,0,0] op_sel_hi:[1,0,0]
    v_exp_f32 v108, v108 clamp
    v_exp_f32 v109, v109 clamp
    v_pk_fma_f32 v[228:229], v[228:229], v[58:59], v[62:63] op_sel:[0,0,0] op_sel_hi:[1,0,0]
    v_exp_f32 v110, v110 clamp
    v_exp_f32 v111, v111 clamp
    v_pk_fma_f32 v[230:231], v[230:231], v[58:59], v[62:63] op_sel:[0,0,0] op_sel_hi:[1,0,0]
    v_max_f32 v216, v216, v62
    v_max_f32 v217, v217, v62
    v_max_f32 v218, v218, v62
    v_max_f32 v219, v219, v62
    v_max_f32 v220, v220, v62
    v_max_f32 v221, v221, v62
    v_max_f32 v222, v222, v62
    v_max_f32 v223, v223, v62
    v_max_f32 v224, v224, v62
    v_max_f32 v225, v225, v62
    v_max_f32 v226, v226, v62
    v_max_f32 v227, v227, v62
    v_max_f32 v228, v228, v62
    v_max_f32 v229, v229, v62
    v_max_f32 v230, v230, v62
    v_max_f32 v231, v231, v62
    v_pk_add_f32 v[216:217], v[216:217], v[96:97] op_sel:[0,0] op_sel_hi:[1,1]
    v_pk_add_f32 v[218:219], v[218:219], v[98:99] op_sel:[0,0] op_sel_hi:[1,1]
    v_pk_add_f32 v[220:221], v[220:221], v[100:101] op_sel:[0,0] op_sel_hi:[1,1]
    v_pk_add_f32 v[222:223], v[222:223], v[102:103] op_sel:[0,0] op_sel_hi:[1,1]
    v_pk_add_f32 v[224:225], v[224:225], v[104:105] op_sel:[0,0] op_sel_hi:[1,1]
    v_pk_add_f32 v[226:227], v[226:227], v[106:107] op_sel:[0,0] op_sel_hi:[1,1]
    v_pk_add_f32 v[228:229], v[228:229], v[108:109] op_sel:[0,0] op_sel_hi:[1,1]
    v_pk_add_f32 v[230:231], v[230:231], v[110:111] op_sel:[0,0] op_sel_hi:[1,1]
    v_cvt_pk_bf16_f32 v112, v216, v217
    v_cvt_pk_bf16_f32 v113, v218, v219
    v_cvt_pk_bf16_f32 v114, v220, v221
    v_cvt_pk_bf16_f32 v115, v222, v223
    v_cvt_pk_bf16_f32 v116, v224, v225
    v_cvt_pk_bf16_f32 v117, v226, v227
    v_cvt_pk_bf16_f32 v118, v228, v229
    v_cvt_pk_bf16_f32 v119, v230, v231
    buffer_store_dwordx4 v[112:115], v3, s[44:47], s70 offen sc1
    buffer_store_dwordx4 v[116:119], v3, s[44:47], s70 offen offset:512 sc1
    s_add_u32 s70, s70, 4096
    s_mov_b32 s65, 3
    v_mov_b32 v6, 1073741824
    s_lshl_b32 s70, s57, 8
    s_add_u32 s70, s70, 14221312
    v_writelane_b32 v6, s70, 0
    s_lshl_b32 s70, 1, s58
    v_mov_b32 v7, s70
    s_branch L_p2
L_typeK:
    s_lshr_b32 s72, s56, 1
    s_and_b32 s73, s56, 1
    s_mov_b32 s40, s18
    s_and_b32 s41, s19, 0xffff
    s_mov_b32 s42, 2457600
    s_mov_b32 s43, 0x20000
    s_and_b32 s71, s56, 3
    v_lshrrev_b32 v2, 3, v1
    s_lshl_b32 s75, s71, 3
    v_add_u32 v2, s75, v2
    v_mul_u32_u24 v2, 3840, v2
    v_and_b32 v3, 7, v1
    v_lshrrev_b32 v4, 2, v1
    v_and_b32 v4, 4, v4
    v_xor_b32 v3, v3, v4
    s_sub_u32 s4, s58, 9
    s_and_b32 s79, s4, 1
    s_mul_i32 s6, s4, 320
    s_add_u32 s6, s6, 1280
    s_lshl_b32 s7, s79, 6
    s_add_u32 s7, s7, s6
    s_cmp_eq_u32 s79, 0
    s_cselect_b32 s8, 256, 0
    s_add_u32 s8, s8, s6
    v_lshl_add_u32 v4, v3, 4, v2
    v_add_u32 v8, s7, v4
    v_xor_b32 v5, 2, v3
    v_lshl_add_u32 v4, v5, 4, v2
    v_add_u32 v10, s7, v4
    v_lshrrev_b32 v4, 2, v3
    v_lshlrev_b32 v5, 1, v4
    v_xor_b32 v5, v5, v3
    v_and_b32 v5, 3, v5
    v_lshl_add_u32 v5, v5, 4, v2
    v_mul_u32_u24 v4, 1280, v4
    v_add3_u32 v9, v5, v4, s8
    s_lshr_b32 s70, s56, 2
    s_lshl_b32 s71, s71, 10
    s_add_u32 s74, s71, 155648
    s_mul_i32 s64, s70, 24576
    s_add_u32 s64, s64, s71
    s_add_u32 s64, s64, 32768
    s_mul_i32 s60, s76, 245760
    s_mul_i32 s70, s70, 122880
    s_add_u32 s60, s60, s70
    s_mov_b32 s61, 0
    s_cmp_lt_u32 s56, 4
    s_cbranch_scc1 L_K_p1
    s_add_u32 m0, s66, 0
    s_add_u32 s70, s62, 20480
    buffer_load_dwordx4 v6, s[36:39], s62 offen lds
    s_add_u32 m0, s66, 1024
    s_add_u32 s70, s62, 20480
    buffer_load_dwordx4 v7, s[36:39], s62 offen lds
    s_add_u32 m0, s66, 2048
    s_add_u32 s70, s62, 20480
    buffer_load_dwordx4 v6, s[36:39], s70 offen lds
    s_add_u32 m0, s66, 3072
    s_add_u32 s70, s62, 20480
    buffer_load_dwordx4 v7, s[36:39], s70 offen lds
    s_xor_b32 s66, s66, 16384
    s_add_u32 s62, s62, 128
    s_cmp_eq_u32 s62, 1280
    s_cselect_b32 s62, 0, s62
    s_branch L_K_p2
L_K_p1:
    s_add_u32 m0, s64, 0
    s_nop 0
    buffer_load_dwordx4 v8, s[40:43], s60 offen offset:0 lds
    s_add_u32 m0, s64, 3968
    s_nop 0
    buffer_load_dwordx4 v8, s[40:43], s60 offen offset:128 lds
    s_add_u32 m0, s64, 6912
    s_nop 0
    buffer_load_dwordx4 v10, s[40:43], s60 offen offset:1280 lds
    s_add_u32 m0, s64, 10880
    s_nop 0
    buffer_load_dwordx4 v10, s[40:43], s60 offen offset:1408 lds
    s_add_u32 m0, s64, 16384
    s_nop 0
    buffer_load_dwordx4 v9, s[40:43], s60 offen offset:0 lds
    s_add_u32 s64, s64, 49152
    s_cmp_ge_u32 s64, s74
    s_cselect_b32 s70, 122880, 0
    s_sub_u32 s64, s64, s70
    s_add_u32 s60, s60, 245760
    s_cmp_ge_u32 s60, 2457600
    s_cselect_b32 s70, 2457600, 0
    s_sub_u32 s60, s60, s70
L_K_p2:
    v_and_b32 v2, 31, v1
    v_lshrrev_b32 v3, 5, v1
    v_bfe_u32 v4, v1, 1, 3
    v_xor_b32 v3, v3, v4
    s_lshl_b32 s70, s72, 12
    v_lshl_add_u32 v2, v2, 7, s70
    v_xor_b32 v4, 0, v3
    v_lshl_add_u32 v11, v4, 4, v2
    v_xor_b32 v4, 2, v3
    v_lshl_add_u32 v12, v4, 4, v2
    v_xor_b32 v4, 4, v3
    v_lshl_add_u32 v13, v4, 4, v2
    v_xor_b32 v4, 6, v3
    v_lshl_add_u32 v14, v4, 4, v2
    v_lshrrev_b32 v2, 5, v1
    v_lshlrev_b32 v2, 10, v2
    v_bfe_u32 v3, v1, 2, 2
    v_lshl_add_u32 v2, v3, 7, v2
    v_and_b32 v4, 3, v1
    v_lshl_add_u32 v2, v4, 3, v2
    v_and_b32 v3, 2, v3
    v_bfe_u32 v4, v1, 4, 1
    v_xor_b32 v3, v3, v4
    s_lshl_b32 s9, s73, 1
    s_add_u32 s9, s9, s79
    s_lshl_b32 s9, s9, 3
    v_bfe_u32 v4, v1, 4, 1
    v_cmp_eq_u32 vcc, 1, v4
    v_and_b32 v3, 2, v3
    s_lshr_b32 s70, 50663424, s9
    s_and_b32 s70, s70, 0xff
    s_lshr_b32 s71, 67506433, s9
    s_and_b32 s71, s71, 0xff
    v_mov_b32 v4, s70
    v_mov_b32 v5, s71
    v_cndmask_b32 v4, v4, v5, vcc
    v_lshrrev_b32 v5, 2, v4
    v_lshl_add_u32 v5, v5, 12, v2
    v_and_b32 v4, 3, v4
    v_xor_b32 v4, v4, v3
    v_lshl_add_u32 v15, v4, 5, v5
    s_lshr_b32 s70, 84344834, s9
    s_and_b32 s70, s70, 0xff
    s_lshr_b32 s71, 101712131, s9
    s_and_b32 s71, s71, 0xff
    v_mov_b32 v4, s70
    v_mov_b32 v5, s71
    v_cndmask_b32 v4, v4, v5, vcc
    v_lshrrev_b32 v5, 2, v4
    v_lshl_add_u32 v5, v5, 12, v2
    v_and_b32 v4, 3, v4
    v_xor_b32 v4, v4, v3
    v_lshl_add_u32 v16, v4, 5, v5
    s_lshr_b32 s70, 118555140, s9
    s_and_b32 s70, s70, 0xff
    s_lshr_b32 s71, 168563465, s9
    s_and_b32 s71, s71, 0xff
    v_mov_b32 v4, s70
    v_mov_b32 v5, s71
    v_cndmask_b32 v4, v4, v5, vcc
    v_lshrrev_b32 v5, 2, v4
    v_lshl_add_u32 v5, v5, 12, v2
    v_and_b32 v4, 3, v4
    v_xor_b32 v4, v4, v3
    v_lshl_add_u32 v17, v4, 5, v5
    s_lshr_b32 s70, 219091464, s9
    s_and_b32 s70, s70, 0xff
    s_lshr_b32 s71, 202246411, s9
    s_and_b32 s71, s71, 0xff
    v_mov_b32 v4, s70
    v_mov_b32 v5, s71
    v_cndmask_b32 v4, v4, v5, vcc
    v_lshrrev_b32 v5, 2, v4
    v_lshl_add_u32 v5, v5, 12, v2
    v_and_b32 v4, 3, v4
    v_xor_b32 v4, v4, v3
    v_lshl_add_u32 v18, v4, 5, v5
    s_lshr_b32 s70, 252905482, s9
    s_and_b32 s70, s70, 0xff
    s_lshr_b32 s71, 236063501, s9
    s_and_b32 s71, s71, 0xff
    v_mov_b32 v4, s70
    v_mov_b32 v5, s71
    v_cndmask_b32 v4, v4, v5, vcc
    v_lshrrev_b32 v5, 2, v4
    v_lshl_add_u32 v5, v5, 12, v2
    v_and_b32 v4, 3, v4
    v_xor_b32 v4, v4, v3
    v_lshl_add_u32 v19, v4, 5, v5
    s_mul_i32 s75, s72, 14336
    s_cmp_ge_u32 s72, 2
    s_cselect_b32 s70, 106496, 0
    s_add_u32 s75, s75, s70
    s_mul_i32 s70, s73, 6720
    s_add_u32 s75, s75, s70
    v_lshlrev_b32 v5, 4, v1
    v_add_u32 v5, 28688, v5
    v_lshrrev_b32 v4, 5, v1
    v_lshlrev_b32 v4, 2, v4
    v_and_b32 v2, 31, v1
    v_add_u32 v2, 84, v2
    v_mul_u32_u24 v3, 205, v2
    v_lshrrev_b32 v3, 12, v3
    v_mul_u32_u24 v2, 80, v2
    v_add_u32 v2, s75, v2
    v_add_u32 v232, 100, v4
    v_mul_u32_u24 v80, 205, v232
    v_lshrrev_b32 v80, 12, v80
    v_cmp_eq_u32 vcc, v80, v3
    v_lshl_add_u32 v232, v232, 2, v2
    v_subrev_u32 v232, 8400, v232
    v_cndmask_b32 v232, v5, v232, vcc
    v_add_u32 v233, 108, v4
    v_mul_u32_u24 v80, 205, v233
    v_lshrrev_b32 v80, 12, v80
    v_cmp_eq_u32 vcc, v80, v3
    v_lshl_add_u32 v233, v233, 2, v2
    v_subrev_u32 v233, 8400, v233
    v_cndmask_b32 v233, v5, v233, vcc
    v_add_u32 v234, 116, v4
    v_mul_u32_u24 v80, 205, v234
    v_lshrrev_b32 v80, 12, v80
    v_cmp_eq_u32 vcc, v80, v3
    v_lshl_add_u32 v234, v234, 2, v2
    v_subrev_u32 v234, 8400, v234
    v_cndmask_b32 v234, v5, v234, vcc
    v_and_b32 v2, 31, v1
    v_add_u32 v2, 116, v2
    v_mul_u32_u24 v3, 205, v2
    v_lshrrev_b32 v3, 12, v3
    v_mul_u32_u24 v2, 80, v2
    v_add_u32 v2, s75, v2
    v_add_u32 v236, 100, v4
    v_mul_u32_u24 v80, 205, v236
    v_lshrrev_b32 v80, 12, v80
    v_cmp_eq_u32 vcc, v80, v3
    v_lshl_add_u32 v236, v236, 2, v2
    v_subrev_u32 v236, 8400, v236
    v_cndmask_b32 v236, v5, v236, vcc
    v_add_u32 v237, 108, v4
    v_mul_u32_u24 v80, 205, v237
    v_lshrrev_b32 v80, 12, v80
    v_cmp_eq_u32 vcc, v80, v3
    v_lshl_add_u32 v237, v237, 2, v2
    v_subrev_u32 v237, 8400, v237
    v_cndmask_b32 v237, v5, v237, vcc
    v_add_u32 v238, 116, v4
    v_mul_u32_u24 v80, 205, v238
    v_lshrrev_b32 v80, 12, v80
    v_cmp_eq_u32 vcc, v80, v3
    v_lshl_add_u32 v238, v238, 2, v2
    v_subrev_u32 v238, 8400, v238
    v_cndmask_b32 v238, v5, v238, vcc
    v_add_u32 v239, 124, v4
    v_mul_u32_u24 v80, 205, v239
    v_lshrrev_b32 v80, 12, v80
    v_cmp_eq_u32 vcc, v80, v3
    v_lshl_add_u32 v239, v239, 2, v2
    v_subrev_u32 v239, 8400, v239
    v_cndmask_b32 v239, v5, v239, vcc
    v_and_b32 v2, 31, v1
    v_add_u32 v2, 116, v2
    v_mul_u32_u24 v3, 205, v2
    v_lshrrev_b32 v3, 12, v3
    v_mul_u32_u24 v2, 80, v2
    v_add_u32 v2, s75, v2
    v_add_u32 v240, 132, v4
    v_mul_u32_u24 v80, 205, v240
    v_lshrrev_b32 v80, 12, v80
    v_cmp_eq_u32 vcc, v80, v3
    v_lshl_add_u32 v240, v240, 2, v2
    v_subrev_u32 v240, 8400, v240
    v_cndmask_b32 v240, v5, v240, vcc
    v_add_u32 v241, 140, v4
    v_mul_u32_u24 v80, 205, v241
    v_lshrrev_b32 v80, 12, v80
    v_cmp_eq_u32 vcc, v80, v3
    v_lshl_add_u32 v241, v241, 2, v2
    v_subrev_u32 v241, 8400, v241
    v_cndmask_b32 v241, v5, v241, vcc
    v_add_u32 v242, 148, v4
    v_mul_u32_u24 v80, 205, v242
    v_lshrrev_b32 v80, 12, v80
    v_cmp_eq_u32 vcc, v80, v3
    v_lshl_add_u32 v242, v242, 2, v2
    v_subrev_u32 v242, 8400, v242
    v_cndmask_b32 v242, v5, v242, vcc
    v_add_u32 v243, 156, v4
    v_mul_u32_u24 v80, 205, v243
    v_lshrrev_b32 v80, 12, v80
    v_cmp_eq_u32 vcc, v80, v3
    v_lshl_add_u32 v243, v243, 2, v2
    v_subrev_u32 v243, 8400, v243
    v_cndmask_b32 v243, v5, v243, vcc
    v_and_b32 v2, 31, v1
    v_add_u32 v2, 148, v2
    v_mul_u32_u24 v3, 205, v2
    v_lshrrev_b32 v3, 12, v3
    v_mul_u32_u24 v2, 80, v2
    v_add_u32 v2, s75, v2
    v_add_u32 v245, 140, v4
    v_mul_u32_u24 v80, 205, v245
    v_lshrrev_b32 v80, 12, v80
    v_cmp_eq_u32 vcc, v80, v3
    v_lshl_add_u32 v245, v245, 2, v2
    v_subrev_u32 v245, 8400, v245
    v_cndmask_b32 v245, v5, v245, vcc
    v_add_u32 v246, 148, v4
    v_mul_u32_u24 v80, 205, v246
    v_lshrrev_b32 v80, 12, v80
    v_cmp_eq_u32 vcc, v80, v3
    v_lshl_add_u32 v246, v246, 2, v2
    v_subrev_u32 v246, 8400, v246
    v_cndmask_b32 v246, v5, v246, vcc
    v_add_u32 v247, 156, v4
    v_mul_u32_u24 v80, 205, v247
    v_lshrrev_b32 v80, 12, v80
    v_cmp_eq_u32 vcc, v80, v3
    v_lshl_add_u32 v247, v247, 2, v2
    v_subrev_u32 v247, 8400, v247
    v_cndmask_b32 v247, v5, v247, vcc
    v_and_b32 v2, 31, v1
    v_add_u32 v2, 148, v2
    v_mul_u32_u24 v3, 205, v2
    v_lshrrev_b32 v3, 12, v3
    v_mul_u32_u24 v2, 80, v2
    v_add_u32 v2, s75, v2
    v_add_u32 v248, 164, v4
    v_mul_u32_u24 v80, 205, v248
    v_lshrrev_b32 v80, 12, v80
    v_cmp_eq_u32 vcc, v80, v3
    v_lshl_add_u32 v248, v248, 2, v2
    v_subrev_u32 v248, 8400, v248
    v_cndmask_b32 v248, v5, v248, vcc
    v_add_u32 v249, 172, v4
    v_mul_u32_u24 v80, 205, v249
    v_lshrrev_b32 v80, 12, v80
    v_cmp_eq_u32 vcc, v80, v3
    v_lshl_add_u32 v249, v249, 2, v2
    v_subrev_u32 v249, 8400, v249
    v_cndmask_b32 v249, v5, v249, vcc
    v_and_b32 v2, 15, v1
    v_lshrrev_b32 v4, 4, v1
    v_lshlrev_b32 v4, 2, v4
    v_lshl_add_u32 v4, v2, 4, v4
    v_add_u32 v252, 0, v4
    v_mul_u32_u24 v80, 205, v252
    v_lshrrev_b32 v80, 12, v80
    v_mul_u32_u24 v80, 1600, v80
    v_lshl_add_u32 v252, v252, 2, v80
    v_add_u32 v252, s75, v252
    v_add_u32 v252, 1600, v252
    v_cmp_gt_u32 vcc, 2, v2
    s_nop 1
    v_cndmask_b32 v252, v5, v252, vcc
    v_add_u32 v253, 32, v4
    v_mul_u32_u24 v80, 205, v253
    v_lshrrev_b32 v80, 12, v80
    v_mul_u32_u24 v80, 1600, v80
    v_lshl_add_u32 v253, v253, 2, v80
    v_add_u32 v253, s75, v253
    v_add_u32 v253, 1600, v253
    v_cmp_gt_u32 vcc, 2, v2
    s_nop 1
    v_cndmask_b32 v253, v5, v253, vcc
    v_add_u32 v254, 64, v4
    v_mul_u32_u24 v80, 205, v254
    v_lshrrev_b32 v80, 12, v80
    v_mul_u32_u24 v80, 1600, v80
    v_lshl_add_u32 v254, v254, 2, v80
    v_add_u32 v254, s75, v254
    v_add_u32 v254, 1600, v254
    v_cmp_gt_u32 vcc, 1, v2
    s_nop 1
    v_cndmask_b32 v254, v5, v254, vcc
    s_mov_b32 s65, 32768
    v_and_b32 v25, 15, v1
    v_lshlrev_b32 v25, 8, v25
    v_add_u32 v25, 14221440, v25
    v_and_b32 v2, 15, v1
    v_bfe_u32 v3, v1, 4, 1
    v_cmp_eq_u32 vcc, v2, v3
    v_mov_b32 v4, 0x3f803f80
    s_nop 0
    v_cndmask_b32 v52, 0, v4, vcc
    v_mov_b32 v53, v52
    v_mov_b32 v54, v52
    v_mov_b32 v55, v52
    v_mov_b32 v32, 0
    v_mov_b32 v33, 0
    v_mov_b32 v34, 0
    v_mov_b32 v35, 0
    v_mov_b32 v36, 0
    v_mov_b32 v37, 0
    v_mov_b32 v38, 0
    v_mov_b32 v39, 0
    v_mov_b32 v40, 0
    v_mov_b32 v41, 0
    v_mov_b32 v42, 0
    v_mov_b32 v43, 0
    v_mov_b32 v44, 0
    v_mov_b32 v45, 0
    v_mov_b32 v46, 0
    v_mov_b32 v47, 0
    v_mov_b32 v48, 0
    v_mov_b32 v49, 0
    v_mov_b32 v50, 0
    v_mov_b32 v51, 0
    v_mov_b32 v152, 0
    v_mov_b32 v153, 0
    v_mov_b32 v154, 0
    v_mov_b32 v155, 0
    v_mov_b32 v156, 0
    v_mov_b32 v157, 0
    v_mov_b32 v158, 0
    v_mov_b32 v159, 0
    v_mov_b32 v160, 0
    v_mov_b32 v161, 0
    v_mov_b32 v162, 0
    v_mov_b32 v163, 0
    v_mov_b32 v164, 0
    v_mov_b32 v165, 0
    v_mov_b32 v166, 0
    v_mov_b32 v167, 0
    v_mov_b32 v168, 0
    v_mov_b32 v169, 0
    v_mov_b32 v170, 0
    v_mov_b32 v171, 0
    v_mov_b32 v172, 0
    v_mov_b32 v173, 0
    v_mov_b32 v174, 0
    v_mov_b32 v175, 0
    v_mov_b32 v176, 0
    v_mov_b32 v177, 0
    v_mov_b32 v178, 0
    v_mov_b32 v179, 0
    v_mov_b32 v180, 0
    v_mov_b32 v181, 0
    v_mov_b32 v182, 0
    v_mov_b32 v183, 0
    v_mov_b32 v184, 0
    v_mov_b32 v185, 0
    v_mov_b32 v186, 0
    v_mov_b32 v187, 0
    v_mov_b32 v188, 0
    v_mov_b32 v189, 0
    v_mov_b32 v190, 0
    v_mov_b32 v191, 0
    v_mov_b32 v192, 0
    v_mov_b32 v193, 0
    v_mov_b32 v194, 0
    v_mov_b32 v195, 0
    v_mov_b32 v196, 0
    v_mov_b32 v197, 0
    v_mov_b32 v198, 0
    v_mov_b32 v199, 0
    v_mov_b32 v200, 0
    v_mov_b32 v201, 0
    v_mov_b32 v202, 0
    v_mov_b32 v203, 0
    v_mov_b32 v204, 0
    v_mov_b32 v205, 0
    v_mov_b32 v206, 0
    v_mov_b32 v207, 0
    v_mov_b32 v208, 0
    v_mov_b32 v209, 0
    v_mov_b32 v210, 0
    v_mov_b32 v211, 0
    v_mov_b32 v212, 0
    v_mov_b32 v213, 0
    v_mov_b32 v214, 0
    v_mov_b32 v215, 0
    v_mov_b32 v216, 0
    v_mov_b32 v217, 0
    v_mov_b32 v218, 0
    v_mov_b32 v219, 0
    v_mov_b32 v220, 0
    v_mov_b32 v221, 0
    v_mov_b32 v222, 0
    v_mov_b32 v223, 0
    v_mov_b32 v224, 0
    v_mov_b32 v225, 0
    v_mov_b32 v226, 0
    v_mov_b32 v227, 0
    v_mov_b32 v228, 0
    v_mov_b32 v229, 0
    v_mov_b32 v230, 0
    v_mov_b32 v231, 0
    s_mov_b32 s80, 2
    s_bitcmp1_b32 0x88ff, s57
    s_cselect_b32 s68, 0, 99
    s_cmp_eq_u32 s72, 0
    s_cselect_b32 s68, s68, 99
    s_mov_b32 s70, 0xe
    s_cmp_eq_u32 s56, 0
    s_cselect_b32 s69, s70, 0
    s_cmp_eq_u32 s56, 3
    s_cselect_b32 s70, 0xc0, 0
    s_or_b32 s69, s69, s70
    s_or_b32 s69, s69, 0x300
    s_mov_b32 s59, 0
    s_mov_b32 s78, 0
    s_and_b32 s3, s2, 7
    s_lshr_b32 s4, s2, 3
    s_and_b32 s17, s4, 7
    s_lshr_b32 s4, s4, 3
    s_lshl_b32 s3, s3, 2
    s_add_u32 s16, s3, s4
    s_sub_u32 s3, s56, 4
    s_mul_i32 s4, s3, 14
    s_cmp_eq_u32 s3, 3
    s_cselect_b32 s5, 1, 0
    s_sub_u32 s4, s4, s5
    s_cmp_ge_u32 s3, 2
    s_cselect_b32 s5, 13, 14
    s_cselect_b32 s26, 1073741824, 0
    s_and_b32 s6, s16, 3
    s_lshl_b32 s6, s6, 1
    s_add_u32 s6, s6, s17
    s_mul_i32 s6, s6, 7
    s_lshr_b32 s6, s6, 2
    s_sub_u32 s7, s6, s5
    s_cmp_ge_u32 s6, s5
    s_cselect_b32 s6, s7, s6
    s_mul_i32 s22, s16, 54
    s_add_u32 s22, s22, s4
    s_lshl_b32 s22, s22, 12
    s_lshl_b32 s7, s5, 12
    s_add_u32 s23, s22, s7
    s_lshl_b32 s7, s6, 12
    s_add_u32 s18, s22, s7
    s_mul_i32 s24, s17, 74
    s_add_u32 s24, s24, s4
    s_mul_i32 s24, s24, 5120
    s_add_u32 s24, s24, 10485760
    s_mul_i32 s7, s5, 5120
    s_add_u32 s25, s24, s7
    s_mul_i32 s7, s6, 5120
    s_add_u32 s19, s24, s7
    s_cmp_lt_u32 s56, 4
    s_cselect_b32 s19, 1073741824, s19
    s_cmp_ge_u32 s56, 4
    s_cbranch_scc1 L_K_roleB
    s_waitcnt vmcnt(5)
    v_lshlrev_b32 v64, 16, v56
    v_and_b32 v65, 0xffff0000, v56
    v_lshlrev_b32 v66, 16, v57
    v_and_b32 v67, 0xffff0000, v57
    v_lshlrev_b32 v68, 16, v58
    v_and_b32 v69, 0xffff0000, v58
    v_lshlrev_b32 v70, 16, v59
    v_and_b32 v71, 0xffff0000, v59
    v_lshlrev_b32 v72, 16, v60
    v_and_b32 v73, 0xffff0000, v60
    v_add_f32 v76, v64, v65
    v_add_f32 v76, v76, v66
    v_add_f32 v76, v76, v67
    v_add_f32 v76, v76, v68
    v_add_f32 v76, v76, v69
    v_add_f32 v76, v76, v70
    v_add_f32 v76, v76, v71
    v_add_f32 v76, v76, v72
    v_add_f32 v76, v76, v73
    s_nop 1
    v_add_f32_dpp v76, v76, v76 quad_perm:[1,0,3,2] row_mask:0xf bank_mask:0xf
    s_nop 1
    v_add_f32_dpp v76, v76, v76 quad_perm:[2,3,0,1] row_mask:0xf bank_mask:0xf
    s_nop 1
    v_add_f32_dpp v76, v76, v76 row_half_mirror row_mask:0xf bank_mask:0xf
    s_nop 1
    v_add_f32_dpp v76, v76, v76 row_mirror row_mask:0xf bank_mask:0xf
    s_nop 0
    v_readlane_b32 s4, v76, 0
    v_readlane_b32 s5, v76, 16
    v_readlane_b32 s6, v76, 32
    v_readlane_b32 s7, v76, 48
    v_mov_b32 v76, s4
    v_mov_b32 v77, s6
    v_add_f32 v76, s5, v76
    v_add_f32 v77, s7, v77
    v_add_f32 v76, v76, v77
    v_mul_f32 v76, 0x3acccccd, v76
    v_sub_f32 v64, v64, v76
    v_sub_f32 v65, v65, v76
    v_sub_f32 v66, v66, v76
    v_sub_f32 v67, v67, v76
    v_sub_f32 v68, v68, v76
    v_sub_f32 v69, v69, v76
    v_sub_f32 v70, v70, v76
    v_sub_f32 v71, v71, v76
    v_sub_f32 v72, v72, v76
    v_sub_f32 v73, v73, v76
    v_mul_f32 v77, v64, v64
    v_fmac_f32 v77, v65, v65
    v_fmac_f32 v77, v66, v66
    v_fmac_f32 v77, v67, v67
    v_fmac_f32 v77, v68, v68
    v_fmac_f32 v77, v69, v69
    v_fmac_f32 v77, v70, v70
    v_fmac_f32 v77, v71, v71
    v_fmac_f32 v77, v72, v72
    v_fmac_f32 v77, v73, v73
    s_nop 1
    v_add_f32_dpp v77, v77, v77 quad_perm:[1,0,3,2] row_mask:0xf bank_mask:0xf
    s_nop 1
    v_add_f32_dpp v77, v77, v77 quad_perm:[2,3,0,1] row_mask:0xf bank_mask:0xf
    s_nop 1
    v_add_f32_dpp v77, v77, v77 row_half_mirror row_mask:0xf bank_mask:0xf
    s_nop 1
    v_add_f32_dpp v77, v77, v77 row_mirror row_mask:0xf bank_mask:0xf
    s_nop 0
    v_readlane_b32 s4, v77, 0
    v_readlane_b32 s5, v77, 16
    v_readlane_b32 s6, v77, 32
    v_readlane_b32 s7, v77, 48
    v_mov_b32 v77, s4
    v_mov_b32 v78, s6
    v_add_f32 v77, s5, v77
    v_add_f32 v78, s7, v78
    v_add_f32 v77, v77, v78
    v_mov_b32 v78, 0x3727c5ac
    v_fmac_f32 v78, 0x3acccccd, v77
    v_mov_b32 v77, v78
    v_cmp_eq_u32 vcc, 0, v1
    v_mov_b32 v4, 1073741824
    s_nop 0
    v_cndmask_b32 v2, v4, v1, vcc
    s_lshl_b32 s70, s77, 3
    s_add_u32 s70, s70, 13631488
    buffer_store_dwordx2 v[76:77], v2, s[44:47], s70 offen sc1
    s_waitcnt vmcnt(1)
    s_barrier
    v_add_u32 v20, s65, v15
    v_add_u32 v21, s65, v16
    v_add_u32 v22, s65, v17
    v_add_u32 v23, s65, v18
    v_add_u32 v24, s65, v19
    ds_read_b64_tr_b16 v[64:65], v20 offset:0
    ds_read_b64_tr_b16 v[66:67], v20 offset:512
    ds_read_b64_tr_b16 v[72:73], v21 offset:0
    ds_read_b64_tr_b16 v[74:75], v21 offset:512
    ds_read_b64_tr_b16 v[80:81], v22 offset:0
    ds_read_b64_tr_b16 v[82:83], v22 offset:512
    ds_read_b64_tr_b16 v[88:89], v23 offset:0
    ds_read_b64_tr_b16 v[90:91], v23 offset:512
    ds_read_b64_tr_b16 v[96:97], v24 offset:0
    ds_read_b64_tr_b16 v[98:99], v24 offset:512
    ds_read_b128 v[56:59], v11 offset:0
    ds_read_b64_tr_b16 v[68:69], v20 offset:2048
    ds_read_b64_tr_b16 v[70:71], v20 offset:2560
    ds_read_b64_tr_b16 v[76:77], v21 offset:2048
    ds_read_b64_tr_b16 v[78:79], v21 offset:2560
    ds_read_b64_tr_b16 v[84:85], v22 offset:2048
    ds_read_b64_tr_b16 v[86:87], v22 offset:2560
    ds_read_b64_tr_b16 v[92:93], v23 offset:2048
    ds_read_b64_tr_b16 v[94:95], v23 offset:2560
    ds_read_b64_tr_b16 v[100:101], v24 offset:2048
    ds_read_b64_tr_b16 v[102:103], v24 offset:2560
    ds_read_b128 v[60:63], v12 offset:0
    s_add_u32 s65, s65, 24576
    s_cmp_eq_u32 s65, 155648
    s_cselect_b32 s65, 32768, s65
    s_setprio 1
    s_waitcnt lgkmcnt(0)
    v_mfma_f32_32x32x16_bf16 v[152:167], v[56:59], v[64:67], v[152:167]
    v_mfma_f32_32x32x16_bf16 v[168:183], v[56:59], v[72:75], v[168:183]
    v_mfma_f32_32x32x16_bf16 v[184:199], v[56:59], v[80:83], v[184:199]
    v_mfma_f32_32x32x16_bf16 v[200:215], v[56:59], v[88:91], v[200:215]
    v_mfma_f32_32x32x16_bf16 v[216:231], v[56:59], v[96:99], v[216:231]
    v_mfma_f32_32x32x16_bf16 v[152:167], v[60:63], v[68:71], v[152:167]
    v_mfma_f32_32x32x16_bf16 v[168:183], v[60:63], v[76:79], v[168:183]
    v_mfma_f32_32x32x16_bf16 v[184:199], v[60:63], v[84:87], v[184:199]
    v_mfma_f32_32x32x16_bf16 v[200:215], v[60:63], v[92:95], v[200:215]
    v_mfma_f32_32x32x16_bf16 v[216:231], v[60:63], v[100:103], v[216:231]
    s_cmp_lg_u32 s68, 0
    s_cbranch_scc1 L_KA_pc0
    v_mfma_f32_16x16x32_bf16 v[32:35], v[64:67], v[52:55], v[32:35]
    v_mfma_f32_16x16x32_bf16 v[36:39], v[72:75], v[52:55], v[36:39]
    v_mfma_f32_16x16x32_bf16 v[40:43], v[80:83], v[52:55], v[40:43]
    v_mfma_f32_16x16x32_bf16 v[44:47], v[88:91], v[52:55], v[44:47]
    v_mfma_f32_16x16x32_bf16 v[48:51], v[96:99], v[52:55], v[48:51]
    v_mfma_f32_16x16x32_bf16 v[32:35], v[68:71], v[52:55], v[32:35]
    v_mfma_f32_16x16x32_bf16 v[36:39], v[76:79], v[52:55], v[36:39]
    v_mfma_f32_16x16x32_bf16 v[40:43], v[84:87], v[52:55], v[40:43]
    v_mfma_f32_16x16x32_bf16 v[44:47], v[92:95], v[52:55], v[44:47]
    v_mfma_f32_16x16x32_bf16 v[48:51], v[100:103], v[52:55], v[48:51]
L_KA_pc0:
    s_add_u32 m0, s64, 0
    s_nop 0
    buffer_load_dwordx4 v8, s[40:43], s60 offen offset:0 lds
    s_add_u32 m0, s64, 3968
    s_nop 0
    buffer_load_dwordx4 v8, s[40:43], s60 offen offset:128 lds
    s_add_u32 m0, s64, 6912
    s_nop 0
    buffer_load_dwordx4 v10, s[40:43], s60 offen offset:1280 lds
    s_add_u32 m0, s64, 10880
    s_nop 0
    buffer_load_dwordx4 v10, s[40:43], s60 offen offset:1408 lds
    s_add_u32 m0, s64, 16384
    s_nop 0
    buffer_load_dwordx4 v9, s[40:43], s60 offen offset:0 lds
    s_add_u32 s64, s64, 49152
    s_cmp_ge_u32 s64, s74
    s_cselect_b32 s70, 122880, 0
    s_sub_u32 s64, s64, s70
    s_add_u32 s60, s60, 245760
    s_cmp_ge_u32 s60, 2457600
    s_cselect_b32 s70, 2457600, 0
    s_sub_u32 s60, s60, s70
    s_sub_u32 s81, s56, 1
    s_cmp_gt_u32 s81, 1
    s_cbranch_scc1 L_KA_nou
    s_lshl_b32 s92, s58, 4
    s_add_u32 s92, s92, s57
    s_lshl_b32 s92, s92, 1
    s_add_u32 s92, s92, s81
    s_lshl_b32 s82, s81, 12
    s_add_u32 s82, s82, 155648
    s_mul_i32 s93, s92, 205
    s_lshr_b32 s93, s93, 11
    s_mul_i32 s94, s93, 10
    s_sub_u32 s94, s92, s94
    s_cmp_lt_u32 s93, 54
    s_cselect_b32 s88, s28, s20
    s_cselect_b32 s89, s29, s21
    s_mov_b32 s90, 819200
    s_cselect_b32 s90, 2211840, s90
    s_cselect_b32 s70, 0, 54
    s_and_b32 s89, s89, 0xffff
    s_mov_b32 s91, 0x20000
    s_sub_u32 s70, s93, s70
    s_mul_i32 s70, s70, 40960
    s_lshl_b32 s71, s94, 7
    s_add_u32 s70, s70, s71
    v_lshrrev_b32 v2, 3, v1
    v_mul_u32_u24 v2, 1280, v2
    v_and_b32 v3, 7, v1
    v_lshl_add_u32 v2, v3, 4, v2
    s_add_u32 m0, s82, 0
    s_nop 0
    buffer_load_dwordx4 v2, s[88:91], s70 offen lds
    s_add_u32 s70, s70, 10240
    s_add_u32 m0, s82, 1024
    s_nop 0
    buffer_load_dwordx4 v2, s[88:91], s70 offen lds
    s_add_u32 s70, s70, 10240
    s_add_u32 m0, s82, 2048
    s_nop 0
    buffer_load_dwordx4 v2, s[88:91], s70 offen lds
    s_add_u32 s70, s70, 10240
    s_add_u32 m0, s82, 3072
    s_nop 0
    buffer_load_dwordx4 v2, s[88:91], s70 offen lds
    s_add_u32 s70, s70, 10240
L_KA_nou:
    s_barrier
    v_add_u32 v20, s65, v15
    v_add_u32 v21, s65, v16
    v_add_u32 v22, s65, v17
    v_add_u32 v23, s65, v18
    v_add_u32 v24, s65, v19
    ds_read_b64_tr_b16 v[112:113], v20 offset:0
    ds_read_b64_tr_b16 v[114:115], v20 offset:512
    ds_read_b64_tr_b16 v[120:121], v21 offset:0
    ds_read_b64_tr_b16 v[122:123], v21 offset:512
    ds_read_b64_tr_b16 v[128:129], v22 offset:0
    ds_read_b64_tr_b16 v[130:131], v22 offset:512
    ds_read_b64_tr_b16 v[136:137], v23 offset:0
    ds_read_b64_tr_b16 v[138:139], v23 offset:512
    ds_read_b64_tr_b16 v[144:145], v24 offset:0
    ds_read_b64_tr_b16 v[146:147], v24 offset:512
    ds_read_b128 v[104:107], v13 offset:0
    ds_read_b64_tr_b16 v[116:117], v20 offset:2048
    ds_read_b64_tr_b16 v[118:119], v20 offset:2560
    ds_read_b64_tr_b16 v[124:125], v21 offset:2048
    ds_read_b64_tr_b16 v[126:127], v21 offset:2560
    ds_read_b64_tr_b16 v[132:133], v22 offset:2048
    ds_read_b64_tr_b16 v[134:135], v22 offset:2560
    ds_read_b64_tr_b16 v[140:141], v23 offset:2048
    ds_read_b64_tr_b16 v[142:143], v23 offset:2560
    ds_read_b64_tr_b16 v[148:149], v24 offset:2048
    ds_read_b64_tr_b16 v[150:151], v24 offset:2560
    ds_read_b128 v[108:111], v14 offset:0
    s_add_u32 s65, s65, 24576
    s_cmp_eq_u32 s65, 155648
    s_cselect_b32 s65, 32768, s65
    s_waitcnt lgkmcnt(0)
    v_mfma_f32_32x32x16_bf16 v[152:167], v[104:107], v[112:115], v[152:167]
    v_mfma_f32_32x32x16_bf16 v[168:183], v[104:107], v[120:123], v[168:183]
    v_mfma_f32_32x32x16_bf16 v[184:199], v[104:107], v[128:131], v[184:199]
    v_mfma_f32_32x32x16_bf16 v[200:215], v[104:107], v[136:139], v[200:215]
    v_mfma_f32_32x32x16_bf16 v[216:231], v[104:107], v[144:147], v[216:231]
    v_mfma_f32_32x32x16_bf16 v[152:167], v[108:111], v[116:119], v[152:167]
    v_mfma_f32_32x32x16_bf16 v[168:183], v[108:111], v[124:127], v[168:183]
    v_mfma_f32_32x32x16_bf16 v[184:199], v[108:111], v[132:135], v[184:199]
    v_mfma_f32_32x32x16_bf16 v[200:215], v[108:111], v[140:143], v[200:215]
    v_mfma_f32_32x32x16_bf16 v[216:231], v[108:111], v[148:151], v[216:231]
    s_add_u32 m0, s64, 0
    s_nop 0
    buffer_load_dwordx4 v8, s[40:43], s60 offen offset:0 lds
    s_add_u32 m0, s64, 3968
    s_nop 0
    buffer_load_dwordx4 v8, s[40:43], s60 offen offset:128 lds
    s_add_u32 m0, s64, 6912
    s_nop 0
    buffer_load_dwordx4 v10, s[40:43], s60 offen offset:1280 lds
    s_add_u32 m0, s64, 10880
    s_nop 0
    buffer_load_dwordx4 v10, s[40:43], s60 offen offset:1408 lds
    s_add_u32 m0, s64, 16384
    s_nop 0
    buffer_load_dwordx4 v9, s[40:43], s60 offen offset:0 lds
    s_add_u32 s64, s64, 49152
    s_cmp_ge_u32 s64, s74
    s_cselect_b32 s70, 122880, 0
    s_sub_u32 s64, s64, s70
    s_add_u32 s60, s60, 245760
    s_cmp_ge_u32 s60, 2457600
    s_cselect_b32 s70, 2457600, 0
    s_sub_u32 s60, s60, s70
    s_cmp_eq_u32 s68, 0
    s_cbranch_scc1 L_KA_cs1
    s_waitcnt vmcnt(5)
L_KA_pc1:
    s_cmp_gt_u32 s81, 1
    s_cbranch_scc1 L_KA_pc2
    s_mul_i32 s93, s92, 205
    s_lshr_b32 s93, s93, 11
    s_mul_i32 s94, s93, 10
    s_sub_u32 s94, s92, s94
    v_bfe_u32 v2, v1, 2, 2
    v_lshlrev_b32 v2, 7, v2
    v_and_b32 v3, 3, v1
    v_lshl_add_u32 v2, v3, 3, v2
    v_lshrrev_b32 v3, 4, v1
    s_cmp_lt_u32 s93, 54
    s_cselect_b32 s70, 10, 9
    s_movk_i32 s71, 512
    s_cselect_b32 s71, s71, 2048
    v_lshlrev_b32 v3, s70, v3
    v_add3_u32 v2, v2, v3, s82
    v_add_u32 v3, s71, v2
    ds_read_b64_tr_b16 v[56:57], v2 offset:0
    ds_read_b64_tr_b16 v[58:59], v3 offset:0
    ds_read_b64_tr_b16 v[60:61], v2 offset:32
    ds_read_b64_tr_b16 v[62:63], v3 offset:32
    ds_read_b64_tr_b16 v[64:65], v2 offset:64
    ds_read_b64_tr_b16 v[66:67], v3 offset:64
    ds_read_b64_tr_b16 v[68:69], v2 offset:96
    ds_read_b64_tr_b16 v[70:71], v3 offset:96
    v_lshlrev_b32 v4, 4, v1
    s_waitcnt lgkmcnt(0)
    s_lshl_b32 s70, s94, 2
    s_add_u32 s70, s70, 0
    s_mul_i32 s71, s70, 205
    s_lshr_b32 s71, s71, 10
    s_mul_i32 s75, s71, 365
    s_add_u32 s70, s70, s75
    s_mul_i32 s75, s93, 5
    s_add_u32 s70, s70, s75
    s_lshl_b32 s70, s70, 10
    s_add_u32 s70, s70, 10485760
    s_cmp_lt_u32 s92, 740
    s_cselect_b32 s70, s70, 1073741824
    buffer_store_dwordx4 v[56:59], v4, s[44:47], s70 offen sc1
    s_lshl_b32 s70, s94, 2
    s_add_u32 s70, s70, 1
    s_mul_i32 s71, s70, 205
    s_lshr_b32 s71, s71, 10
    s_mul_i32 s75, s71, 365
    s_add_u32 s70, s70, s75
    s_mul_i32 s75, s93, 5
    s_add_u32 s70, s70, s75
    s_lshl_b32 s70, s70, 10
    s_add_u32 s70, s70, 10485760
    s_cmp_lt_u32 s92, 740
    s_cselect_b32 s70, s70, 1073741824
    buffer_store_dwordx4 v[60:63], v4, s[44:47], s70 offen sc1
    s_lshl_b32 s70, s94, 2
    s_add_u32 s70, s70, 2
    s_mul_i32 s71, s70, 205
    s_lshr_b32 s71, s71, 10
    s_mul_i32 s75, s71, 365
    s_add_u32 s70, s70, s75
    s_mul_i32 s75, s93, 5
    s_add_u32 s70, s70, s75
    s_lshl_b32 s70, s70, 10
    s_add_u32 s70, s70, 10485760
    s_cmp_lt_u32 s92, 740
    s_cselect_b32 s70, s70, 1073741824
    buffer_store_dwordx4 v[64:67], v4, s[44:47], s70 offen sc1
    s_lshl_b32 s70, s94, 2
    s_add_u32 s70, s70, 3
    s_mul_i32 s71, s70, 205
    s_lshr_b32 s71, s71, 10
    s_mul_i32 s75, s71, 365
    s_add_u32 s70, s70, s75
    s_mul_i32 s75, s93, 5
    s_add_u32 s70, s70, s75
    s_lshl_b32 s70, s70, 10
    s_add_u32 s70, s70, 10485760
    s_cmp_lt_u32 s92, 740
    s_cselect_b32 s70, s70, 1073741824
    buffer_store_dwordx4 v[68:71], v4, s[44:47], s70 offen sc1
L_KA_pc2:
    s_barrier
    v_xor_b32 v11, 16384, v11
    v_xor_b32 v12, 16384, v12
    v_xor_b32 v13, 16384, v13
    v_xor_b32 v14, 16384, v14
    v_add_u32 v20, s65, v15
    v_add_u32 v21, s65, v16
    v_add_u32 v22, s65, v17
    v_add_u32 v23, s65, v18
    v_add_u32 v24, s65, v19
    ds_read_b64_tr_b16 v[64:65], v20 offset:0
    ds_read_b64_tr_b16 v[66:67], v20 offset:512
    ds_read_b64_tr_b16 v[72:73], v21 offset:0
    ds_read_b64_tr_b16 v[74:75], v21 offset:512
    ds_read_b64_tr_b16 v[80:81], v22 offset:0
    ds_read_b64_tr_b16 v[82:83], v22 offset:512
    ds_read_b64_tr_b16 v[88:89], v23 offset:0
    ds_read_b64_tr_b16 v[90:91], v23 offset:512
    ds_read_b64_tr_b16 v[96:97], v24 offset:0
    ds_read_b64_tr_b16 v[98:99], v24 offset:512
    ds_read_b128 v[56:59], v11 offset:0
    ds_read_b64_tr_b16 v[68:69], v20 offset:2048
    ds_read_b64_tr_b16 v[70:71], v20 offset:2560
    ds_read_b64_tr_b16 v[76:77], v21 offset:2048
    ds_read_b64_tr_b16 v[78:79], v21 offset:2560
    ds_read_b64_tr_b16 v[84:85], v22 offset:2048
    ds_read_b64_tr_b16 v[86:87], v22 offset:2560
    ds_read_b64_tr_b16 v[92:93], v23 offset:2048
    ds_read_b64_tr_b16 v[94:95], v23 offset:2560
    ds_read_b64_tr_b16 v[100:101], v24 offset:2048
    ds_read_b64_tr_b16 v[102:103], v24 offset:2560
    ds_read_b128 v[60:63], v12 offset:0
    s_add_u32 s65, s65, 24576
    s_cmp_eq_u32 s65, 155648
    s_cselect_b32 s65, 32768, s65
    s_mov_b32 s59, 1
    s_waitcnt lgkmcnt(0)
.p2align 6
L_KA_loop:
    v_mfma_f32_32x32x16_bf16 v[152:167], v[56:59], v[64:67], v[152:167]
    v_add_u32 v20, s65, v15
    v_add_u32 v21, s65, v16
    v_add_u32 v22, s65, v17
    v_add_u32 v23, s65, v18
    v_add_u32 v24, s65, v19
    v_mfma_f32_32x32x16_bf16 v[168:183], v[56:59], v[72:75], v[168:183]
    ds_read_b64_tr_b16 v[112:113], v20 offset:0
    ds_read_b64_tr_b16 v[114:115], v20 offset:512
    ds_read_b64_tr_b16 v[120:121], v21 offset:0
    ds_read_b64_tr_b16 v[122:123], v21 offset:512
    v_mfma_f32_32x32x16_bf16 v[184:199], v[56:59], v[80:83], v[184:199]
    ds_read_b64_tr_b16 v[128:129], v22 offset:0
    ds_read_b64_tr_b16 v[130:131], v22 offset:512
    ds_read_b64_tr_b16 v[136:137], v23 offset:0
    ds_read_b64_tr_b16 v[138:139], v23 offset:512
    v_mfma_f32_32x32x16_bf16 v[200:215], v[56:59], v[88:91], v[200:215]
    ds_read_b64_tr_b16 v[144:145], v24 offset:0
    ds_read_b64_tr_b16 v[146:147], v24 offset:512
    ds_read_b128 v[104:107], v13 offset:0
    v_mfma_f32_32x32x16_bf16 v[216:231], v[56:59], v[96:99], v[216:231]
    ds_read_b64_tr_b16 v[116:117], v20 offset:2048
    ds_read_b64_tr_b16 v[118:119], v20 offset:2560
    ds_read_b64_tr_b16 v[124:125], v21 offset:2048
    ds_read_b64_tr_b16 v[126:127], v21 offset:2560
    v_mfma_f32_32x32x16_bf16 v[152:167], v[60:63], v[68:71], v[152:167]
    ds_read_b64_tr_b16 v[132:133], v22 offset:2048
    ds_read_b64_tr_b16 v[134:135], v22 offset:2560
    ds_read_b64_tr_b16 v[140:141], v23 offset:2048
    ds_read_b64_tr_b16 v[142:143], v23 offset:2560
    v_mfma_f32_32x32x16_bf16 v[168:183], v[60:63], v[76:79], v[168:183]
    ds_read_b64_tr_b16 v[148:149], v24 offset:2048
    ds_read_b64_tr_b16 v[150:151], v24 offset:2560
    ds_read_b128 v[108:111], v14 offset:0
    v_mfma_f32_32x32x16_bf16 v[184:199], v[60:63], v[84:87], v[184:199]
    v_mfma_f32_32x32x16_bf16 v[200:215], v[60:63], v[92:95], v[200:215]
    s_add_u32 s65, s65, 24576
    s_cmp_eq_u32 s65, 155648
    s_cselect_b32 s65, 32768, s65
    v_mfma_f32_32x32x16_bf16 v[216:231], v[60:63], v[100:103], v[216:231]
    s_bitcmp1_b32 s69, s59
    s_cbranch_scc1 L_KA_spec
L_KA_specr:
    s_add_u32 m0, s64, 0
    s_nop 0
    buffer_load_dwordx4 v8, s[40:43], s60 offen offset:0 lds
    s_add_u32 m0, s64, 3968
    s_nop 0
    buffer_load_dwordx4 v8, s[40:43], s60 offen offset:128 lds
    s_add_u32 m0, s64, 6912
    s_nop 0
    buffer_load_dwordx4 v10, s[40:43], s60 offen offset:1280 lds
    s_add_u32 m0, s64, 10880
    s_nop 0
    buffer_load_dwordx4 v10, s[40:43], s60 offen offset:1408 lds
    s_add_u32 m0, s64, 16384
    s_nop 0
    buffer_load_dwordx4 v9, s[40:43], s60 offen offset:0 lds
    s_add_u32 s64, s64, 49152
    s_cmp_ge_u32 s64, s74
    s_cselect_b32 s70, 122880, 0
    s_sub_u32 s64, s64, s70
    s_add_u32 s60, s60, 245760
    s_cmp_ge_u32 s60, 2457600
    s_cselect_b32 s70, 2457600, 0
    s_sub_u32 s60, s60, s70
    s_waitcnt vmcnt(5) lgkmcnt(0)
L_KA_bar:
    s_barrier
    v_mfma_f32_32x32x16_bf16 v[152:167], v[104:107], v[112:115], v[152:167]
    v_xor_b32 v11, 16384, v11
    v_xor_b32 v12, 16384, v12
    v_add_u32 v20, s65, v15
    v_add_u32 v21, s65, v16
    v_add_u32 v22, s65, v17
    v_add_u32 v23, s65, v18
    v_add_u32 v24, s65, v19
    v_mfma_f32_32x32x16_bf16 v[168:183], v[104:107], v[120:123], v[168:183]
    ds_read_b64_tr_b16 v[64:65], v20 offset:0
    ds_read_b64_tr_b16 v[66:67], v20 offset:512
    ds_read_b64_tr_b16 v[72:73], v21 offset:0
    ds_read_b64_tr_b16 v[74:75], v21 offset:512
    v_mfma_f32_32x32x16_bf16 v[184:199], v[104:107], v[128:131], v[184:199]
    ds_read_b64_tr_b16 v[80:81], v22 offset:0
    ds_read_b64_tr_b16 v[82:83], v22 offset:512
    ds_read_b64_tr_b16 v[88:89], v23 offset:0
    ds_read_b64_tr_b16 v[90:91], v23 offset:512
    v_mfma_f32_32x32x16_bf16 v[200:215], v[104:107], v[136:139], v[200:215]
    ds_read_b64_tr_b16 v[96:97], v24 offset:0
    ds_read_b64_tr_b16 v[98:99], v24 offset:512
    ds_read_b128 v[56:59], v11 offset:0
    v_mfma_f32_32x32x16_bf16 v[216:231], v[104:107], v[144:147], v[216:231]
    ds_read_b64_tr_b16 v[68:69], v20 offset:2048
    ds_read_b64_tr_b16 v[70:71], v20 offset:2560
    ds_read_b64_tr_b16 v[76:77], v21 offset:2048
    ds_read_b64_tr_b16 v[78:79], v21 offset:2560
    v_mfma_f32_32x32x16_bf16 v[152:167], v[108:111], v[116:119], v[152:167]
    ds_read_b64_tr_b16 v[84:85], v22 offset:2048
    ds_read_b64_tr_b16 v[86:87], v22 offset:2560
    ds_read_b64_tr_b16 v[92:93], v23 offset:2048
    ds_read_b64_tr_b16 v[94:95], v23 offset:2560
    v_mfma_f32_32x32x16_bf16 v[168:183], v[108:111], v[124:127], v[168:183]
    ds_read_b64_tr_b16 v[100:101], v24 offset:2048
    ds_read_b64_tr_b16 v[102:103], v24 offset:2560
    ds_read_b128 v[60:63], v12 offset:0
    v_mfma_f32_32x32x16_bf16 v[184:199], v[108:111], v[132:135], v[184:199]
    s_add_u32 s65, s65, 24576
    s_cmp_eq_u32 s65, 155648
    s_cselect_b32 s65, 32768, s65
    v_xor_b32 v13, 16384, v13
    v_xor_b32 v14, 16384, v14
    v_mfma_f32_32x32x16_bf16 v[200:215], v[108:111], v[140:143], v[200:215]
    s_add_u32 s59, s59, 1
    s_cmp_lt_u32 s59, 10
    v_mfma_f32_32x32x16_bf16 v[216:231], v[108:111], v[148:151], v[216:231]
    s_waitcnt lgkmcnt(0)
    s_cbranch_scc1 L_KA_loop
    s_branch L_K_epi
L_KA_cs1:
    v_mfma_f32_16x16x32_bf16 v[32:35], v[112:115], v[52:55], v[32:35]
    v_mfma_f32_16x16x32_bf16 v[36:39], v[120:123], v[52:55], v[36:39]
    v_mfma_f32_16x16x32_bf16 v[40:43], v[128:131], v[52:55], v[40:43]
    v_mfma_f32_16x16x32_bf16 v[44:47], v[136:139], v[52:55], v[44:47]
    v_mfma_f32_16x16x32_bf16 v[48:51], v[144:147], v[52:55], v[48:51]
    v_mfma_f32_16x16x32_bf16 v[32:35], v[116:119], v[52:55], v[32:35]
    v_mfma_f32_16x16x32_bf16 v[36:39], v[124:127], v[52:55], v[36:39]
    v_mfma_f32_16x16x32_bf16 v[40:43], v[132:135], v[52:55], v[40:43]
    v_mfma_f32_16x16x32_bf16 v[44:47], v[140:143], v[52:55], v[44:47]
    v_mfma_f32_16x16x32_bf16 v[48:51], v[148:151], v[52:55], v[48:51]
    v_and_b32 v2, 15, v1
    v_lshrrev_b32 v3, 4, v1
    v_lshlrev_b32 v3, 4, v3
    v_lshl_add_u32 v3, v2, 6, v3
    v_cmp_gt_u32 vcc, 2, v2
    v_mov_b32 v4, 1073741824
    s_nop 0
    v_cndmask_b32 v3, v4, v3, vcc
    s_mul_i32 s70, s58, 10
    s_add_u32 s70, s70, s76
    s_mul_i32 s70, s70, 1536
    s_mul_i32 s71, s73, 640
    s_add_u32 s70, s70, s71
    s_add_u32 s70, s70, 13697024
    buffer_store_dwordx4 v[32:35], v3, s[44:47], s70 offen offset:0 sc1
    buffer_store_dwordx4 v[36:39], v3, s[44:47], s70 offen offset:128 sc1
    buffer_store_dwordx4 v[40:43], v3, s[44:47], s70 offen offset:256 sc1
    buffer_store_dwordx4 v[44:47], v3, s[44:47], s70 offen offset:384 sc1
    buffer_store_dwordx4 v[48:51], v3, s[44:47], s70 offen offset:512 sc1
    s_waitcnt vmcnt(10)
    s_branch L_KA_pc1
L_KA_spec:
    s_cmp_eq_u32 s59, 9
    s_cbranch_scc1 L_KA_sum
    s_cmp_eq_u32 s59, 8
    s_cbranch_scc1 L_KA_go
    s_cmp_eq_u32 s59, 7
    s_cbranch_scc1 L_KA_chk
    s_cmp_eq_u32 s59, 6
    s_cbranch_scc1 L_KA_poll0
L_KA_pub:
    s_cmp_lg_u32 s59, 2
    s_cbranch_scc1 L_KA_pub1
    s_branch L_KA_wz_c
L_KA_wz:
    s_sleep 4
    buffer_load_dword v30, off, s[48:51], 0 sc1
L_KA_wz_c:
    s_waitcnt vmcnt(0)
    v_readfirstlane_b32 s70, v30
    s_add_u32 s78, s78, 1
    s_cmp_gt_u32 s78, 1048576
    s_cbranch_scc1 L_KA_wz_ok
    s_cmp_lt_u32 s70, 16
    s_cbranch_scc1 L_KA_wz
L_KA_wz_ok:
L_KA_pub1:
    s_add_u32 m0, s64, 0
    s_nop 0
    buffer_load_dwordx4 v8, s[40:43], s60 offen offset:0 lds
    s_add_u32 m0, s64, 3968
    s_nop 0
    buffer_load_dwordx4 v8, s[40:43], s60 offen offset:128 lds
    s_add_u32 m0, s64, 6912
    s_nop 0
    buffer_load_dwordx4 v10, s[40:43], s60 offen offset:1280 lds
    s_add_u32 m0, s64, 10880
    s_nop 0
    buffer_load_dwordx4 v10, s[40:43], s60 offen offset:1408 lds
    s_add_u32 m0, s64, 16384
    s_nop 0
    buffer_load_dwordx4 v9, s[40:43], s60 offen offset:0 lds
    s_add_u32 s64, s64, 49152
    s_cmp_ge_u32 s64, s74
    s_cselect_b32 s70, 122880, 0
    s_sub_u32 s64, s64, s70
    s_add_u32 s60, s60, 245760
    s_cmp_ge_u32 s60, 2457600
    s_cselect_b32 s70, 2457600, 0
    s_sub_u32 s60, s60, s70
    s_cmp_eq_u32 s59, 3
    s_cbranch_scc1 L_KA_pub3
    s_cmp_eq_u32 s59, 2
    s_cbranch_scc1 L_KA_pub2
    buffer_load_dword v30, off, s[48:51], 0 sc1
    s_branch L_KA_pub3
L_KA_pub2:
    s_lshl_b32 s70, s57, 8
    s_add_u32 s70, s70, 14221440
    v_mov_b32 v2, 1073741824
    v_writelane_b32 v2, s70, 0
    v_mov_b32 v3, 1
    buffer_atomic_add v3, v2, s[44:47], 0 offen sc1
L_KA_pub3:
    s_waitcnt vmcnt(6) lgkmcnt(0)
    s_branch L_KA_bar
L_KA_poll0:
    s_add_u32 m0, s64, 0
    s_nop 0
    buffer_load_dwordx4 v8, s[40:43], s60 offen offset:0 lds
    s_add_u32 m0, s64, 3968
    s_nop 0
    buffer_load_dwordx4 v8, s[40:43], s60 offen offset:128 lds
    s_add_u32 m0, s64, 6912
    s_nop 0
    buffer_load_dwordx4 v10, s[40:43], s60 offen offset:1280 lds
    s_add_u32 m0, s64, 10880
    s_nop 0
    buffer_load_dwordx4 v10, s[40:43], s60 offen offset:1408 lds
    s_add_u32 m0, s64, 16384
    s_nop 0
    buffer_load_dwordx4 v9, s[40:43], s60 offen offset:0 lds
    s_add_u32 s64, s64, 49152
    s_cmp_ge_u32 s64, s74
    s_cselect_b32 s70, 122880, 0
    s_sub_u32 s64, s64, s70
    s_add_u32 s60, s60, 245760
    s_cmp_ge_u32 s60, 2457600
    s_cselect_b32 s70, 2457600, 0
    s_sub_u32 s60, s60, s70
    buffer_load_dword v30, v25, s[44:47], 0 offen sc1
    s_waitcnt vmcnt(6) lgkmcnt(0)
    s_branch L_KA_bar
L_KA_poll:
    s_sleep 8
    buffer_load_dword v30, v25, s[44:47], 0 offen sc1
L_KA_chk:
    s_waitcnt vmcnt(0)
    v_cmp_gt_u32 vcc, 16, v30
    s_add_u32 s78, s78, 1
    s_cmp_gt_u32 s78, 1048576
    s_cbranch_scc1 L_KA_specr
    s_cmp_lg_u64 vcc, 0
    s_cbranch_scc1 L_KA_poll
    s_branch L_KA_specr
L_KA_go:
    v_lshlrev_b32 v2, 3, v0
    v_cmp_gt_u32 vcc, 160, v0
    v_mov_b32 v4, 1073741824
    s_nop 0
    v_cndmask_b32 v2, v4, v2, vcc
    s_mul_i32 s70, s58, 15360
    s_add_u32 s70, s70, 13697024
    buffer_load_dwordx2 v[32:33], v2, s[44:47], s70 offen offset:0 sc1
    buffer_load_dwordx2 v[34:35], v2, s[44:47], s70 offen offset:1536 sc1
    s_add_u32 s70, s70, 3072
    buffer_load_dwordx2 v[36:37], v2, s[44:47], s70 offen offset:0 sc1
    buffer_load_dwordx2 v[38:39], v2, s[44:47], s70 offen offset:1536 sc1
    s_add_u32 s70, s70, 3072
    buffer_load_dwordx2 v[40:41], v2, s[44:47], s70 offen offset:0 sc1
    buffer_load_dwordx2 v[42:43], v2, s[44:47], s70 offen offset:1536 sc1
    s_add_u32 s70, s70, 3072
    buffer_load_dwordx2 v[44:45], v2, s[44:47], s70 offen offset:0 sc1
    buffer_load_dwordx2 v[46:47], v2, s[44:47], s70 offen offset:1536 sc1
    s_add_u32 s70, s70, 3072
    buffer_load_dwordx2 v[48:49], v2, s[44:47], s70 offen offset:0 sc1
    buffer_load_dwordx2 v[50:51], v2, s[44:47], s70 offen offset:1536 sc1
    s_lshl_b32 s70, s57, 10
    s_add_u32 s70, s70, 13631488
    v_lshlrev_b32 v3, 2, v0
    buffer_load_dword v31, v3, s[44:47], s70 offen sc1
    s_lshr_b32 s4, s2, 3
    s_and_b32 s4, s4, 7
    s_mul_i32 s4, s4, 378880
    s_and_b32 s5, s56, 3
    s_mul_i32 s5, s5, 6144
    s_add_u32 s4, s4, s5
    s_add_u32 s4, s4, 10762240
    s_add_u32 s5, s5, 32768
    v_lshlrev_b32 v2, 4, v1
    s_add_u32 m0, s5, 0
    s_add_u32 s6, s4, 0
    buffer_load_dwordx4 v2, s[44:47], s6 offen offset:0 sc1 lds
    buffer_load_dwordx4 v2, s[44:47], s6 offen offset:1024 sc1 lds
    buffer_load_dwordx4 v2, s[44:47], s6 offen offset:2048 sc1 lds
    buffer_load_dwordx4 v2, s[44:47], s6 offen offset:3072 sc1 lds
    s_add_u32 m0, s5, 4096
    s_add_u32 s6, s4, 4096
    buffer_load_dwordx4 v2, s[44:47], s6 offen offset:0 sc1 lds
    buffer_load_dwordx4 v2, s[44:47], s6 offen offset:1024 sc1 lds
    s_waitcnt vmcnt(17) lgkmcnt(0)
    s_branch L_KA_bar
L_KA_sum:
    s_waitcnt vmcnt(6)
    v_add_f32 v32, v32, v34
    v_add_f32 v33, v33, v35
    v_add_f32 v32, v32, v36
    v_add_f32 v33, v33, v37
    v_add_f32 v32, v32, v38
    v_add_f32 v33, v33, v39
    v_add_f32 v32, v32, v40
    v_add_f32 v33, v33, v41
    v_add_f32 v32, v32, v42
    v_add_f32 v33, v33, v43
    v_add_f32 v32, v32, v44
    v_add_f32 v33, v33, v45
    v_add_f32 v32, v32, v46
    v_add_f32 v33, v33, v47
    v_add_f32 v32, v32, v48
    v_add_f32 v33, v33, v49
    v_add_f32 v32, v32, v50
    v_add_f32 v33, v33, v51
    v_lshlrev_b32 v2, 3, v0
    v_add_u32 v2, 155648, v2
    ds_write_b64 v2, v[32:33]
    v_rsq_f32 v4, v31
    v_and_b32 v3, 1, v0
    v_cmp_eq_u32 vcc, 1, v3
    v_lshlrev_b32 v3, 9, v3
    v_lshrrev_b32 v2, 1, v0
    v_lshl_add_u32 v3, v2, 2, v3
    v_add_u32 v3, 157696, v3
    v_cndmask_b32 v2, v31, v4, vcc
    ds_write_b32 v3, v2
    v_mul_f32 v4, 0x3fb8aa3b, v4
    ds_write_b32 v3, v4 offset:1024
    s_lshr_b32 s4, s2, 3
    s_and_b32 s4, s4, 7
    s_mul_i32 s4, s4, 378880
    s_and_b32 s5, s56, 3
    s_mul_i32 s5, s5, 5120
    s_add_u32 s4, s4, s5
    s_add_u32 s4, s4, 10815488
    s_add_u32 s5, s5, 86016
    v_lshlrev_b32 v2, 4, v1
    s_add_u32 m0, s5, 0
    s_add_u32 s6, s4, 0
    buffer_load_dwordx4 v2, s[44:47], s6 offen offset:0 sc1 lds
    buffer_load_dwordx4 v2, s[44:47], s6 offen offset:1024 sc1 lds
    buffer_load_dwordx4 v2, s[44:47], s6 offen offset:2048 sc1 lds
    buffer_load_dwordx4 v2, s[44:47], s6 offen offset:3072 sc1 lds
    s_add_u32 m0, s5, 4096
    s_add_u32 s6, s4, 4096
    buffer_load_dwordx4 v2, s[44:47], s6 offen offset:0 sc1 lds
    s_waitcnt lgkmcnt(0)
    s_branch L_KA_bar
L_K_roleB:
    s_add_u32 m0, s64, 0
    s_nop 0
    buffer_load_dwordx4 v8, s[40:43], s60 offen offset:0 lds
    s_add_u32 m0, s64, 3968
    s_nop 0
    buffer_load_dwordx4 v8, s[40:43], s60 offen offset:128 lds
    s_add_u32 m0, s64, 6912
    s_nop 0
    buffer_load_dwordx4 v10, s[40:43], s60 offen offset:1280 lds
    s_add_u32 m0, s64, 10880
    s_nop 0
    buffer_load_dwordx4 v10, s[40:43], s60 offen offset:1408 lds
    s_add_u32 m0, s64, 16384
    s_nop 0
    buffer_load_dwordx4 v9, s[40:43], s60 offen offset:0 lds
    s_add_u32 s64, s64, 49152
    s_cmp_ge_u32 s64, s74
    s_cselect_b32 s70, 122880, 0
    s_sub_u32 s64, s64, s70
    s_add_u32 s60, s60, 245760
    s_cmp_ge_u32 s60, 2457600
    s_cselect_b32 s70, 2457600, 0
    s_sub_u32 s60, s60, s70
    s_waitcnt vmcnt(9)
    v_lshlrev_b32 v64, 16, v56
    v_and_b32 v65, 0xffff0000, v56
    v_lshlrev_b32 v66, 16, v57
    v_and_b32 v67, 0xffff0000, v57
    v_lshlrev_b32 v68, 16, v58
    v_and_b32 v69, 0xffff0000, v58
    v_lshlrev_b32 v70, 16, v59
    v_and_b32 v71, 0xffff0000, v59
    v_lshlrev_b32 v72, 16, v60
    v_and_b32 v73, 0xffff0000, v60
    v_add_f32 v76, v64, v65
    v_add_f32 v76, v76, v66
    v_add_f32 v76, v76, v67
    v_add_f32 v76, v76, v68
    v_add_f32 v76, v76, v69
    v_add_f32 v76, v76, v70
    v_add_f32 v76, v76, v71
    v_add_f32 v76, v76, v72
    v_add_f32 v76, v76, v73
    s_nop 1
    v_add_f32_dpp v76, v76, v76 quad_perm:[1,0,3,2] row_mask:0xf bank_mask:0xf
    s_nop 1
    v_add_f32_dpp v76, v76, v76 quad_perm:[2,3,0,1] row_mask:0xf bank_mask:0xf
    s_nop 1
    v_add_f32_dpp v76, v76, v76 row_half_mirror row_mask:0xf bank_mask:0xf
    s_nop 1
    v_add_f32_dpp v76, v76, v76 row_mirror row_mask:0xf bank_mask:0xf
    s_nop 0
    v_readlane_b32 s4, v76, 0
    v_readlane_b32 s5, v76, 16
    v_readlane_b32 s6, v76, 32
    v_readlane_b32 s7, v76, 48
    v_mov_b32 v76, s4
    v_mov_b32 v77, s6
    v_add_f32 v76, s5, v76
    v_add_f32 v77, s7, v77
    v_add_f32 v76, v76, v77
    v_mul_f32 v76, 0x3acccccd, v76
    v_sub_f32 v64, v64, v76
    v_sub_f32 v65, v65, v76
    v_sub_f32 v66, v66, v76
    v_sub_f32 v67, v67, v76
    v_sub_f32 v68, v68, v76
    v_sub_f32 v69, v69, v76
    v_sub_f32 v70, v70, v76
    v_sub_f32 v71, v71, v76
    v_sub_f32 v72, v72, v76
    v_sub_f32 v73, v73, v76
    v_mul_f32 v77, v64, v64
    v_fmac_f32 v77, v65, v65
    v_fmac_f32 v77, v66, v66
    v_fmac_f32 v77, v67, v67
    v_fmac_f32 v77, v68, v68
    v_fmac_f32 v77, v69, v69
    v_fmac_f32 v77, v70, v70
    v_fmac_f32 v77, v71, v71
    v_fmac_f32 v77, v72, v72
    v_fmac_f32 v77, v73, v73
    s_nop 1
    v_add_f32_dpp v77, v77, v77 quad_perm:[1,0,3,2] row_mask:0xf bank_mask:0xf
    s_nop 1
    v_add_f32_dpp v77, v77, v77 quad_perm:[2,3,0,1] row_mask:0xf bank_mask:0xf
    s_nop 1
    v_add_f32_dpp v77, v77, v77 row_half_mirror row_mask:0xf bank_mask:0xf
    s_nop 1
    v_add_f32_dpp v77, v77, v77 row_mirror row_mask:0xf bank_mask:0xf
    s_nop 0
    v_readlane_b32 s4, v77, 0
    v_readlane_b32 s5, v77, 16
    v_readlane_b32 s6, v77, 32
    v_readlane_b32 s7, v77, 48
    v_mov_b32 v77, s4
    v_mov_b32 v78, s6
    v_add_f32 v77, s5, v77
    v_add_f32 v78, s7, v78
    v_add_f32 v77, v77, v78
    v_mov_b32 v78, 0x3727c5ac
    v_fmac_f32 v78, 0x3acccccd, v77
    v_mov_b32 v77, v78
    v_cmp_eq_u32 vcc, 0, v1
    v_mov_b32 v4, 1073741824
    s_nop 0
    v_cndmask_b32 v2, v4, v1, vcc
    s_lshl_b32 s70, s77, 3
    s_add_u32 s70, s70, 13631488
    buffer_store_dwordx2 v[76:77], v2, s[44:47], s70 offen sc1
    s_waitcnt vmcnt(6)
    s_barrier
    v_add_u32 v20, s65, v15
    v_add_u32 v21, s65, v16
    v_add_u32 v22, s65, v17
    v_add_u32 v23, s65, v18
    v_add_u32 v24, s65, v19
    ds_read_b64_tr_b16 v[64:65], v20 offset:0
    ds_read_b64_tr_b16 v[66:67], v20 offset:512
    ds_read_b64_tr_b16 v[72:73], v21 offset:0
    ds_read_b64_tr_b16 v[74:75], v21 offset:512
    ds_read_b64_tr_b16 v[80:81], v22 offset:0
    ds_read_b64_tr_b16 v[82:83], v22 offset:512
    ds_read_b64_tr_b16 v[88:89], v23 offset:0
    ds_read_b64_tr_b16 v[90:91], v23 offset:512
    ds_read_b64_tr_b16 v[96:97], v24 offset:0
    ds_read_b64_tr_b16 v[98:99], v24 offset:512
    ds_read_b128 v[56:59], v11 offset:0
    ds_read_b64_tr_b16 v[68:69], v20 offset:2048
    ds_read_b64_tr_b16 v[70:71], v20 offset:2560
    ds_read_b64_tr_b16 v[76:77], v21 offset:2048
    ds_read_b64_tr_b16 v[78:79], v21 offset:2560
    ds_read_b64_tr_b16 v[84:85], v22 offset:2048
    ds_read_b64_tr_b16 v[86:87], v22 offset:2560
    ds_read_b64_tr_b16 v[92:93], v23 offset:2048
    ds_read_b64_tr_b16 v[94:95], v23 offset:2560
    ds_read_b64_tr_b16 v[100:101], v24 offset:2048
    ds_read_b64_tr_b16 v[102:103], v24 offset:2560
    ds_read_b128 v[60:63], v12 offset:0
    s_add_u32 s65, s65, 24576
    s_cmp_eq_u32 s65, 155648
    s_cselect_b32 s65, 32768, s65
    s_add_u32 m0, s66, 0
    s_add_u32 s70, s62, 20480
    buffer_load_dwordx4 v6, s[36:39], s62 offen lds
    s_add_u32 m0, s66, 1024
    s_add_u32 s70, s62, 20480
    buffer_load_dwordx4 v7, s[36:39], s62 offen lds
    s_add_u32 m0, s66, 2048
    s_add_u32 s70, s62, 20480
    buffer_load_dwordx4 v6, s[36:39], s70 offen lds
    s_add_u32 m0, s66, 3072
    s_add_u32 s70, s62, 20480
    buffer_load_dwordx4 v7, s[36:39], s70 offen lds
    s_xor_b32 s66, s66, 16384
    s_add_u32 s62, s62, 128
    s_cmp_eq_u32 s62, 1280
    s_cselect_b32 s62, 0, s62
    s_waitcnt lgkmcnt(0)
    v_mfma_f32_32x32x16_bf16 v[152:167], v[56:59], v[64:67], v[152:167]
    v_mfma_f32_32x32x16_bf16 v[168:183], v[56:59], v[72:75], v[168:183]
    v_mfma_f32_32x32x16_bf16 v[184:199], v[56:59], v[80:83], v[184:199]
    v_mfma_f32_32x32x16_bf16 v[200:215], v[56:59], v[88:91], v[200:215]
    v_mfma_f32_32x32x16_bf16 v[216:231], v[56:59], v[96:99], v[216:231]
    v_mfma_f32_32x32x16_bf16 v[152:167], v[60:63], v[68:71], v[152:167]
    v_mfma_f32_32x32x16_bf16 v[168:183], v[60:63], v[76:79], v[168:183]
    v_mfma_f32_32x32x16_bf16 v[184:199], v[60:63], v[84:87], v[184:199]
    v_mfma_f32_32x32x16_bf16 v[200:215], v[60:63], v[92:95], v[200:215]
    v_mfma_f32_32x32x16_bf16 v[216:231], v[60:63], v[100:103], v[216:231]
    s_waitcnt vmcnt(5)
    s_barrier
    v_add_u32 v20, s65, v15
    v_add_u32 v21, s65, v16
    v_add_u32 v22, s65, v17
    v_add_u32 v23, s65, v18
    v_add_u32 v24, s65, v19
    ds_read_b64_tr_b16 v[112:113], v20 offset:0
    ds_read_b64_tr_b16 v[114:115], v20 offset:512
    ds_read_b64_tr_b16 v[120:121], v21 offset:0
    ds_read_b64_tr_b16 v[122:123], v21 offset:512
    ds_read_b64_tr_b16 v[128:129], v22 offset:0
    ds_read_b64_tr_b16 v[130:131], v22 offset:512
    ds_read_b64_tr_b16 v[136:137], v23 offset:0
    ds_read_b64_tr_b16 v[138:139], v23 offset:512
    ds_read_b64_tr_b16 v[144:145], v24 offset:0
    ds_read_b64_tr_b16 v[146:147], v24 offset:512
    ds_read_b128 v[104:107], v13 offset:0
    ds_read_b64_tr_b16 v[116:117], v20 offset:2048
    ds_read_b64_tr_b16 v[118:119], v20 offset:2560
    ds_read_b64_tr_b16 v[124:125], v21 offset:2048
    ds_read_b64_tr_b16 v[126:127], v21 offset:2560
    ds_read_b64_tr_b16 v[132:133], v22 offset:2048
    ds_read_b64_tr_b16 v[134:135], v22 offset:2560
    ds_read_b64_tr_b16 v[140:141], v23 offset:2048
    ds_read_b64_tr_b16 v[142:143], v23 offset:2560
    ds_read_b64_tr_b16 v[148:149], v24 offset:2048
    ds_read_b64_tr_b16 v[150:151], v24 offset:2560
    ds_read_b128 v[108:111], v14 offset:0
    s_add_u32 s65, s65, 24576
    s_cmp_eq_u32 s65, 155648
    s_cselect_b32 s65, 32768, s65
    s_add_u32 m0, s64, 0
    s_nop 0
    buffer_load_dwordx4 v8, s[40:43], s60 offen offset:0 lds
    s_add_u32 m0, s64, 3968
    s_nop 0
    buffer_load_dwordx4 v8, s[40:43], s60 offen offset:128 lds
    s_add_u32 m0, s64, 6912
    s_nop 0
    buffer_load_dwordx4 v10, s[40:43], s60 offen offset:1280 lds
    s_add_u32 m0, s64, 10880
    s_nop 0
    buffer_load_dwordx4 v10, s[40:43], s60 offen offset:1408 lds
    s_add_u32 m0, s64, 16384
    s_nop 0
    buffer_load_dwordx4 v9, s[40:43], s60 offen offset:0 lds
    s_add_u32 s64, s64, 49152
    s_cmp_ge_u32 s64, s74
    s_cselect_b32 s70, 122880, 0
    s_sub_u32 s64, s64, s70
    s_add_u32 s60, s60, 245760
    s_cmp_ge_u32 s60, 2457600
    s_cselect_b32 s70, 2457600, 0
    s_sub_u32 s60, s60, s70
    s_waitcnt lgkmcnt(0)
    v_mfma_f32_32x32x16_bf16 v[152:167], v[104:107], v[112:115], v[152:167]
    v_mfma_f32_32x32x16_bf16 v[168:183], v[104:107], v[120:123], v[168:183]
    v_mfma_f32_32x32x16_bf16 v[184:199], v[104:107], v[128:131], v[184:199]
    v_mfma_f32_32x32x16_bf16 v[200:215], v[104:107], v[136:139], v[200:215]
    v_mfma_f32_32x32x16_bf16 v[216:231], v[104:107], v[144:147], v[216:231]
    v_mfma_f32_32x32x16_bf16 v[152:167], v[108:111], v[116:119], v[152:167]
    v_mfma_f32_32x32x16_bf16 v[168:183], v[108:111], v[124:127], v[168:183]
    v_mfma_f32_32x32x16_bf16 v[184:199], v[108:111], v[132:135], v[184:199]
    v_mfma_f32_32x32x16_bf16 v[200:215], v[108:111], v[140:143], v[200:215]
    v_mfma_f32_32x32x16_bf16 v[216:231], v[108:111], v[148:151], v[216:231]
    s_waitcnt vmcnt(0)
    s_barrier
    s_add_u32 m0, s66, 0
    s_add_u32 s70, s62, 20480
    buffer_load_dwordx4 v6, s[36:39], s62 offen lds
    s_add_u32 m0, s66, 1024
    s_add_u32 s70, s62, 20480
    buffer_load_dwordx4 v7, s[36:39], s62 offen lds
    s_add_u32 m0, s66, 2048
    s_add_u32 s70, s62, 20480
    buffer_load_dwordx4 v6, s[36:39], s70 offen lds
    s_add_u32 m0, s66, 3072
    s_add_u32 s70, s62, 20480
    buffer_load_dwordx4 v7, s[36:39], s70 offen lds
    s_xor_b32 s66, s66, 16384
    s_add_u32 s62, s62, 128
    s_cmp_eq_u32 s62, 1280
    s_cselect_b32 s62, 0, s62
    s_add_u32 m0, s64, 0
    s_nop 0
    buffer_load_dwordx4 v8, s[40:43], s60 offen offset:0 lds
    s_add_u32 m0, s64, 3968
    s_nop 0
    buffer_load_dwordx4 v8, s[40:43], s60 offen offset:128 lds
    s_add_u32 m0, s64, 6912
    s_nop 0
    buffer_load_dwordx4 v10, s[40:43], s60 offen offset:1280 lds
    s_add_u32 m0, s64, 10880
    s_nop 0
    buffer_load_dwordx4 v10, s[40:43], s60 offen offset:1408 lds
    s_add_u32 m0, s64, 16384
    s_nop 0
    buffer_load_dwordx4 v9, s[40:43], s60 offen offset:0 lds
    s_add_u32 s64, s64, 49152
    s_cmp_ge_u32 s64, s74
    s_cselect_b32 s70, 122880, 0
    s_sub_u32 s64, s64, s70
    s_add_u32 s60, s60, 245760
    s_cmp_ge_u32 s60, 2457600
    s_cselect_b32 s70, 2457600, 0
    s_sub_u32 s60, s60, s70
    v_xor_b32 v11, 16384, v11
    v_xor_b32 v12, 16384, v12
    v_xor_b32 v13, 16384, v13
    v_xor_b32 v14, 16384, v14
    v_add_u32 v20, s65, v15
    v_add_u32 v21, s65, v16
    v_add_u32 v22, s65, v17
    v_add_u32 v23, s65, v18
    v_add_u32 v24, s65, v19
    ds_read_b64_tr_b16 v[64:65], v20 offset:0
    ds_read_b64_tr_b16 v[66:67], v20 offset:512
    ds_read_b64_tr_b16 v[72:73], v21 offset:0
    ds_read_b64_tr_b16 v[74:75], v21 offset:512
    ds_read_b64_tr_b16 v[80:81], v22 offset:0
    ds_read_b64_tr_b16 v[82:83], v22 offset:512
    ds_read_b64_tr_b16 v[88:89], v23 offset:0
    ds_read_b64_tr_b16 v[90:91], v23 offset:512
    ds_read_b64_tr_b16 v[96:97], v24 offset:0
    ds_read_b64_tr_b16 v[98:99], v24 offset:512
    ds_read_b128 v[56:59], v11 offset:0
    ds_read_b64_tr_b16 v[68:69], v20 offset:2048
    ds_read_b64_tr_b16 v[70:71], v20 offset:2560
    ds_read_b64_tr_b16 v[76:77], v21 offset:2048
    ds_read_b64_tr_b16 v[78:79], v21 offset:2560
    ds_read_b64_tr_b16 v[84:85], v22 offset:2048
    ds_read_b64_tr_b16 v[86:87], v22 offset:2560
    ds_read_b64_tr_b16 v[92:93], v23 offset:2048
    ds_read_b64_tr_b16 v[94:95], v23 offset:2560
    ds_read_b64_tr_b16 v[100:101], v24 offset:2048
    ds_read_b64_tr_b16 v[102:103], v24 offset:2560
    ds_read_b128 v[60:63], v12 offset:0
    s_add_u32 s65, s65, 24576
    s_cmp_eq_u32 s65, 155648
    s_cselect_b32 s65, 32768, s65
    s_mov_b32 s59, 1
    s_waitcnt lgkmcnt(0)
.p2align 6
L_KB_loop:
    v_mfma_f32_32x32x16_bf16 v[152:167], v[56:59], v[64:67], v[152:167]
    v_add_u32 v20, s65, v15
    v_add_u32 v21, s65, v16
    v_add_u32 v22, s65, v17
    v_add_u32 v23, s65, v18
    v_add_u32 v24, s65, v19
    v_mfma_f32_32x32x16_bf16 v[168:183], v[56:59], v[72:75], v[168:183]
    ds_read_b64_tr_b16 v[112:113], v20 offset:0
    ds_read_b64_tr_b16 v[114:115], v20 offset:512
    ds_read_b64_tr_b16 v[120:121], v21 offset:0
    ds_read_b64_tr_b16 v[122:123], v21 offset:512
    v_mfma_f32_32x32x16_bf16 v[184:199], v[56:59], v[80:83], v[184:199]
    ds_read_b64_tr_b16 v[128:129], v22 offset:0
    ds_read_b64_tr_b16 v[130:131], v22 offset:512
    ds_read_b64_tr_b16 v[136:137], v23 offset:0
    ds_read_b64_tr_b16 v[138:139], v23 offset:512
    v_mfma_f32_32x32x16_bf16 v[200:215], v[56:59], v[88:91], v[200:215]
    ds_read_b64_tr_b16 v[144:145], v24 offset:0
    ds_read_b64_tr_b16 v[146:147], v24 offset:512
    ds_read_b128 v[104:107], v13 offset:0
    v_mfma_f32_32x32x16_bf16 v[216:231], v[56:59], v[96:99], v[216:231]
    ds_read_b64_tr_b16 v[116:117], v20 offset:2048
    ds_read_b64_tr_b16 v[118:119], v20 offset:2560
    ds_read_b64_tr_b16 v[124:125], v21 offset:2048
    ds_read_b64_tr_b16 v[126:127], v21 offset:2560
    v_mfma_f32_32x32x16_bf16 v[152:167], v[60:63], v[68:71], v[152:167]
    ds_read_b64_tr_b16 v[132:133], v22 offset:2048
    ds_read_b64_tr_b16 v[134:135], v22 offset:2560
    ds_read_b64_tr_b16 v[140:141], v23 offset:2048
    ds_read_b64_tr_b16 v[142:143], v23 offset:2560
    v_mfma_f32_32x32x16_bf16 v[168:183], v[60:63], v[76:79], v[168:183]
    ds_read_b64_tr_b16 v[148:149], v24 offset:2048
    ds_read_b64_tr_b16 v[150:151], v24 offset:2560
    ds_read_b128 v[108:111], v14 offset:0
    v_mfma_f32_32x32x16_bf16 v[184:199], v[60:63], v[84:87], v[184:199]
    v_mfma_f32_32x32x16_bf16 v[200:215], v[60:63], v[92:95], v[200:215]
    s_add_u32 s65, s65, 24576
    s_cmp_eq_u32 s65, 155648
    s_cselect_b32 s65, 32768, s65
    v_mfma_f32_32x32x16_bf16 v[216:231], v[60:63], v[100:103], v[216:231]
    s_waitcnt vmcnt(0) lgkmcnt(0)
    s_barrier
    s_cmp_ge_u32 s59, 8
    s_cbranch_scc1 L_KB_nod
    s_add_u32 m0, s66, 0
    s_add_u32 s70, s62, 20480
    buffer_load_dwordx4 v6, s[36:39], s62 offen lds
    s_add_u32 m0, s66, 1024
    s_add_u32 s70, s62, 20480
    buffer_load_dwordx4 v7, s[36:39], s62 offen lds
    s_add_u32 m0, s66, 2048
    s_add_u32 s70, s62, 20480
    buffer_load_dwordx4 v6, s[36:39], s70 offen lds
    s_add_u32 m0, s66, 3072
    s_add_u32 s70, s62, 20480
    buffer_load_dwordx4 v7, s[36:39], s70 offen lds
    s_xor_b32 s66, s66, 16384
    s_add_u32 s62, s62, 128
    s_cmp_eq_u32 s62, 1280
    s_cselect_b32 s62, 0, s62
    s_add_u32 m0, s64, 0
    s_nop 0
    buffer_load_dwordx4 v8, s[40:43], s60 offen offset:0 lds
    s_add_u32 m0, s64, 3968
    s_nop 0
    buffer_load_dwordx4 v8, s[40:43], s60 offen offset:128 lds
    s_add_u32 m0, s64, 6912
    s_nop 0
    buffer_load_dwordx4 v10, s[40:43], s60 offen offset:1280 lds
    s_add_u32 m0, s64, 10880
    s_nop 0
    buffer_load_dwordx4 v10, s[40:43], s60 offen offset:1408 lds
    s_add_u32 m0, s64, 16384
    s_nop 0
    buffer_load_dwordx4 v9, s[40:43], s60 offen offset:0 lds
    s_add_u32 s64, s64, 49152
    s_cmp_ge_u32 s64, s74
    s_cselect_b32 s70, 122880, 0
    s_sub_u32 s64, s64, s70
    s_add_u32 s60, s60, 245760
    s_cmp_ge_u32 s60, 2457600
    s_cselect_b32 s70, 2457600, 0
    s_sub_u32 s60, s60, s70
    v_mfma_f32_32x32x16_bf16 v[152:167], v[104:107], v[112:115], v[152:167]
    v_xor_b32 v11, 16384, v11
    v_xor_b32 v12, 16384, v12
    v_add_u32 v20, s65, v15
    v_add_u32 v21, s65, v16
    v_add_u32 v22, s65, v17
    v_add_u32 v23, s65, v18
    v_add_u32 v24, s65, v19
    v_mfma_f32_32x32x16_bf16 v[168:183], v[104:107], v[120:123], v[168:183]
    ds_read_b64_tr_b16 v[64:65], v20 offset:0
    ds_read_b64_tr_b16 v[66:67], v20 offset:512
    ds_read_b64_tr_b16 v[72:73], v21 offset:0
    ds_read_b64_tr_b16 v[74:75], v21 offset:512
    v_mfma_f32_32x32x16_bf16 v[184:199], v[104:107], v[128:131], v[184:199]
    ds_read_b64_tr_b16 v[80:81], v22 offset:0
    ds_read_b64_tr_b16 v[82:83], v22 offset:512
    ds_read_b64_tr_b16 v[88:89], v23 offset:0
    ds_read_b64_tr_b16 v[90:91], v23 offset:512
    v_mfma_f32_32x32x16_bf16 v[200:215], v[104:107], v[136:139], v[200:215]
    ds_read_b64_tr_b16 v[96:97], v24 offset:0
    ds_read_b64_tr_b16 v[98:99], v24 offset:512
    ds_read_b128 v[56:59], v11 offset:0
    v_mfma_f32_32x32x16_bf16 v[216:231], v[104:107], v[144:147], v[216:231]
    ds_read_b64_tr_b16 v[68:69], v20 offset:2048
    ds_read_b64_tr_b16 v[70:71], v20 offset:2560
    ds_read_b64_tr_b16 v[76:77], v21 offset:2048
    ds_read_b64_tr_b16 v[78:79], v21 offset:2560
    v_mfma_f32_32x32x16_bf16 v[152:167], v[108:111], v[116:119], v[152:167]
    ds_read_b64_tr_b16 v[84:85], v22 offset:2048
    ds_read_b64_tr_b16 v[86:87], v22 offset:2560
    ds_read_b64_tr_b16 v[92:93], v23 offset:2048
    ds_read_b64_tr_b16 v[94:95], v23 offset:2560
    v_mfma_f32_32x32x16_bf16 v[168:183], v[108:111], v[124:127], v[168:183]
    ds_read_b64_tr_b16 v[100:101], v24 offset:2048
    ds_read_b64_tr_b16 v[102:103], v24 offset:2560
    ds_read_b128 v[60:63], v12 offset:0
    v_mfma_f32_32x32x16_bf16 v[184:199], v[108:111], v[132:135], v[184:199]
    s_add_u32 s65, s65, 24576
    s_cmp_eq_u32 s65, 155648
    s_cselect_b32 s65, 32768, s65
    v_xor_b32 v13, 16384, v13
    v_xor_b32 v14, 16384, v14
    v_mfma_f32_32x32x16_bf16 v[200:215], v[108:111], v[140:143], v[200:215]
    s_add_u32 s59, s59, 1
    s_cmp_lt_u32 s59, 10
    v_mfma_f32_32x32x16_bf16 v[216:231], v[108:111], v[148:151], v[216:231]
L_KB_end:
    s_waitcnt lgkmcnt(0)
    s_cbranch_scc1 L_KB_loop
    s_branch L_K_epi
L_KB_nod:
    s_cmp_eq_u32 s59, 9
    s_cbranch_scc1 L_KB_nod9
    s_lshr_b32 s4, s2, 3
    s_and_b32 s4, s4, 7
    s_mul_i32 s4, s4, 378880
    s_and_b32 s5, s56, 3
    s_mul_i32 s5, s5, 7168
    s_add_u32 s4, s4, s5
    s_add_u32 s4, s4, 10786816
    s_add_u32 s5, s5, 57344
    v_lshlrev_b32 v2, 4, v1
    s_add_u32 m0, s5, 0
    s_add_u32 s6, s4, 0
    buffer_load_dwordx4 v2, s[44:47], s6 offen offset:0 sc1 lds
    buffer_load_dwordx4 v2, s[44:47], s6 offen offset:1024 sc1 lds
    buffer_load_dwordx4 v2, s[44:47], s6 offen offset:2048 sc1 lds
    buffer_load_dwordx4 v2, s[44:47], s6 offen offset:3072 sc1 lds
    s_add_u32 m0, s5, 4096
    s_add_u32 s6, s4, 4096
    buffer_load_dwordx4 v2, s[44:47], s6 offen offset:0 sc1 lds
    buffer_load_dwordx4 v2, s[44:47], s6 offen offset:1024 sc1 lds
    buffer_load_dwordx4 v2, s[44:47], s6 offen offset:2048 sc1 lds
    s_branch L_KB_nod2
L_KB_nod9:
    s_lshr_b32 s4, s2, 3
    s_and_b32 s4, s4, 7
    s_mul_i32 s4, s4, 378880
    s_and_b32 s5, s56, 3
    s_mul_i32 s5, s5, 7168
    s_add_u32 s4, s4, s5
    s_add_u32 s4, s4, 10835968
    s_add_u32 s5, s5, 106496
    v_lshlrev_b32 v2, 4, v1
    s_add_u32 m0, s5, 0
    s_add_u32 s6, s4, 0
    buffer_load_dwordx4 v2, s[44:47], s6 offen offset:0 sc1 lds
    buffer_load_dwordx4 v2, s[44:47], s6 offen offset:1024 sc1 lds
    buffer_load_dwordx4 v2, s[44:47], s6 offen offset:2048 sc1 lds
    buffer_load_dwordx4 v2, s[44:47], s6 offen offset:3072 sc1 lds
    s_add_u32 m0, s5, 4096
    s_add_u32 s6, s4, 4096
    buffer_load_dwordx4 v2, s[44:47], s6 offen offset:0 sc1 lds
    buffer_load_dwordx4 v2, s[44:47], s6 offen offset:1024 sc1 lds
    buffer_load_dwordx4 v2, s[44:47], s6 offen offset:2048 sc1 lds
L_KB_nod2:
    v_mfma_f32_32x32x16_bf16 v[152:167], v[104:107], v[112:115], v[152:167]
    v_xor_b32 v11, 16384, v11
    v_xor_b32 v12, 16384, v12
    v_add_u32 v20, s65, v15
    v_add_u32 v21, s65, v16
    v_add_u32 v22, s65, v17
    v_add_u32 v23, s65, v18
    v_add_u32 v24, s65, v19
    v_mfma_f32_32x32x16_bf16 v[168:183], v[104:107], v[120:123], v[168:183]
    ds_read_b64_tr_b16 v[64:65], v20 offset:0
    ds_read_b64_tr_b16 v[66:67], v20 offset:512
    ds_read_b64_tr_b16 v[72:73], v21 offset:0
    ds_read_b64_tr_b16 v[74:75], v21 offset:512
    v_mfma_f32_32x32x16_bf16 v[184:199], v[104:107], v[128:131], v[184:199]
    ds_read_b64_tr_b16 v[80:81], v22 offset:0
    ds_read_b64_tr_b16 v[82:83], v22 offset:512
    ds_read_b64_tr_b16 v[88:89], v23 offset:0
    ds_read_b64_tr_b16 v[90:91], v23 offset:512
    v_mfma_f32_32x32x16_bf16 v[200:215], v[104:107], v[136:139], v[200:215]
    ds_read_b64_tr_b16 v[96:97], v24 offset:0
    ds_read_b64_tr_b16 v[98:99], v24 offset:512
    ds_read_b128 v[56:59], v11 offset:0
    v_mfma_f32_32x32x16_bf16 v[216:231], v[104:107], v[144:147], v[216:231]
    ds_read_b64_tr_b16 v[68:69], v20 offset:2048
    ds_read_b64_tr_b16 v[70:71], v20 offset:2560
    ds_read_b64_tr_b16 v[76:77], v21 offset:2048
    ds_read_b64_tr_b16 v[78:79], v21 offset:2560
    v_mfma_f32_32x32x16_bf16 v[152:167], v[108:111], v[116:119], v[152:167]
    ds_read_b64_tr_b16 v[84:85], v22 offset:2048
    ds_read_b64_tr_b16 v[86:87], v22 offset:2560
    ds_read_b64_tr_b16 v[92:93], v23 offset:2048
    ds_read_b64_tr_b16 v[94:95], v23 offset:2560
    v_mfma_f32_32x32x16_bf16 v[168:183], v[108:111], v[124:127], v[168:183]
    ds_read_b64_tr_b16 v[100:101], v24 offset:2048
    ds_read_b64_tr_b16 v[102:103], v24 offset:2560
    ds_read_b128 v[60:63], v12 offset:0
    v_mfma_f32_32x32x16_bf16 v[184:199], v[108:111], v[132:135], v[184:199]
    s_add_u32 s65, s65, 24576
    s_cmp_eq_u32 s65, 155648
    s_cselect_b32 s65, 32768, s65
    v_xor_b32 v13, 16384, v13
    v_xor_b32 v14, 16384, v14
    v_mfma_f32_32x32x16_bf16 v[200:215], v[108:111], v[140:143], v[200:215]
    s_add_u32 s59, s59, 1
    s_cmp_lt_u32 s59, 10
    v_mfma_f32_32x32x16_bf16 v[216:231], v[108:111], v[148:151], v[216:231]
    s_branch L_KB_end
L_K_epi:
    s_setprio 0
    v_lshlrev_b32 v5, 4, v1
    v_and_b32 v2, 31, v1
    v_cmp_gt_u32 vcc, 16, v2
    v_lshlrev_b32 v2, 2, v2
    s_mul_i32 s70, s73, 640
    s_add_u32 s70, s70, 155648
    v_add_u32 v3, s70, v2
    v_lshrrev_b32 v4, 5, v1
    s_lshl_b32 s70, s72, 7
    s_add_u32 s70, s70, 157696
    buffer_load_dwordx4 v[8:11], v5, s[44:47], s19 offen offset:0 sc1
    v_lshl_add_u32 v4, v4, 4, s70
    ds_read_b32 v48, v3 offset:0
    ds_read_b32 v50, v3 offset:128
    ds_read_b32 v244, v3 offset:256
    ds_read_b32 v250, v3 offset:384
    ds_read_b32 v120, v3 offset:512
    ds_read_b128 v[56:59], v4 offset:0
    ds_read_b128 v[60:63], v4 offset:32
    ds_read_b128 v[64:67], v4 offset:64
    ds_read_b128 v[68:71], v4 offset:96
    ds_read_b128 v[72:75], v4 offset:512
    ds_read_b128 v[76:79], v4 offset:544
    ds_read_b128 v[80:83], v4 offset:576
    ds_read_b128 v[84:87], v4 offset:608
    ds_read_b128 v[88:91], v4 offset:1536
    ds_read_b128 v[92:95], v4 offset:1568
    ds_read_b128 v[96:99], v4 offset:1600
    ds_read_b128 v[100:103], v4 offset:1632
    v_mov_b32 v122, 0x358637bd
    v_mov_b32 v125, 0xff800000
    v_cndmask_b32 v124, 0, v122, vcc
    v_cndmask_b32 v126, v125, v124, vcc
    v_cndmask_b32 v125, v125, v122, vcc
    v_min_f32 v126, 0, v126
    s_waitcnt lgkmcnt(4)
    v_pk_fma_f32 v[200:201], v[56:57], v[250:251], v[200:201] op_sel:[0,0,0] op_sel_hi:[1,0,1] neg_lo:[1,0,0] neg_hi:[1,0,0]
    v_pk_fma_f32 v[202:203], v[58:59], v[250:251], v[202:203] op_sel:[0,0,0] op_sel_hi:[1,0,1] neg_lo:[1,0,0] neg_hi:[1,0,0]
    v_pk_fma_f32 v[204:205], v[60:61], v[250:251], v[204:205] op_sel:[0,0,0] op_sel_hi:[1,0,1] neg_lo:[1,0,0] neg_hi:[1,0,0]
    buffer_load_dwordx4 v[12:15], v5, s[44:47], s19 offen offset:1024 sc1
    v_pk_fma_f32 v[206:207], v[62:63], v[250:251], v[206:207] op_sel:[0,0,0] op_sel_hi:[1,0,1] neg_lo:[1,0,0] neg_hi:[1,0,0]
    v_pk_fma_f32 v[208:209], v[64:65], v[250:251], v[208:209] op_sel:[0,0,0] op_sel_hi:[1,0,1] neg_lo:[1,0,0] neg_hi:[1,0,0]
    v_pk_fma_f32 v[210:211], v[66:67], v[250:251], v[210:211] op_sel:[0,0,0] op_sel_hi:[1,0,1] neg_lo:[1,0,0] neg_hi:[1,0,0]
    v_pk_fma_f32 v[212:213], v[68:69], v[250:251], v[212:213] op_sel:[0,0,0] op_sel_hi:[1,0,1] neg_lo:[1,0,0] neg_hi:[1,0,0]
    v_pk_fma_f32 v[214:215], v[70:71], v[250:251], v[214:215] op_sel:[0,0,0] op_sel_hi:[1,0,1] neg_lo:[1,0,0] neg_hi:[1,0,0]
    v_pk_mul_f32 v[200:201], v[200:201], v[72:73] op_sel:[0,0] op_sel_hi:[1,1]
    v_pk_mul_f32 v[202:203], v[202:203], v[74:75] op_sel:[0,0] op_sel_hi:[1,1]
    v_pk_mul_f32 v[204:205], v[204:205], v[76:77] op_sel:[0,0] op_sel_hi:[1,1]
    v_pk_mul_f32 v[206:207], v[206:207], v[78:79] op_sel:[0,0] op_sel_hi:[1,1]
    v_pk_mul_f32 v[208:209], v[208:209], v[80:81] op_sel:[0,0] op_sel_hi:[1,1]
    v_pk_mul_f32 v[210:211], v[210:211], v[82:83] op_sel:[0,0] op_sel_hi:[1,1]
    v_pk_mul_f32 v[212:213], v[212:213], v[84:85] op_sel:[0,0] op_sel_hi:[1,1]
    v_pk_mul_f32 v[214:215], v[214:215], v[86:87] op_sel:[0,0] op_sel_hi:[1,1]
    v_cvt_pk_bf16_f32 v200, v200, v201
    v_cvt_pk_bf16_f32 v201, v202, v203
    v_cvt_pk_bf16_f32 v202, v204, v205
    v_cvt_pk_bf16_f32 v203, v206, v207
    v_cvt_pk_bf16_f32 v204, v208, v209
    v_cvt_pk_bf16_f32 v205, v210, v211
    v_cvt_pk_bf16_f32 v206, v212, v213
    v_cvt_pk_bf16_f32 v207, v214, v215
    v_pk_fma_f32 v[216:217], v[56:57], v[120:121], v[216:217] op_sel:[0,0,0] op_sel_hi:[1,0,1] neg_lo:[1,0,0] neg_hi:[1,0,0]
    v_pk_fma_f32 v[218:219], v[58:59], v[120:121], v[218:219] op_sel:[0,0,0] op_sel_hi:[1,0,1] neg_lo:[1,0,0] neg_hi:[1,0,0]
    v_pk_fma_f32 v[220:221], v[60:61], v[120:121], v[220:221] op_sel:[0,0,0] op_sel_hi:[1,0,1] neg_lo:[1,0,0] neg_hi:[1,0,0]
    v_pk_fma_f32 v[222:223], v[62:63], v[120:121], v[222:223] op_sel:[0,0,0] op_sel_hi:[1,0,1] neg_lo:[1,0,0] neg_hi:[1,0,0]
    v_pk_fma_f32 v[224:225], v[64:65], v[120:121], v[224:225] op_sel:[0,0,0] op_sel_hi:[1,0,1] neg_lo:[1,0,0] neg_hi:[1,0,0]
    v_pk_fma_f32 v[226:227], v[66:67], v[120:121], v[226:227] op_sel:[0,0,0] op_sel_hi:[1,0,1] neg_lo:[1,0,0] neg_hi:[1,0,0]
    v_pk_fma_f32 v[228:229], v[68:69], v[120:121], v[228:229] op_sel:[0,0,0] op_sel_hi:[1,0,1] neg_lo:[1,0,0] neg_hi:[1,0,0]
    buffer_load_dwordx4 v[16:19], v5, s[44:47], s19 offen offset:2048 sc1
    v_pk_fma_f32 v[230:231], v[70:71], v[120:121], v[230:231] op_sel:[0,0,0] op_sel_hi:[1,0,1] neg_lo:[1,0,0] neg_hi:[1,0,0]
    v_pk_mul_f32 v[216:217], v[216:217], v[72:73] op_sel:[0,0] op_sel_hi:[1,1]
    v_pk_mul_f32 v[218:219], v[218:219], v[74:75] op_sel:[0,0] op_sel_hi:[1,1]
    v_pk_mul_f32 v[220:221], v[220:221], v[76:77] op_sel:[0,0] op_sel_hi:[1,1]
    v_pk_mul_f32 v[222:223], v[222:223], v[78:79] op_sel:[0,0] op_sel_hi:[1,1]
    v_pk_mul_f32 v[224:225], v[224:225], v[80:81] op_sel:[0,0] op_sel_hi:[1,1]
    v_pk_mul_f32 v[226:227], v[226:227], v[82:83] op_sel:[0,0] op_sel_hi:[1,1]
    v_pk_mul_f32 v[228:229], v[228:229], v[84:85] op_sel:[0,0] op_sel_hi:[1,1]
    v_pk_mul_f32 v[230:231], v[230:231], v[86:87] op_sel:[0,0] op_sel_hi:[1,1]
    v_cvt_pk_bf16_f32 v216, v216, v217
    v_cvt_pk_bf16_f32 v217, v218, v219
    v_cvt_pk_bf16_f32 v218, v220, v221
    v_cvt_pk_bf16_f32 v219, v222, v223
    v_cvt_pk_bf16_f32 v220, v224, v225
    v_cvt_pk_bf16_f32 v221, v226, v227
    v_cvt_pk_bf16_f32 v222, v228, v229
    v_cvt_pk_bf16_f32 v223, v230, v231
    s_waitcnt lgkmcnt(0)
    v_pk_fma_f32 v[184:185], v[56:57], v[244:245], v[184:185] op_sel:[0,0,0] op_sel_hi:[1,0,1] neg_lo:[1,0,0] neg_hi:[1,0,0]
    v_pk_fma_f32 v[186:187], v[58:59], v[244:245], v[186:187] op_sel:[0,0,0] op_sel_hi:[1,0,1] neg_lo:[1,0,0] neg_hi:[1,0,0]
    v_pk_fma_f32 v[188:189], v[60:61], v[244:245], v[188:189] op_sel:[0,0,0] op_sel_hi:[1,0,1] neg_lo:[1,0,0] neg_hi:[1,0,0]
    v_pk_fma_f32 v[190:191], v[62:63], v[244:245], v[190:191] op_sel:[0,0,0] op_sel_hi:[1,0,1] neg_lo:[1,0,0] neg_hi:[1,0,0]
    v_pk_fma_f32 v[192:193], v[64:65], v[244:245], v[192:193] op_sel:[0,0,0] op_sel_hi:[1,0,1] neg_lo:[1,0,0] neg_hi:[1,0,0]
    v_pk_fma_f32 v[194:195], v[66:67], v[244:245], v[194:195] op_sel:[0,0,0] op_sel_hi:[1,0,1] neg_lo:[1,0,0] neg_hi:[1,0,0]
    v_pk_fma_f32 v[196:197], v[68:69], v[244:245], v[196:197] op_sel:[0,0,0] op_sel_hi:[1,0,1] neg_lo:[1,0,0] neg_hi:[1,0,0]
    v_pk_fma_f32 v[198:199], v[70:71], v[244:245], v[198:199] op_sel:[0,0,0] op_sel_hi:[1,0,1] neg_lo:[1,0,0] neg_hi:[1,0,0]
    v_pk_fma_f32 v[104:105], v[184:185], v[88:89], v[126:127] op_sel:[0,0,0] op_sel_hi:[1,1,0]
    v_pk_fma_f32 v[106:107], v[186:187], v[90:91], v[126:127] op_sel:[0,0,0] op_sel_hi:[1,1,0]
    buffer_load_dwordx4 v[20:23], v5, s[44:47], s19 offen offset:3072 sc1
    v_pk_fma_f32 v[108:109], v[188:189], v[92:93], v[126:127] op_sel:[0,0,0] op_sel_hi:[1,1,0]
    v_pk_fma_f32 v[110:111], v[190:191], v[94:95], v[126:127] op_sel:[0,0,0] op_sel_hi:[1,1,0]
    v_pk_fma_f32 v[112:113], v[192:193], v[96:97], v[126:127] op_sel:[0,0,0] op_sel_hi:[1,1,0]
    v_pk_fma_f32 v[114:115], v[194:195], v[98:99], v[126:127] op_sel:[0,0,0] op_sel_hi:[1,1,0]
    v_pk_fma_f32 v[116:117], v[196:197], v[100:101], v[126:127] op_sel:[0,0,0] op_sel_hi:[1,1,0]
    v_pk_fma_f32 v[118:119], v[198:199], v[102:103], v[126:127] op_sel:[0,0,0] op_sel_hi:[1,1,0]
    v_exp_f32 v104, v104 clamp
    v_exp_f32 v105, v105 clamp
    v_pk_fma_f32 v[184:185], v[184:185], v[72:73], v[124:125] op_sel:[0,0,0] op_sel_hi:[1,1,0]
    v_exp_f32 v106, v106 clamp
    v_exp_f32 v107, v107 clamp
    v_pk_fma_f32 v[186:187], v[186:187], v[74:75], v[124:125] op_sel:[0,0,0] op_sel_hi:[1,1,0]
    v_exp_f32 v108, v108 clamp
    v_exp_f32 v109, v109 clamp
    v_pk_fma_f32 v[188:189], v[188:189], v[76:77], v[124:125] op_sel:[0,0,0] op_sel_hi:[1,1,0]
    v_exp_f32 v110, v110 clamp
    v_exp_f32 v111, v111 clamp
    v_pk_fma_f32 v[190:191], v[190:191], v[78:79], v[124:125] op_sel:[0,0,0] op_sel_hi:[1,1,0]
    v_exp_f32 v112, v112 clamp
    v_exp_f32 v113, v113 clamp
    v_pk_fma_f32 v[192:193], v[192:193], v[80:81], v[124:125] op_sel:[0,0,0] op_sel_hi:[1,1,0]
    v_exp_f32 v114, v114 clamp
    v_exp_f32 v115, v115 clamp
    v_pk_fma_f32 v[194:195], v[194:195], v[82:83], v[124:125] op_sel:[0,0,0] op_sel_hi:[1,1,0]
    v_exp_f32 v116, v116 clamp
    v_exp_f32 v117, v117 clamp
    v_pk_fma_f32 v[196:197], v[196:197], v[84:85], v[124:125] op_sel:[0,0,0] op_sel_hi:[1,1,0]
    v_exp_f32 v118, v118 clamp
    s_add_u32 s3, s19, 4096
    buffer_load_dwordx4 v[24:27], v5, s[44:47], s3 offen sc1
    s_add_u32 s19, s19, 5120
    s_cmp_eq_u32 s19, s25
    s_cselect_b32 s19, s24, s19
    v_exp_f32 v119, v119 clamp
    v_pk_fma_f32 v[198:199], v[198:199], v[86:87], v[124:125] op_sel:[0,0,0] op_sel_hi:[1,1,0]
    v_max_f32 v184, v184, v125
    v_max_f32 v185, v185, v125
    v_max_f32 v186, v186, v125
    v_max_f32 v187, v187, v125
    v_max_f32 v188, v188, v125
    v_max_f32 v189, v189, v125
    v_max_f32 v190, v190, v125
    v_max_f32 v191, v191, v125
    v_max_f32 v192, v192, v125
    v_max_f32 v193, v193, v125
    v_max_f32 v194, v194, v125
    v_max_f32 v195, v195, v125
    v_max_f32 v196, v196, v125
    v_max_f32 v197, v197, v125
    v_max_f32 v198, v198, v125
    v_max_f32 v199, v199, v125
    v_pk_add_f32 v[184:185], v[184:185], v[104:105] op_sel:[0,0] op_sel_hi:[1,1]
    v_pk_add_f32 v[186:187], v[186:187], v[106:107] op_sel:[0,0] op_sel_hi:[1,1]
    v_pk_add_f32 v[188:189], v[188:189], v[108:109] op_sel:[0,0] op_sel_hi:[1,1]
    v_pk_add_f32 v[190:191], v[190:191], v[110:111] op_sel:[0,0] op_sel_hi:[1,1]
    v_pk_add_f32 v[192:193], v[192:193], v[112:113] op_sel:[0,0] op_sel_hi:[1,1]
    v_pk_add_f32 v[194:195], v[194:195], v[114:115] op_sel:[0,0] op_sel_hi:[1,1]
    v_pk_add_f32 v[196:197], v[196:197], v[116:117] op_sel:[0,0] op_sel_hi:[1,1]
    v_pk_add_f32 v[198:199], v[198:199], v[118:119] op_sel:[0,0] op_sel_hi:[1,1]
    v_cvt_pk_bf16_f32 v184, v184, v185
    v_cvt_pk_bf16_f32 v185, v186, v187
    buffer_load_dwordx4 v[28:31], v5, s[44:47], s19 offen offset:0 sc1
    v_cvt_pk_bf16_f32 v186, v188, v189
    v_cvt_pk_bf16_f32 v187, v190, v191
    v_cvt_pk_bf16_f32 v188, v192, v193
    v_cvt_pk_bf16_f32 v189, v194, v195
    v_cvt_pk_bf16_f32 v190, v196, v197
    v_cvt_pk_bf16_f32 v191, v198, v199
    v_pk_fma_f32 v[152:153], v[56:57], v[48:49], v[152:153] op_sel:[0,0,0] op_sel_hi:[1,0,1] neg_lo:[1,0,0] neg_hi:[1,0,0]
    v_pk_fma_f32 v[154:155], v[58:59], v[48:49], v[154:155] op_sel:[0,0,0] op_sel_hi:[1,0,1] neg_lo:[1,0,0] neg_hi:[1,0,0]
    v_pk_fma_f32 v[156:157], v[60:61], v[48:49], v[156:157] op_sel:[0,0,0] op_sel_hi:[1,0,1] neg_lo:[1,0,0] neg_hi:[1,0,0]
    v_pk_fma_f32 v[158:159], v[62:63], v[48:49], v[158:159] op_sel:[0,0,0] op_sel_hi:[1,0,1] neg_lo:[1,0,0] neg_hi:[1,0,0]
    v_pk_fma_f32 v[160:161], v[64:65], v[48:49], v[160:161] op_sel:[0,0,0] op_sel_hi:[1,0,1] neg_lo:[1,0,0] neg_hi:[1,0,0]
    v_pk_fma_f32 v[162:163], v[66:67], v[48:49], v[162:163] op_sel:[0,0,0] op_sel_hi:[1,0,1] neg_lo:[1,0,0] neg_hi:[1,0,0]
    v_pk_fma_f32 v[164:165], v[68:69], v[48:49], v[164:165] op_sel:[0,0,0] op_sel_hi:[1,0,1] neg_lo:[1,0,0] neg_hi:[1,0,0]
    v_pk_fma_f32 v[166:167], v[70:71], v[48:49], v[166:167] op_sel:[0,0,0] op_sel_hi:[1,0,1] neg_lo:[1,0,0] neg_hi:[1,0,0]
    v_pk_mul_f32 v[104:105], v[152:153], v[88:89] op_sel:[0,0] op_sel_hi:[1,1]
    v_pk_mul_f32 v[106:107], v[154:155], v[90:91] op_sel:[0,0] op_sel_hi:[1,1]
    v_pk_mul_f32 v[108:109], v[156:157], v[92:93] op_sel:[0,0] op_sel_hi:[1,1]
    v_pk_mul_f32 v[110:111], v[158:159], v[94:95] op_sel:[0,0] op_sel_hi:[1,1]
    v_pk_mul_f32 v[112:113], v[160:161], v[96:97] op_sel:[0,0] op_sel_hi:[1,1]
    v_pk_mul_f32 v[114:115], v[162:163], v[98:99] op_sel:[0,0] op_sel_hi:[1,1]
    v_pk_mul_f32 v[116:117], v[164:165], v[100:101] op_sel:[0,0] op_sel_hi:[1,1]
    v_pk_mul_f32 v[118:119], v[166:167], v[102:103] op_sel:[0,0] op_sel_hi:[1,1]
    v_exp_f32 v104, v104 clamp
    v_exp_f32 v105, v105 clamp
    v_pk_fma_f32 v[152:153], v[152:153], v[72:73], v[122:123] op_sel:[0,0,0] op_sel_hi:[1,1,0]
    v_exp_f32 v106, v106 clamp
    v_exp_f32 v107, v107 clamp
    v_pk_fma_f32 v[154:155], v[154:155], v[74:75], v[122:123] op_sel:[0,0,0] op_sel_hi:[1,1,0]
    buffer_load_dwordx4 v[32:35], v5, s[44:47], s19 offen offset:1024 sc1
    v_exp_f32 v108, v108 clamp
    v_exp_f32 v109, v109 clamp
    v_pk_fma_f32 v[156:157], v[156:157], v[76:77], v[122:123] op_sel:[0,0,0] op_sel_hi:[1,1,0]
    v_exp_f32 v110, v110 clamp
    v_exp_f32 v111, v111 clamp
    v_pk_fma_f32 v[158:159], v[158:159], v[78:79], v[122:123] op_sel:[0,0,0] op_sel_hi:[1,1,0]
    v_exp_f32 v112, v112 clamp
    v_exp_f32 v113, v113 clamp
    v_pk_fma_f32 v[160:161], v[160:161], v[80:81], v[122:123] op_sel:[0,0,0] op_sel_hi:[1,1,0]
    v_exp_f32 v114, v114 clamp
    v_exp_f32 v115, v115 clamp
    v_pk_fma_f32 v[162:163], v[162:163], v[82:83], v[122:123] op_sel:[0,0,0] op_sel_hi:[1,1,0]
    v_exp_f32 v116, v116 clamp
    v_exp_f32 v117, v117 clamp
    v_pk_fma_f32 v[164:165], v[164:165], v[84:85], v[122:123] op_sel:[0,0,0] op_sel_hi:[1,1,0]
    v_exp_f32 v118, v118 clamp
    v_exp_f32 v119, v119 clamp
    v_pk_fma_f32 v[166:167], v[166:167], v[86:87], v[122:123] op_sel:[0,0,0] op_sel_hi:[1,1,0]
    v_max_f32 v152, v152, v122
    v_max_f32 v153, v153, v122
    v_max_f32 v154, v154, v122
    v_max_f32 v155, v155, v122
    v_max_f32 v156, v156, v122
    v_max_f32 v157, v157, v122
    v_max_f32 v158, v158, v122
    v_max_f32 v159, v159, v122
    v_max_f32 v160, v160, v122
    v_max_f32 v161, v161, v122
    buffer_load_dwordx4 v[36:39], v5, s[44:47], s19 offen offset:2048 sc1
    v_max_f32 v162, v162, v122
    v_max_f32 v163, v163, v122
    v_max_f32 v164, v164, v122
    v_max_f32 v165, v165, v122
    v_max_f32 v166, v166, v122
    v_max_f32 v167, v167, v122
    v_pk_add_f32 v[152:153], v[152:153], v[104:105] op_sel:[0,0] op_sel_hi:[1,1]
    v_pk_add_f32 v[154:155], v[154:155], v[106:107] op_sel:[0,0] op_sel_hi:[1,1]
    v_pk_add_f32 v[156:157], v[156:157], v[108:109] op_sel:[0,0] op_sel_hi:[1,1]
    v_pk_add_f32 v[158:159], v[158:159], v[110:111] op_sel:[0,0] op_sel_hi:[1,1]
    v_pk_add_f32 v[160:161], v[160:161], v[112:113] op_sel:[0,0] op_sel_hi:[1,1]
    v_pk_add_f32 v[162:163], v[162:163], v[114:115] op_sel:[0,0] op_sel_hi:[1,1]
    v_pk_add_f32 v[164:165], v[164:165], v[116:117] op_sel:[0,0] op_sel_hi:[1,1]
    v_pk_add_f32 v[166:167], v[166:167], v[118:119] op_sel:[0,0] op_sel_hi:[1,1]
    v_cvt_pk_bf16_f32 v152, v152, v153
    v_cvt_pk_bf16_f32 v153, v154, v155
    v_cvt_pk_bf16_f32 v154, v156, v157
    v_cvt_pk_bf16_f32 v155, v158, v159
    v_cvt_pk_bf16_f32 v156, v160, v161
    v_cvt_pk_bf16_f32 v157, v162, v163
    v_cvt_pk_bf16_f32 v158, v164, v165
    v_cvt_pk_bf16_f32 v159, v166, v167
    v_pk_fma_f32 v[168:169], v[56:57], v[50:51], v[168:169] op_sel:[0,0,0] op_sel_hi:[1,0,1] neg_lo:[1,0,0] neg_hi:[1,0,0]
    v_pk_fma_f32 v[170:171], v[58:59], v[50:51], v[170:171] op_sel:[0,0,0] op_sel_hi:[1,0,1] neg_lo:[1,0,0] neg_hi:[1,0,0]
    v_pk_fma_f32 v[172:173], v[60:61], v[50:51], v[172:173] op_sel:[0,0,0] op_sel_hi:[1,0,1] neg_lo:[1,0,0] neg_hi:[1,0,0]
    v_pk_fma_f32 v[174:175], v[62:63], v[50:51], v[174:175] op_sel:[0,0,0] op_sel_hi:[1,0,1] neg_lo:[1,0,0] neg_hi:[1,0,0]
    v_pk_fma_f32 v[176:177], v[64:65], v[50:51], v[176:177] op_sel:[0,0,0] op_sel_hi:[1,0,1] neg_lo:[1,0,0] neg_hi:[1,0,0]
    v_pk_fma_f32 v[178:179], v[66:67], v[50:51], v[178:179] op_sel:[0,0,0] op_sel_hi:[1,0,1] neg_lo:[1,0,0] neg_hi:[1,0,0]
    buffer_load_dwordx4 v[40:43], v5, s[44:47], s19 offen offset:3072 sc1
    v_pk_fma_f32 v[180:181], v[68:69], v[50:51], v[180:181] op_sel:[0,0,0] op_sel_hi:[1,0,1] neg_lo:[1,0,0] neg_hi:[1,0,0]
    v_pk_fma_f32 v[182:183], v[70:71], v[50:51], v[182:183] op_sel:[0,0,0] op_sel_hi:[1,0,1] neg_lo:[1,0,0] neg_hi:[1,0,0]
    v_pk_mul_f32 v[104:105], v[168:169], v[88:89] op_sel:[0,0] op_sel_hi:[1,1]
    v_pk_mul_f32 v[106:107], v[170:171], v[90:91] op_sel:[0,0] op_sel_hi:[1,1]
    v_pk_mul_f32 v[108:109], v[172:173], v[92:93] op_sel:[0,0] op_sel_hi:[1,1]
    v_pk_mul_f32 v[110:111], v[174:175], v[94:95] op_sel:[0,0] op_sel_hi:[1,1]
    v_pk_mul_f32 v[112:113], v[176:177], v[96:97] op_sel:[0,0] op_sel_hi:[1,1]
    v_pk_mul_f32 v[114:115], v[178:179], v[98:99] op_sel:[0,0] op_sel_hi:[1,1]
    v_pk_mul_f32 v[116:117], v[180:181], v[100:101] op_sel:[0,0] op_sel_hi:[1,1]
    v_pk_mul_f32 v[118:119], v[182:183], v[102:103] op_sel:[0,0] op_sel_hi:[1,1]
    v_exp_f32 v104, v104 clamp
    v_exp_f32 v105, v105 clamp
    v_pk_fma_f32 v[168:169], v[168:169], v[72:73], v[122:123] op_sel:[0,0,0] op_sel_hi:[1,1,0]
    v_exp_f32 v106, v106 clamp
    v_exp_f32 v107, v107 clamp
    v_pk_fma_f32 v[170:171], v[170:171], v[74:75], v[122:123] op_sel:[0,0,0] op_sel_hi:[1,1,0]
    v_exp_f32 v108, v108 clamp
    v_exp_f32 v109, v109 clamp
    v_pk_fma_f32 v[172:173], v[172:173], v[76:77], v[122:123] op_sel:[0,0,0] op_sel_hi:[1,1,0]
    v_exp_f32 v110, v110 clamp
    v_exp_f32 v111, v111 clamp
    v_pk_fma_f32 v[174:175], v[174:175], v[78:79], v[122:123] op_sel:[0,0,0] op_sel_hi:[1,1,0]
    v_exp_f32 v112, v112 clamp
    v_exp_f32 v113, v113 clamp
    v_pk_fma_f32 v[176:177], v[176:177], v[80:81], v[122:123] op_sel:[0,0,0] op_sel_hi:[1,1,0]
    v_exp_f32 v114, v114 clamp
    v_exp_f32 v115, v115 clamp
    v_pk_fma_f32 v[178:179], v[178:179], v[82:83], v[122:123] op_sel:[0,0,0] op_sel_hi:[1,1,0]
    s_add_u32 s3, s19, 4096
    buffer_load_dwordx4 v[44:47], v5, s[44:47], s3 offen sc1
    s_add_u32 s19, s19, 5120
    s_cmp_eq_u32 s19, s25
    s_cselect_b32 s19, s24, s19
    v_exp_f32 v116, v116 clamp
    v_exp_f32 v117, v117 clamp
    v_pk_fma_f32 v[180:181], v[180:181], v[84:85], v[122:123] op_sel:[0,0,0] op_sel_hi:[1,1,0]
    v_exp_f32 v118, v118 clamp
    v_exp_f32 v119, v119 clamp
    v_pk_fma_f32 v[182:183], v[182:183], v[86:87], v[122:123] op_sel:[0,0,0] op_sel_hi:[1,1,0]
    v_max_f32 v168, v168, v122
    v_max_f32 v169, v169, v122
    v_max_f32 v170, v170, v122
    v_max_f32 v171, v171, v122
    v_max_f32 v172, v172, v122
    v_max_f32 v173, v173, v122
    v_max_f32 v174, v174, v122
    v_max_f32 v175, v175, v122
    v_max_f32 v176, v176, v122
    v_max_f32 v177, v177, v122
    v_max_f32 v178, v178, v122
    v_max_f32 v179, v179, v122
    v_max_f32 v180, v180, v122
    v_max_f32 v181, v181, v122
    v_max_f32 v182, v182, v122
    v_max_f32 v183, v183, v122
    v_pk_add_f32 v[168:169], v[168:169], v[104:105] op_sel:[0,0] op_sel_hi:[1,1]
    v_pk_add_f32 v[170:171], v[170:171], v[106:107] op_sel:[0,0] op_sel_hi:[1,1]
    v_pk_add_f32 v[172:173], v[172:173], v[108:109] op_sel:[0,0] op_sel_hi:[1,1]
    v_pk_add_f32 v[174:175], v[174:175], v[110:111] op_sel:[0,0] op_sel_hi:[1,1]
    v_pk_add_f32 v[176:177], v[176:177], v[112:113] op_sel:[0,0] op_sel_hi:[1,1]
    v_pk_add_f32 v[178:179], v[178:179], v[114:115] op_sel:[0,0] op_sel_hi:[1,1]
    v_pk_add_f32 v[180:181], v[180:181], v[116:117] op_sel:[0,0] op_sel_hi:[1,1]
    v_pk_add_f32 v[182:183], v[182:183], v[118:119] op_sel:[0,0] op_sel_hi:[1,1]
    v_cvt_pk_bf16_f32 v168, v168, v169
    v_cvt_pk_bf16_f32 v169, v170, v171
    v_cvt_pk_bf16_f32 v170, v172, v173
    v_cvt_pk_bf16_f32 v171, v174, v175
    v_cvt_pk_bf16_f32 v172, v176, v177
    v_cvt_pk_bf16_f32 v173, v178, v179
    v_cvt_pk_bf16_f32 v174, v180, v181
    v_cvt_pk_bf16_f32 v175, v182, v183
    v_mfma_f32_32x32x16_bf16 v[56:71], v[152:155], v[184:187], 0
    v_mfma_f32_32x32x16_bf16 v[72:87], v[152:155], v[200:203], 0
    v_mfma_f32_32x32x16_bf16 v[88:103], v[168:171], v[200:203], 0
    v_mfma_f32_32x32x16_bf16 v[104:119], v[168:171], v[216:219], 0
    v_mfma_f32_32x32x16_bf16 v[120:135], v[184:187], v[216:219], 0
    v_mfma_f32_16x16x32_bf16 v[136:139], v[152:155], v[52:55], 0
    v_mfma_f32_16x16x32_bf16 v[140:143], v[168:171], v[52:55], 0
    v_mfma_f32_16x16x32_bf16 v[144:147], v[184:187], v[52:55], 0
    v_mfma_f32_32x32x16_bf16 v[56:71], v[156:159], v[188:191], v[56:71]
    v_mfma_f32_32x32x16_bf16 v[72:87], v[156:159], v[204:207], v[72:87]
    v_mfma_f32_32x32x16_bf16 v[88:103], v[172:175], v[204:207], v[88:103]
    v_mfma_f32_32x32x16_bf16 v[104:119], v[172:175], v[220:223], v[104:119]
    v_mfma_f32_32x32x16_bf16 v[120:135], v[188:191], v[220:223], v[120:135]
    v_mfma_f32_16x16x32_bf16 v[136:139], v[156:159], v[52:55], v[136:139]
    v_mfma_f32_16x16x32_bf16 v[140:143], v[172:175], v[52:55], v[140:143]
    v_mfma_f32_16x16x32_bf16 v[144:147], v[188:191], v[52:55], v[144:147]
    s_cmp_lt_u32 s56, 4
    s_cbranch_scc1 L_K_nb1
    s_barrier
L_K_nb1:
    s_nop 3
    ds_write_b128 v232, v[56:59]
    ds_write_b128 v233, v[60:63]
    ds_write_b128 v234, v[64:67]
    ds_write_b128 v236, v[72:75]
    ds_write_b128 v237, v[76:79]
    ds_write_b128 v238, v[80:83]
    ds_write_b128 v239, v[84:87]
    ds_write_b128 v240, v[88:91]
    ds_write_b128 v241, v[92:95]
    ds_write_b128 v242, v[96:99]
    ds_write_b128 v243, v[100:103]
    ds_write_b128 v245, v[108:111]
    ds_write_b128 v246, v[112:115]
    ds_write_b128 v247, v[116:119]
    ds_write_b128 v248, v[120:123]
    ds_write_b128 v249, v[124:127]
    ds_write_b128 v252, v[136:139]
    ds_write_b128 v253, v[140:143]
    ds_write_b128 v254, v[144:147]
    s_sub_u32 s4, s58, 9
    s_mul_i32 s4, s4, 13440
    s_add_u32 s4, s4, 14155776
    v_lshlrev_b32 v2, 2, v0
    v_add_u32 v3, 135168, v2
    v_cmp_gt_u32 vcc, 288, v0
    v_mov_b32 v4, 1073741824
    s_nop 0
    v_cndmask_b32 v4, v4, v2, vcc
    s_waitcnt lgkmcnt(0)
    s_cmp_ge_u32 s56, 4
    s_cbranch_scc1 L_K_nb2
    s_barrier
L_K_nb2:
    s_barrier
    ds_read_b32 v152, v2 offset:0
    ds_read_b32 v153, v2 offset:14336
    ds_read_b32 v154, v3 offset:0
    ds_read_b32 v155, v3 offset:14336
    ds_read_b32 v156, v2 offset:2048
    ds_read_b32 v157, v2 offset:16384
    ds_read_b32 v158, v3 offset:2048
    ds_read_b32 v159, v3 offset:16384
    ds_read_b32 v160, v2 offset:4096
    ds_read_b32 v161, v2 offset:18432
    ds_read_b32 v162, v3 offset:4096
    ds_read_b32 v163, v3 offset:18432
    s_waitcnt lgkmcnt(8)
    v_add_f32 v152, v152, v153
    v_add_f32 v154, v154, v155
    v_add_f32 v152, v152, v154
    buffer_atomic_add_f32 v152, v2, s[44:47], s4 offen offset:0
    ds_read_b32 v164, v2 offset:6144
    ds_read_b32 v165, v2 offset:20480
    ds_read_b32 v166, v3 offset:6144
    ds_read_b32 v167, v3 offset:20480
    s_waitcnt lgkmcnt(8)
    v_add_f32 v156, v156, v157
    v_add_f32 v158, v158, v159
    v_add_f32 v156, v156, v158
    buffer_atomic_add_f32 v156, v2, s[44:47], s4 offen offset:2048
    s_add_u32 s4, s4, 4096
    ds_read_b32 v168, v2 offset:8192
    ds_read_b32 v169, v2 offset:22528
    ds_read_b32 v170, v3 offset:8192
    ds_read_b32 v171, v3 offset:22528
    s_waitcnt lgkmcnt(8)
    v_add_f32 v160, v160, v161
    v_add_f32 v162, v162, v163
    v_add_f32 v160, v160, v162
    buffer_atomic_add_f32 v160, v2, s[44:47], s4 offen offset:0
    ds_read_b32 v172, v2 offset:10240
    ds_read_b32 v173, v2 offset:24576
    ds_read_b32 v174, v3 offset:10240
    ds_read_b32 v175, v3 offset:24576
    s_waitcnt lgkmcnt(8)
    v_add_f32 v164, v164, v165
    v_add_f32 v166, v166, v167
    v_add_f32 v164, v164, v166
    buffer_atomic_add_f32 v164, v2, s[44:47], s4 offen offset:2048
    s_add_u32 s4, s4, 4096
    ds_read_b32 v176, v2 offset:12288
    ds_read_b32 v177, v2 offset:26624
    ds_read_b32 v178, v3 offset:12288
    ds_read_b32 v179, v3 offset:26624
    s_waitcnt lgkmcnt(8)
    v_add_f32 v168, v168, v169
    v_add_f32 v170, v170, v171
    v_add_f32 v168, v168, v170
    buffer_atomic_add_f32 v168, v2, s[44:47], s4 offen offset:0
    s_waitcnt lgkmcnt(4)
    v_add_f32 v172, v172, v173
    v_add_f32 v174, v174, v175
    v_add_f32 v172, v172, v174
    buffer_atomic_add_f32 v172, v2, s[44:47], s4 offen offset:2048
    s_add_u32 s4, s4, 4096
    s_waitcnt lgkmcnt(0)
    v_add_f32 v176, v176, v177
    v_add_f32 v178, v178, v179
    v_add_f32 v176, v176, v178
    buffer_atomic_add_f32 v176, v4, s[44:47], s4 offen offset:0
    s_mov_b32 s65, 3
    v_mov_b32 v6, 1073741824
    s_sub_u32 s70, s58, 9
    s_lshl_b32 s70, s70, 11
    s_add_u32 s70, s70, 14225408
    v_lshl_add_u32 v2, v1, 8, s70
    v_cmp_gt_u32 vcc, 8, v1
    s_nop 1
    v_cndmask_b32 v6, v6, v2, vcc
    v_mov_b32 v7, 1
    s_branch L_p2
L_aux:
    v_mov_b32 v152, 0
    v_mov_b32 v153, 0
    v_mov_b32 v154, 0
    v_mov_b32 v155, 0
    v_lshlrev_b32 v2, 4, v0
    s_mul_i32 s70, s57, 3360
    s_add_u32 s70, s70, 14155776
    v_add_u32 v2, s70, v2
    v_mov_b32 v4, 1073741824
    v_cmp_gt_u32 vcc, 210, v0
    s_nop 1
    v_cndmask_b32 v2, v4, v2, vcc
    s_cmp_lg_u32 s56, 7
    s_cbranch_scc1 L_A_z
    s_lshl_b32 s70, s57, 8
    s_add_u32 s70, s70, 14221312
    v_writelane_b32 v2, s70, 0
    s_add_u32 s70, s70, 128
    v_writelane_b32 v2, s70, 3
    s_lshl_b32 s70, s57, 9
    s_add_u32 s70, s70, 14225408
    v_writelane_b32 v2, s70, 1
    s_add_u32 s70, s70, 256
    v_writelane_b32 v2, s70, 2
L_A_z:
    buffer_store_dwordx4 v[152:155], v2, s[44:47], 0 offen sc1
    s_cmp_lg_u32 s56, 7
    s_cbranch_scc1 L_A_z2
    s_waitcnt vmcnt(0)
    v_mov_b32 v2, 1073741824
    v_writelane_b32 v2, 0, 0
    v_mov_b32 v3, 1
    buffer_atomic_add v3, v2, s[48:51], 0 offen sc1
L_A_z2:
    s_lshl_b32 s81, s57, 3
    s_add_u32 s81, s81, s56
    s_add_u32 s81, s81, 480
    s_mul_i32 s82, s56, 12288
    s_add_u32 s92, s81, 0
    s_add_u32 s9, s82, 0
    s_mul_i32 s93, s92, 205
    s_lshr_b32 s93, s93, 11
    s_mul_i32 s94, s93, 10
    s_sub_u32 s94, s92, s94
    s_cmp_lt_u32 s93, 54
    s_cselect_b32 s88, s28, s20
    s_cselect_b32 s89, s29, s21
    s_mov_b32 s90, 819200
    s_cselect_b32 s90, 2211840, s90
    s_cselect_b32 s70, 0, 54
    s_and_b32 s89, s89, 0xffff
    s_mov_b32 s91, 0x20000
    s_sub_u32 s70, s93, s70
    s_mul_i32 s70, s70, 40960
    s_lshl_b32 s71, s94, 7
    s_add_u32 s70, s70, s71
    v_lshrrev_b32 v2, 3, v1
    v_mul_u32_u24 v2, 1280, v2
    v_and_b32 v3, 7, v1
    v_lshl_add_u32 v2, v3, 4, v2
    s_add_u32 m0, s9, 0
    s_nop 0
    buffer_load_dwordx4 v2, s[88:91], s70 offen lds
    s_add_u32 s70, s70, 10240
    s_add_u32 m0, s9, 1024
    s_nop 0
    buffer_load_dwordx4 v2, s[88:91], s70 offen lds
    s_add_u32 s70, s70, 10240
    s_add_u32 m0, s9, 2048
    s_nop 0
    buffer_load_dwordx4 v2, s[88:91], s70 offen lds
    s_add_u32 s70, s70, 10240
    s_add_u32 m0, s9, 3072
    s_nop 0
    buffer_load_dwordx4 v2, s[88:91], s70 offen lds
    s_add_u32 s70, s70, 10240
    s_add_u32 s92, s81, 128
    s_add_u32 s9, s82, 4096
    s_mul_i32 s93, s92, 205
    s_lshr_b32 s93, s93, 11
    s_mul_i32 s94, s93, 10
    s_sub_u32 s94, s92, s94
    s_cmp_lt_u32 s93, 54
    s_cselect_b32 s88, s28, s20
    s_cselect_b32 s89, s29, s21
    s_mov_b32 s90, 819200
    s_cselect_b32 s90, 2211840, s90
    s_cselect_b32 s70, 0, 54
    s_and_b32 s89, s89, 0xffff
    s_mov_b32 s91, 0x20000
    s_sub_u32 s70, s93, s70
    s_mul_i32 s70, s70, 40960
    s_lshl_b32 s71, s94, 7
    s_add_u32 s70, s70, s71
    v_lshrrev_b32 v2, 3, v1
    v_mul_u32_u24 v2, 1280, v2
    v_and_b32 v3, 7, v1
    v_lshl_add_u32 v2, v3, 4, v2
    s_add_u32 m0, s9, 0
    s_nop 0
    buffer_load_dwordx4 v2, s[88:91], s70 offen lds
    s_add_u32 s70, s70, 10240
    s_add_u32 m0, s9, 1024
    s_nop 0
    buffer_load_dwordx4 v2, s[88:91], s70 offen lds
    s_add_u32 s70, s70, 10240
    s_add_u32 m0, s9, 2048
    s_nop 0
    buffer_load_dwordx4 v2, s[88:91], s70 offen lds
    s_add_u32 s70, s70, 10240
    s_add_u32 m0, s9, 3072
    s_nop 0
    buffer_load_dwordx4 v2, s[88:91], s70 offen lds
    s_add_u32 s70, s70, 10240
    s_add_u32 s92, s81, 256
    s_add_u32 s9, s82, 8192
    s_mul_i32 s93, s92, 205
    s_lshr_b32 s93, s93, 11
    s_mul_i32 s94, s93, 10
    s_sub_u32 s94, s92, s94
    s_cmp_lt_u32 s93, 54
    s_cselect_b32 s88, s28, s20
    s_cselect_b32 s89, s29, s21
    s_mov_b32 s90, 819200
    s_cselect_b32 s90, 2211840, s90
    s_cselect_b32 s70, 0, 54
    s_and_b32 s89, s89, 0xffff
    s_mov_b32 s91, 0x20000
    s_sub_u32 s70, s93, s70
    s_mul_i32 s70, s70, 40960
    s_lshl_b32 s71, s94, 7
    s_add_u32 s70, s70, s71
    v_lshrrev_b32 v2, 3, v1
    v_mul_u32_u24 v2, 1280, v2
    v_and_b32 v3, 7, v1
    v_lshl_add_u32 v2, v3, 4, v2
    s_add_u32 m0, s9, 0
    s_nop 0
    buffer_load_dwordx4 v2, s[88:91], s70 offen lds
    s_add_u32 s70, s70, 10240
    s_add_u32 m0, s9, 1024
    s_nop 0
    buffer_load_dwordx4 v2, s[88:91], s70 offen lds
    s_add_u32 s70, s70, 10240
    s_add_u32 m0, s9, 2048
    s_nop 0
    buffer_load_dwordx4 v2, s[88:91], s70 offen lds
    s_add_u32 s70, s70, 10240
    s_add_u32 m0, s9, 3072
    s_nop 0
    buffer_load_dwordx4 v2, s[88:91], s70 offen lds
    s_add_u32 s70, s70, 10240
    s_waitcnt vmcnt(12)
    v_lshlrev_b32 v64, 16, v56
    v_and_b32 v65, 0xffff0000, v56
    v_lshlrev_b32 v66, 16, v57
    v_and_b32 v67, 0xffff0000, v57
    v_lshlrev_b32 v68, 16, v58
    v_and_b32 v69, 0xffff0000, v58
    v_lshlrev_b32 v70, 16, v59
    v_and_b32 v71, 0xffff0000, v59
    v_lshlrev_b32 v72, 16, v60
    v_and_b32 v73, 0xffff0000, v60
    v_add_f32 v76, v64, v65
    v_add_f32 v76, v76, v66
    v_add_f32 v76, v76, v67
    v_add_f32 v76, v76, v68
    v_add_f32 v76, v76, v69
    v_add_f32 v76, v76, v70
    v_add_f32 v76, v76, v71
    v_add_f32 v76, v76, v72
    v_add_f32 v76, v76, v73
    s_nop 1
    v_add_f32_dpp v76, v76, v76 quad_perm:[1,0,3,2] row_mask:0xf bank_mask:0xf
    s_nop 1
    v_add_f32_dpp v76, v76, v76 quad_perm:[2,3,0,1] row_mask:0xf bank_mask:0xf
    s_nop 1
    v_add_f32_dpp v76, v76, v76 row_half_mirror row_mask:0xf bank_mask:0xf
    s_nop 1
    v_add_f32_dpp v76, v76, v76 row_mirror row_mask:0xf bank_mask:0xf
    s_nop 0
    v_readlane_b32 s4, v76, 0
    v_readlane_b32 s5, v76, 16
    v_readlane_b32 s6, v76, 32
    v_readlane_b32 s7, v76, 48
    v_mov_b32 v76, s4
    v_mov_b32 v77, s6
    v_add_f32 v76, s5, v76
    v_add_f32 v77, s7, v77
    v_add_f32 v76, v76, v77
    v_mul_f32 v76, 0x3acccccd, v76
    v_sub_f32 v64, v64, v76
    v_sub_f32 v65, v65, v76
    v_sub_f32 v66, v66, v76
    v_sub_f32 v67, v67, v76
    v_sub_f32 v68, v68, v76
    v_sub_f32 v69, v69, v76
    v_sub_f32 v70, v70, v76
    v_sub_f32 v71, v71, v76
    v_sub_f32 v72, v72, v76
    v_sub_f32 v73, v73, v76
    v_mul_f32 v77, v64, v64
    v_fmac_f32 v77, v65, v65
    v_fmac_f32 v77, v66, v66
    v_fmac_f32 v77, v67, v67
    v_fmac_f32 v77, v68, v68
    v_fmac_f32 v77, v69, v69
    v_fmac_f32 v77, v70, v70
    v_fmac_f32 v77, v71, v71
    v_fmac_f32 v77, v72, v72
    v_fmac_f32 v77, v73, v73
    s_nop 1
    v_add_f32_dpp v77, v77, v77 quad_perm:[1,0,3,2] row_mask:0xf bank_mask:0xf
    s_nop 1
    v_add_f32_dpp v77, v77, v77 quad_perm:[2,3,0,1] row_mask:0xf bank_mask:0xf
    s_nop 1
    v_add_f32_dpp v77, v77, v77 row_half_mirror row_mask:0xf bank_mask:0xf
    s_nop 1
    v_add_f32_dpp v77, v77, v77 row_mirror row_mask:0xf bank_mask:0xf
    s_nop 0
    v_readlane_b32 s4, v77, 0
    v_readlane_b32 s5, v77, 16
    v_readlane_b32 s6, v77, 32
    v_readlane_b32 s7, v77, 48
    v_mov_b32 v77, s4
    v_mov_b32 v78, s6
    v_add_f32 v77, s5, v77
    v_add_f32 v78, s7, v78
    v_add_f32 v77, v77, v78
    v_mov_b32 v78, 0x3727c5ac
    v_fmac_f32 v78, 0x3acccccd, v77
    v_mov_b32 v77, v78
    v_cmp_eq_u32 vcc, 0, v1
    v_mov_b32 v4, 1073741824
    s_nop 0
    v_cndmask_b32 v2, v4, v1, vcc
    s_lshl_b32 s70, s77, 3
    s_add_u32 s70, s70, 13631488
    buffer_store_dwordx2 v[76:77], v2, s[44:47], s70 offen sc1
    s_waitcnt vmcnt(9)
    s_add_u32 s92, s81, 0
    s_add_u32 s9, s82, 0
    s_mul_i32 s93, s92, 205
    s_lshr_b32 s93, s93, 11
    s_mul_i32 s94, s93, 10
    s_sub_u32 s94, s92, s94
    v_bfe_u32 v2, v1, 2, 2
    v_lshlrev_b32 v2, 7, v2
    v_and_b32 v3, 3, v1
    v_lshl_add_u32 v2, v3, 3, v2
    v_lshrrev_b32 v3, 4, v1
    s_cmp_lt_u32 s93, 54
    s_cselect_b32 s70, 10, 9
    s_movk_i32 s71, 512
    s_cselect_b32 s71, s71, 2048
    v_lshlrev_b32 v3, s70, v3
    v_add3_u32 v2, v2, v3, s9
    v_add_u32 v3, s71, v2
    ds_read_b64_tr_b16 v[168:169], v2 offset:0
    ds_read_b64_tr_b16 v[170:171], v3 offset:0
    ds_read_b64_tr_b16 v[172:173], v2 offset:32
    ds_read_b64_tr_b16 v[174:175], v3 offset:32
    ds_read_b64_tr_b16 v[176:177], v2 offset:64
    ds_read_b64_tr_b16 v[178:179], v3 offset:64
    ds_read_b64_tr_b16 v[180:181], v2 offset:96
    ds_read_b64_tr_b16 v[182:183], v3 offset:96
    v_lshlrev_b32 v4, 4, v1
    s_waitcnt lgkmcnt(0)
    s_lshl_b32 s70, s94, 2
    s_add_u32 s70, s70, 0
    s_mul_i32 s71, s70, 205
    s_lshr_b32 s71, s71, 10
    s_mul_i32 s75, s71, 365
    s_add_u32 s70, s70, s75
    s_mul_i32 s75, s93, 5
    s_add_u32 s70, s70, s75
    s_lshl_b32 s70, s70, 10
    s_add_u32 s70, s70, 10485760
    s_cmp_lt_u32 s92, 740
    s_cselect_b32 s70, s70, 1073741824
    buffer_store_dwordx4 v[168:171], v4, s[44:47], s70 offen sc1
    s_lshl_b32 s70, s94, 2
    s_add_u32 s70, s70, 1
    s_mul_i32 s71, s70, 205
    s_lshr_b32 s71, s71, 10
    s_mul_i32 s75, s71, 365
    s_add_u32 s70, s70, s75
    s_mul_i32 s75, s93, 5
    s_add_u32 s70, s70, s75
    s_lshl_b32 s70, s70, 10
    s_add_u32 s70, s70, 10485760
    s_cmp_lt_u32 s92, 740
    s_cselect_b32 s70, s70, 1073741824
    buffer_store_dwordx4 v[172:175], v4, s[44:47], s70 offen sc1
    s_lshl_b32 s70, s94, 2
    s_add_u32 s70, s70, 2
    s_mul_i32 s71, s70, 205
    s_lshr_b32 s71, s71, 10
    s_mul_i32 s75, s71, 365
    s_add_u32 s70, s70, s75
    s_mul_i32 s75, s93, 5
    s_add_u32 s70, s70, s75
    s_lshl_b32 s70, s70, 10
    s_add_u32 s70, s70, 10485760
    s_cmp_lt_u32 s92, 740
    s_cselect_b32 s70, s70, 1073741824
    buffer_store_dwordx4 v[176:179], v4, s[44:47], s70 offen sc1
    s_lshl_b32 s70, s94, 2
    s_add_u32 s70, s70, 3
    s_mul_i32 s71, s70, 205
    s_lshr_b32 s71, s71, 10
    s_mul_i32 s75, s71, 365
    s_add_u32 s70, s70, s75
    s_mul_i32 s75, s93, 5
    s_add_u32 s70, s70, s75
    s_lshl_b32 s70, s70, 10
    s_add_u32 s70, s70, 10485760
    s_cmp_lt_u32 s92, 740
    s_cselect_b32 s70, s70, 1073741824
    buffer_store_dwordx4 v[180:183], v4, s[44:47], s70 offen sc1
    s_waitcnt vmcnt(9)
    s_add_u32 s92, s81, 128
    s_add_u32 s9, s82, 4096
    s_mul_i32 s93, s92, 205
    s_lshr_b32 s93, s93, 11
    s_mul_i32 s94, s93, 10
    s_sub_u32 s94, s92, s94
    v_bfe_u32 v2, v1, 2, 2
    v_lshlrev_b32 v2, 7, v2
    v_and_b32 v3, 3, v1
    v_lshl_add_u32 v2, v3, 3, v2
    v_lshrrev_b32 v3, 4, v1
    s_cmp_lt_u32 s93, 54
    s_cselect_b32 s70, 10, 9
    s_movk_i32 s71, 512
    s_cselect_b32 s71, s71, 2048
    v_lshlrev_b32 v3, s70, v3
    v_add3_u32 v2, v2, v3, s9
    v_add_u32 v3, s71, v2
    ds_read_b64_tr_b16 v[184:185], v2 offset:0
    ds_read_b64_tr_b16 v[186:187], v3 offset:0
    ds_read_b64_tr_b16 v[188:189], v2 offset:32
    ds_read_b64_tr_b16 v[190:191], v3 offset:32
    ds_read_b64_tr_b16 v[192:193], v2 offset:64
    ds_read_b64_tr_b16 v[194:195], v3 offset:64
    ds_read_b64_tr_b16 v[196:197], v2 offset:96
    ds_read_b64_tr_b16 v[198:199], v3 offset:96
    v_lshlrev_b32 v4, 4, v1
    s_waitcnt lgkmcnt(0)
    s_lshl_b32 s70, s94, 2
    s_add_u32 s70, s70, 0
    s_mul_i32 s71, s70, 205
    s_lshr_b32 s71, s71, 10
    s_mul_i32 s75, s71, 365
    s_add_u32 s70, s70, s75
    s_mul_i32 s75, s93, 5
    s_add_u32 s70, s70, s75
    s_lshl_b32 s70, s70, 10
    s_add_u32 s70, s70, 10485760
    s_cmp_lt_u32 s92, 740
    s_cselect_b32 s70, s70, 1073741824
    buffer_store_dwordx4 v[184:187], v4, s[44:47], s70 offen sc1
    s_lshl_b32 s70, s94, 2
    s_add_u32 s70, s70, 1
    s_mul_i32 s71, s70, 205
    s_lshr_b32 s71, s71, 10
    s_mul_i32 s75, s71, 365
    s_add_u32 s70, s70, s75
    s_mul_i32 s75, s93, 5
    s_add_u32 s70, s70, s75
    s_lshl_b32 s70, s70, 10
    s_add_u32 s70, s70, 10485760
    s_cmp_lt_u32 s92, 740
    s_cselect_b32 s70, s70, 1073741824
    buffer_store_dwordx4 v[188:191], v4, s[44:47], s70 offen sc1
    s_lshl_b32 s70, s94, 2
    s_add_u32 s70, s70, 2
    s_mul_i32 s71, s70, 205
    s_lshr_b32 s71, s71, 10
    s_mul_i32 s75, s71, 365
    s_add_u32 s70, s70, s75
    s_mul_i32 s75, s93, 5
    s_add_u32 s70, s70, s75
    s_lshl_b32 s70, s70, 10
    s_add_u32 s70, s70, 10485760
    s_cmp_lt_u32 s92, 740
    s_cselect_b32 s70, s70, 1073741824
    buffer_store_dwordx4 v[192:195], v4, s[44:47], s70 offen sc1
    s_lshl_b32 s70, s94, 2
    s_add_u32 s70, s70, 3
    s_mul_i32 s71, s70, 205
    s_lshr_b32 s71, s71, 10
    s_mul_i32 s75, s71, 365
    s_add_u32 s70, s70, s75
    s_mul_i32 s75, s93, 5
    s_add_u32 s70, s70, s75
    s_lshl_b32 s70, s70, 10
    s_add_u32 s70, s70, 10485760
    s_cmp_lt_u32 s92, 740
    s_cselect_b32 s70, s70, 1073741824
    buffer_store_dwordx4 v[196:199], v4, s[44:47], s70 offen sc1
    s_waitcnt vmcnt(9)
    s_add_u32 s92, s81, 256
    s_add_u32 s9, s82, 8192
    s_mul_i32 s93, s92, 205
    s_lshr_b32 s93, s93, 11
    s_mul_i32 s94, s93, 10
    s_sub_u32 s94, s92, s94
    v_bfe_u32 v2, v1, 2, 2
    v_lshlrev_b32 v2, 7, v2
    v_and_b32 v3, 3, v1
    v_lshl_add_u32 v2, v3, 3, v2
    v_lshrrev_b32 v3, 4, v1
    s_cmp_lt_u32 s93, 54
    s_cselect_b32 s70, 10, 9
    s_movk_i32 s71, 512
    s_cselect_b32 s71, s71, 2048
    v_lshlrev_b32 v3, s70, v3
    v_add3_u32 v2, v2, v3, s9
    v_add_u32 v3, s71, v2
    ds_read_b64_tr_b16 v[200:201], v2 offset:0
    ds_read_b64_tr_b16 v[202:203], v3 offset:0
    ds_read_b64_tr_b16 v[204:205], v2 offset:32
    ds_read_b64_tr_b16 v[206:207], v3 offset:32
    ds_read_b64_tr_b16 v[208:209], v2 offset:64
    ds_read_b64_tr_b16 v[210:211], v3 offset:64
    ds_read_b64_tr_b16 v[212:213], v2 offset:96
    ds_read_b64_tr_b16 v[214:215], v3 offset:96
    v_lshlrev_b32 v4, 4, v1
    s_waitcnt lgkmcnt(0)
    s_lshl_b32 s70, s94, 2
    s_add_u32 s70, s70, 0
    s_mul_i32 s71, s70, 205
    s_lshr_b32 s71, s71, 10
    s_mul_i32 s75, s71, 365
    s_add_u32 s70, s70, s75
    s_mul_i32 s75, s93, 5
    s_add_u32 s70, s70, s75
    s_lshl_b32 s70, s70, 10
    s_add_u32 s70, s70, 10485760
    s_cmp_lt_u32 s92, 740
    s_cselect_b32 s70, s70, 1073741824
    buffer_store_dwordx4 v[200:203], v4, s[44:47], s70 offen sc1
    s_lshl_b32 s70, s94, 2
    s_add_u32 s70, s70, 1
    s_mul_i32 s71, s70, 205
    s_lshr_b32 s71, s71, 10
    s_mul_i32 s75, s71, 365
    s_add_u32 s70, s70, s75
    s_mul_i32 s75, s93, 5
    s_add_u32 s70, s70, s75
    s_lshl_b32 s70, s70, 10
    s_add_u32 s70, s70, 10485760
    s_cmp_lt_u32 s92, 740
    s_cselect_b32 s70, s70, 1073741824
    buffer_store_dwordx4 v[204:207], v4, s[44:47], s70 offen sc1
    s_lshl_b32 s70, s94, 2
    s_add_u32 s70, s70, 2
    s_mul_i32 s71, s70, 205
    s_lshr_b32 s71, s71, 10
    s_mul_i32 s75, s71, 365
    s_add_u32 s70, s70, s75
    s_mul_i32 s75, s93, 5
    s_add_u32 s70, s70, s75
    s_lshl_b32 s70, s70, 10
    s_add_u32 s70, s70, 10485760
    s_cmp_lt_u32 s92, 740
    s_cselect_b32 s70, s70, 1073741824
    buffer_store_dwordx4 v[208:211], v4, s[44:47], s70 offen sc1
    s_lshl_b32 s70, s94, 2
    s_add_u32 s70, s70, 3
    s_mul_i32 s71, s70, 205
    s_lshr_b32 s71, s71, 10
    s_mul_i32 s75, s71, 365
    s_add_u32 s70, s70, s75
    s_mul_i32 s75, s93, 5
    s_add_u32 s70, s70, s75
    s_lshl_b32 s70, s70, 10
    s_add_u32 s70, s70, 10485760
    s_cmp_lt_u32 s92, 740
    s_cselect_b32 s70, s70, 1073741824
    buffer_store_dwordx4 v[212:215], v4, s[44:47], s70 offen sc1
    s_waitcnt vmcnt(0)
    s_barrier
    s_cmp_lg_u32 s56, 0
    s_cbranch_scc1 L_A_w
    s_lshl_b32 s70, s57, 8
    s_add_u32 s70, s70, 14221440
    v_mov_b32 v2, 1073741824
    v_writelane_b32 v2, s70, 0
    v_mov_b32 v3, 1
    buffer_atomic_add v3, v2, s[44:47], 0 offen sc1
    s_mov_b32 s78, 0
L_A_wz:
    s_sleep 4
    buffer_load_dword v30, off, s[48:51], 0 sc1
L_A_wz_c:
    s_waitcnt vmcnt(0)
    v_readfirstlane_b32 s70, v30
    s_add_u32 s78, s78, 1
    s_cmp_gt_u32 s78, 1048576
    s_cbranch_scc1 L_A_wz_ok
    s_cmp_lt_u32 s70, 16
    s_cbranch_scc1 L_A_wz
L_A_wz_ok:
    v_and_b32 v25, 15, v1
    v_lshlrev_b32 v25, 8, v25
    v_add_u32 v25, 14221440, v25
L_A_poll:
    s_sleep 10
    buffer_load_dword v30, v25, s[44:47], 0 offen sc1
    s_waitcnt vmcnt(0)
    v_cmp_gt_u32 vcc, 16, v30
    s_add_u32 s78, s78, 1
    s_cmp_gt_u32 s78, 1048576
    s_cbranch_scc1 L_A_w
    s_cmp_lg_u64 vcc, 0
    s_cbranch_scc1 L_A_poll
L_A_w:
    s_barrier
    s_bfe_u32 s3, s2, 0x10003
    s_lshl_b32 s3, s3, 2
    s_lshr_b32 s4, s56, 1
    s_add_u32 s3, s3, s4
    s_mul_i32 s3, s3, 378880
    s_and_b32 s4, s56, 1
    s_lshl_b32 s4, s4, 13
    s_add_u32 s3, s3, s4
    s_add_u32 s3, s3, 10485760
    v_lshlrev_b32 v2, 7, v1
    buffer_load_dword v152, v2, s[44:47], s3 offen sc1
    s_add_u32 s3, s3, 16384
    buffer_load_dword v153, v2, s[44:47], s3 offen sc1
    s_add_u32 s3, s3, 16384
    buffer_load_dword v154, v2, s[44:47], s3 offen sc1
    s_add_u32 s3, s3, 16384
    buffer_load_dword v155, v2, s[44:47], s3 offen sc1
    s_add_u32 s3, s3, 16384
    buffer_load_dword v156, v2, s[44:47], s3 offen sc1
    s_add_u32 s3, s3, 16384
    s_and_b32 s3, s2, 7
    s_lshr_b32 s4, s2, 3
    s_and_b32 s17, s4, 7
    s_lshr_b32 s4, s4, 3
    s_lshl_b32 s3, s3, 2
    s_add_u32 s16, s3, s4
    v_lshlrev_b32 v5, 4, v1
    s_mov_b32 s65, 0
    v_mov_b32 v6, 1073741824
    v_mov_b32 v7, 0
    s_branch L_p2
L_p2:
    s_mov_b32 s52, s30
    s_and_b32 s53, s31, 0xffff
    s_mov_b32 s54, 2621440
    s_mov_b32 s55, 0x20000
    s_lshr_b32 s64, s16, 1
    s_lshl_b32 s64, s64, 8
    s_add_u32 s64, s64, 14221312
    s_nop 11
    s_cmp_ge_u32 s56, 4
    s_cbranch_scc1 L2_ffn
    s_mul_i32 s8, s56, 14336
    s_cmp_ge_u32 s56, 2
    s_cselect_b32 s9, 106496, 0
    s_add_u32 s8, s8, s9
    v_mov_b32 v192, 0
    v_mov_b32 v193, 0
    v_mov_b32 v194, 0
    v_mov_b32 v195, 0
    s_add_u32 s9, s8, 13440
    v_mov_b32 v4, s9
    ds_write_b128 v4, v[192:195]
    ds_write_b32 v4, v192 offset:16
    s_waitcnt vmcnt(0) lgkmcnt(0)
    s_barrier
    s_cmp_lg_u32 s56, 0
    s_cbranch_scc1 L2_nosig
    buffer_atomic_add v7, v6, s[44:47], 0 offen sc1
L2_nosig:
    s_cmp_lg_u32 s65, 0
    s_cbranch_scc1 L2_wodone
    s_mul_i32 s66, s56, 25600
    s_add_u32 s66, s66, 32768
    s_mul_i32 s6, s17, 74
    s_mul_i32 s7, s56, 5
    s_add_u32 s6, s6, s7
    s_add_u32 s6, s6, 54
    s_mul_i32 s6, s6, 5120
    s_add_u32 s67, s6, 10485760
    s_and_b32 s68, s16, 3
    s_mul_i32 s68, s68, 6144
    s_add_u32 m0, s66, s68
    s_add_u32 s9, s67, s68
    buffer_load_dwordx4 v5, s[44:47], s9 offen sc1 lds
    s_add_u32 s68, s68, 1024
    s_cmp_eq_u32 s68, 25600
    s_cselect_b32 s68, 0, s68
    s_add_u32 m0, s66, s68
    s_add_u32 s9, s67, s68
    buffer_load_dwordx4 v5, s[44:47], s9 offen sc1 lds
    s_add_u32 s68, s68, 1024
    s_cmp_eq_u32 s68, 25600
    s_cselect_b32 s68, 0, s68
    s_add_u32 m0, s66, s68
    s_add_u32 s9, s67, s68
    buffer_load_dwordx4 v5, s[44:47], s9 offen sc1 lds
    s_add_u32 s68, s68, 1024
    s_cmp_eq_u32 s68, 25600
    s_cselect_b32 s68, 0, s68
    s_add_u32 m0, s66, s68
    s_add_u32 s9, s67, s68
    buffer_load_dwordx4 v5, s[44:47], s9 offen sc1 lds
    s_add_u32 s68, s68, 1024
    s_cmp_eq_u32 s68, 25600
    s_cselect_b32 s68, 0, s68
    s_add_u32 m0, s66, s68
    s_add_u32 s9, s67, s68
    buffer_load_dwordx4 v5, s[44:47], s9 offen sc1 lds
    s_add_u32 s68, s68, 1024
    s_cmp_eq_u32 s68, 25600
    s_cselect_b32 s68, 0, s68
    s_add_u32 m0, s66, s68
    s_add_u32 s9, s67, s68
    buffer_load_dwordx4 v5, s[44:47], s9 offen sc1 lds
    s_add_u32 s68, s68, 1024
    s_cmp_eq_u32 s68, 25600
    s_cselect_b32 s68, 0, s68
    s_add_u32 m0, s66, s68
    s_add_u32 s9, s67, s68
    buffer_load_dwordx4 v5, s[44:47], s9 offen sc1 lds
    s_add_u32 s68, s68, 1024
    s_cmp_eq_u32 s68, 25600
    s_cselect_b32 s68, 0, s68
    s_add_u32 m0, s66, s68
    s_add_u32 s9, s67, s68
    buffer_load_dwordx4 v5, s[44:47], s9 offen sc1 lds
    s_add_u32 s68, s68, 1024
    s_cmp_eq_u32 s68, 25600
    s_cselect_b32 s68, 0, s68
    s_add_u32 m0, s66, s68
    s_add_u32 s9, s67, s68
    buffer_load_dwordx4 v5, s[44:47], s9 offen sc1 lds
    s_add_u32 s68, s68, 1024
    s_cmp_eq_u32 s68, 25600
    s_cselect_b32 s68, 0, s68
    s_add_u32 m0, s66, s68
    s_add_u32 s9, s67, s68
    buffer_load_dwordx4 v5, s[44:47], s9 offen sc1 lds
    s_add_u32 s68, s68, 1024
    s_cmp_eq_u32 s68, 25600
    s_cselect_b32 s68, 0, s68
    s_add_u32 m0, s66, s68
    s_add_u32 s9, s67, s68
    buffer_load_dwordx4 v5, s[44:47], s9 offen sc1 lds
    s_add_u32 s68, s68, 1024
    s_cmp_eq_u32 s68, 25600
    s_cselect_b32 s68, 0, s68
    s_add_u32 m0, s66, s68
    s_add_u32 s9, s67, s68
    buffer_load_dwordx4 v5, s[44:47], s9 offen sc1 lds
    s_add_u32 s68, s68, 1024
    s_cmp_eq_u32 s68, 25600
    s_cselect_b32 s68, 0, s68
    s_add_u32 m0, s66, s68
    s_add_u32 s9, s67, s68
    buffer_load_dwordx4 v5, s[44:47], s9 offen sc1 lds
    s_add_u32 s68, s68, 1024
    s_cmp_eq_u32 s68, 25600
    s_cselect_b32 s68, 0, s68
    s_add_u32 m0, s66, s68
    s_add_u32 s9, s67, s68
    buffer_load_dwordx4 v5, s[44:47], s9 offen sc1 lds
    s_add_u32 s68, s68, 1024
    s_cmp_eq_u32 s68, 25600
    s_cselect_b32 s68, 0, s68
    s_add_u32 m0, s66, s68
    s_add_u32 s9, s67, s68
    buffer_load_dwordx4 v5, s[44:47], s9 offen sc1 lds
    s_add_u32 s68, s68, 1024
    s_cmp_eq_u32 s68, 25600
    s_cselect_b32 s68, 0, s68
    s_add_u32 m0, s66, s68
    s_add_u32 s9, s67, s68
    buffer_load_dwordx4 v5, s[44:47], s9 offen sc1 lds
    s_add_u32 s68, s68, 1024
    s_cmp_eq_u32 s68, 25600
    s_cselect_b32 s68, 0, s68
    s_add_u32 m0, s66, s68
    s_add_u32 s9, s67, s68
    buffer_load_dwordx4 v5, s[44:47], s9 offen sc1 lds
    s_add_u32 s68, s68, 1024
    s_cmp_eq_u32 s68, 25600
    s_cselect_b32 s68, 0, s68
    s_add_u32 m0, s66, s68
    s_add_u32 s9, s67, s68
    buffer_load_dwordx4 v5, s[44:47], s9 offen sc1 lds
    s_add_u32 s68, s68, 1024
    s_cmp_eq_u32 s68, 25600
    s_cselect_b32 s68, 0, s68
    s_add_u32 m0, s66, s68
    s_add_u32 s9, s67, s68
    buffer_load_dwordx4 v5, s[44:47], s9 offen sc1 lds
    s_add_u32 s68, s68, 1024
    s_cmp_eq_u32 s68, 25600
    s_cselect_b32 s68, 0, s68
    s_add_u32 m0, s66, s68
    s_add_u32 s9, s67, s68
    buffer_load_dwordx4 v5, s[44:47], s9 offen sc1 lds
    s_add_u32 s68, s68, 1024
    s_cmp_eq_u32 s68, 25600
    s_cselect_b32 s68, 0, s68
    s_add_u32 m0, s66, s68
    s_add_u32 s9, s67, s68
    buffer_load_dwordx4 v5, s[44:47], s9 offen sc1 lds
    s_add_u32 s68, s68, 1024
    s_cmp_eq_u32 s68, 25600
    s_cselect_b32 s68, 0, s68
    s_add_u32 m0, s66, s68
    s_add_u32 s9, s67, s68
    buffer_load_dwordx4 v5, s[44:47], s9 offen sc1 lds
    s_add_u32 s68, s68, 1024
    s_cmp_eq_u32 s68, 25600
    s_cselect_b32 s68, 0, s68
    s_add_u32 m0, s66, s68
    s_add_u32 s9, s67, s68
    buffer_load_dwordx4 v5, s[44:47], s9 offen sc1 lds
    s_add_u32 s68, s68, 1024
    s_cmp_eq_u32 s68, 25600
    s_cselect_b32 s68, 0, s68
    s_add_u32 m0, s66, s68
    s_add_u32 s9, s67, s68
    buffer_load_dwordx4 v5, s[44:47], s9 offen sc1 lds
    s_add_u32 s68, s68, 1024
    s_cmp_eq_u32 s68, 25600
    s_cselect_b32 s68, 0, s68
    s_add_u32 m0, s66, s68
    s_add_u32 s9, s67, s68
    buffer_load_dwordx4 v5, s[44:47], s9 offen sc1 lds
    s_add_u32 s68, s68, 1024
    s_cmp_eq_u32 s68, 25600
    s_cselect_b32 s68, 0, s68
L2_wodone:
    s_mul_i32 s4, s56, 25600
    s_add_u32 s4, s4, 32768
    v_and_b32 v196, 15, v1
    v_lshrrev_b32 v197, 4, v1
    v_add_u32 v204, 0, v196
    v_mul_u32_u24 v204, 205, v204
    v_lshrrev_b32 v204, 12, v204
    v_add_u32 v205, 16, v196
    v_mul_u32_u24 v205, 205, v205
    v_lshrrev_b32 v205, 12, v205
    v_add_u32 v206, 32, v196
    v_mul_u32_u24 v206, 205, v206
    v_lshrrev_b32 v206, 12, v206
    v_add_u32 v207, 48, v196
    v_mul_u32_u24 v207, 205, v207
    v_lshrrev_b32 v207, 12, v207
    v_add_u32 v208, 64, v196
    v_mul_u32_u24 v208, 205, v208
    v_lshrrev_b32 v208, 12, v208
    v_add_u32 v209, 80, v196
    v_mul_u32_u24 v209, 205, v209
    v_lshrrev_b32 v209, 12, v209
    v_add_u32 v210, 96, v196
    v_mul_u32_u24 v210, 205, v210
    v_lshrrev_b32 v210, 12, v210
    v_add_u32 v211, 112, v196
    v_mul_u32_u24 v211, 205, v211
    v_lshrrev_b32 v211, 12, v211
    v_add_u32 v212, 128, v196
    v_mul_u32_u24 v212, 205, v212
    v_lshrrev_b32 v212, 12, v212
    v_add_u32 v213, 144, v196
    v_mul_u32_u24 v213, 205, v213
    v_lshrrev_b32 v213, 12, v213
    v_lshlrev_b32 v214, 3, v197
    v_add_u32 v214, 0, v214
    v_mul_u32_u24 v214, 205, v214
    v_lshrrev_b32 v214, 12, v214
    v_lshlrev_b32 v215, 3, v197
    v_add_u32 v215, 4, v215
    v_mul_u32_u24 v215, 205, v215
    v_lshrrev_b32 v215, 12, v215
    v_lshlrev_b32 v216, 3, v197
    v_add_u32 v216, 32, v216
    v_mul_u32_u24 v216, 205, v216
    v_lshrrev_b32 v216, 12, v216
    v_lshlrev_b32 v217, 3, v197
    v_add_u32 v217, 36, v217
    v_mul_u32_u24 v217, 205, v217
    v_lshrrev_b32 v217, 12, v217
    v_lshlrev_b32 v218, 3, v197
    v_add_u32 v218, 64, v218
    v_mul_u32_u24 v218, 205, v218
    v_lshrrev_b32 v218, 12, v218
    v_lshlrev_b32 v219, 3, v197
    v_add_u32 v219, 68, v219
    v_mul_u32_u24 v219, 205, v219
    v_lshrrev_b32 v219, 12, v219
    v_lshlrev_b32 v220, 3, v197
    v_add_u32 v220, 96, v220
    v_mul_u32_u24 v220, 205, v220
    v_lshrrev_b32 v220, 12, v220
    v_lshlrev_b32 v221, 3, v197
    v_add_u32 v221, 100, v221
    v_mul_u32_u24 v221, 205, v221
    v_lshrrev_b32 v221, 12, v221
    v_lshlrev_b32 v222, 3, v197
    v_add_u32 v222, 128, v222
    v_mul_u32_u24 v222, 205, v222
    v_lshrrev_b32 v222, 12, v222
    v_lshlrev_b32 v223, 3, v197
    v_add_u32 v223, 132, v223
    v_mul_u32_u24 v223, 205, v223
    v_lshrrev_b32 v223, 12, v223
    v_mul_u32_u24 v198, 80, v196
    v_lshl_add_u32 v198, v197, 5, v198
    v_add_u32 v198, s8, v198
    v_and_b32 v200, 3, v196
    v_mul_u32_u24 v199, 1600, v200
    v_lshl_add_u32 v199, v197, 5, v199
    v_add_u32 v199, s8, v199
    v_add_u32 v201, 0, v200
    v_cmp_eq_u32 vcc, v201, v214
    v_add_u32 v8, 1600, v199
    s_nop 0
    v_cndmask_b32 v8, v4, v8, vcc
    v_cmp_eq_u32 vcc, v201, v215
    v_add_u32 v9, 1616, v199
    s_nop 0
    v_cndmask_b32 v9, v4, v9, vcc
    v_cmp_eq_u32 vcc, v201, v216
    v_add_u32 v10, 1728, v199
    s_nop 0
    v_cndmask_b32 v10, v4, v10, vcc
    v_cmp_eq_u32 vcc, v201, v217
    v_add_u32 v11, 1744, v199
    s_nop 0
    v_cndmask_b32 v11, v4, v11, vcc
    v_cmp_eq_u32 vcc, v201, v218
    v_add_u32 v12, 1856, v199
    s_nop 0
    v_cndmask_b32 v12, v4, v12, vcc
    v_cmp_eq_u32 vcc, v201, v219
    v_add_u32 v13, 1872, v199
    s_nop 0
    v_cndmask_b32 v13, v4, v13, vcc
    v_cmp_eq_u32 vcc, v204, v214
    v_add_u32 v14, 0, v198
    s_nop 0
    v_cndmask_b32 v14, v4, v14, vcc
    v_cmp_eq_u32 vcc, v204, v215
    v_add_u32 v15, 16, v198
    s_nop 0
    v_cndmask_b32 v15, v4, v15, vcc
    v_cmp_eq_u32 vcc, v205, v214
    v_add_u32 v16, 1280, v198
    s_nop 0
    v_cndmask_b32 v16, v4, v16, vcc
    v_cmp_eq_u32 vcc, v205, v215
    v_add_u32 v17, 1296, v198
    s_nop 0
    v_cndmask_b32 v17, v4, v17, vcc
    v_cmp_eq_u32 vcc, v205, v216
    v_add_u32 v18, 1408, v198
    s_nop 0
    v_cndmask_b32 v18, v4, v18, vcc
    v_cmp_eq_u32 vcc, v205, v217
    v_add_u32 v19, 1424, v198
    s_nop 0
    v_cndmask_b32 v19, v4, v19, vcc
    v_cmp_eq_u32 vcc, v206, v214
    v_add_u32 v20, 2560, v198
    s_nop 0
    v_cndmask_b32 v20, v4, v20, vcc
    v_cmp_eq_u32 vcc, v206, v215
    v_add_u32 v21, 2576, v198
    s_nop 0
    v_cndmask_b32 v21, v4, v21, vcc
    v_cmp_eq_u32 vcc, v206, v216
    v_add_u32 v22, 2688, v198
    s_nop 0
    v_cndmask_b32 v22, v4, v22, vcc
    v_cmp_eq_u32 vcc, v206, v217
    v_add_u32 v23, 2704, v198
    s_nop 0
    v_cndmask_b32 v23, v4, v23, vcc
    v_cmp_eq_u32 vcc, v207, v216
    v_add_u32 v24, 3968, v198
    s_nop 0
    v_cndmask_b32 v24, v4, v24, vcc
    v_cmp_eq_u32 vcc, v207, v217
    v_add_u32 v25, 3984, v198
    s_nop 0
    v_cndmask_b32 v25, v4, v25, vcc
    v_cmp_eq_u32 vcc, v207, v218
    v_add_u32 v26, 4096, v198
    s_nop 0
    v_cndmask_b32 v26, v4, v26, vcc
    v_cmp_eq_u32 vcc, v207, v219
    v_add_u32 v27, 4112, v198
    s_nop 0
    v_cndmask_b32 v27, v4, v27, vcc
    v_cmp_eq_u32 vcc, v208, v216
    v_add_u32 v28, 5248, v198
    s_nop 0
    v_cndmask_b32 v28, v4, v28, vcc
    v_cmp_eq_u32 vcc, v208, v217
    v_add_u32 v29, 5264, v198
    s_nop 0
    v_cndmask_b32 v29, v4, v29, vcc
    v_cmp_eq_u32 vcc, v208, v218
    v_add_u32 v30, 5376, v198
    s_nop 0
    v_cndmask_b32 v30, v4, v30, vcc
    v_cmp_eq_u32 vcc, v208, v219
    v_add_u32 v31, 5392, v198
    s_nop 0
    v_cndmask_b32 v31, v4, v31, vcc
    v_add_u32 v201, 4, v200
    v_cmp_eq_u32 vcc, v201, v218
    v_add_u32 v32, 8256, v199
    s_nop 0
    v_cndmask_b32 v32, v4, v32, vcc
    v_cmp_eq_u32 vcc, v201, v219
    v_add_u32 v33, 8272, v199
    s_nop 0
    v_cndmask_b32 v33, v4, v33, vcc
    v_cmp_eq_u32 vcc, v201, v220
    v_add_u32 v34, 8384, v199
    s_nop 0
    v_cndmask_b32 v34, v4, v34, vcc
    v_cmp_eq_u32 vcc, v201, v221
    v_add_u32 v35, 8400, v199
    s_nop 0
    v_cndmask_b32 v35, v4, v35, vcc
    v_cmp_eq_u32 vcc, v201, v222
    v_add_u32 v36, 8512, v199
    s_nop 0
    v_cndmask_b32 v36, v4, v36, vcc
    v_cmp_eq_u32 vcc, v201, v223
    v_add_u32 v37, 8528, v199
    s_nop 0
    v_cndmask_b32 v37, v4, v37, vcc
    v_cmp_eq_u32 vcc, v209, v218
    v_add_u32 v38, 6656, v198
    s_nop 0
    v_cndmask_b32 v38, v4, v38, vcc
    v_cmp_eq_u32 vcc, v209, v219
    v_add_u32 v39, 6672, v198
    s_nop 0
    v_cndmask_b32 v39, v4, v39, vcc
    v_cmp_eq_u32 vcc, v209, v220
    v_add_u32 v40, 6784, v198
    s_nop 0
    v_cndmask_b32 v40, v4, v40, vcc
    v_cmp_eq_u32 vcc, v209, v221
    v_add_u32 v41, 6800, v198
    s_nop 0
    v_cndmask_b32 v41, v4, v41, vcc
    v_cmp_eq_u32 vcc, v210, v218
    v_add_u32 v42, 7936, v198
    s_nop 0
    v_cndmask_b32 v42, v4, v42, vcc
    v_cmp_eq_u32 vcc, v210, v219
    v_add_u32 v43, 7952, v198
    s_nop 0
    v_cndmask_b32 v43, v4, v43, vcc
    v_cmp_eq_u32 vcc, v210, v220
    v_add_u32 v44, 8064, v198
    s_nop 0
    v_cndmask_b32 v44, v4, v44, vcc
    v_cmp_eq_u32 vcc, v210, v221
    v_add_u32 v45, 8080, v198
    s_nop 0
    v_cndmask_b32 v45, v4, v45, vcc
    v_cmp_eq_u32 vcc, v211, v220
    v_add_u32 v46, 9344, v198
    s_nop 0
    v_cndmask_b32 v46, v4, v46, vcc
    v_cmp_eq_u32 vcc, v211, v221
    v_add_u32 v47, 9360, v198
    s_nop 0
    v_cndmask_b32 v47, v4, v47, vcc
    v_cmp_eq_u32 vcc, v211, v222
    v_add_u32 v48, 9472, v198
    s_nop 0
    v_cndmask_b32 v48, v4, v48, vcc
    v_cmp_eq_u32 vcc, v211, v223
    v_add_u32 v49, 9488, v198
    s_nop 0
    v_cndmask_b32 v49, v4, v49, vcc
    v_cmp_eq_u32 vcc, v212, v220
    v_add_u32 v50, 10624, v198
    s_nop 0
    v_cndmask_b32 v50, v4, v50, vcc
    v_cmp_eq_u32 vcc, v212, v221
    v_add_u32 v51, 10640, v198
    s_nop 0
    v_cndmask_b32 v51, v4, v51, vcc
    v_cmp_eq_u32 vcc, v212, v222
    v_add_u32 v52, 10752, v198
    s_nop 0
    v_cndmask_b32 v52, v4, v52, vcc
    v_cmp_eq_u32 vcc, v212, v223
    v_add_u32 v53, 10768, v198
    s_nop 0
    v_cndmask_b32 v53, v4, v53, vcc
    v_cmp_eq_u32 vcc, v213, v222
    v_add_u32 v54, 12032, v198
    s_nop 0
    v_cndmask_b32 v54, v4, v54, vcc
    v_cmp_eq_u32 vcc, v213, v223
    v_add_u32 v55, 12048, v198
    s_nop 0
    v_cndmask_b32 v55, v4, v55, vcc
    v_cmp_lt_u32 s[84:85], 0, v197
    v_cmp_lt_u32 s[86:87], 1, v197
    v_cmp_lt_u32 s[88:89], 2, v197
    s_setprio 3
    s_lshr_b32 s10, s56, 1
    s_lshl_b32 s10, 0x2000, s10
    s_mov_b32 s78, 0
    v_mov_b32 v3, 0
L2_pq:
    buffer_load_dword v2, v3, s[44:47], s64 offen sc1
    s_waitcnt vmcnt(0)
    v_readfirstlane_b32 s75, v2
    s_add_u32 s78, s78, 1
    s_and_b32 s75, s75, s10
    s_cmp_ge_u32 s75, s10
    s_cbranch_scc1 L2_pq_ok
    s_cmp_gt_u32 s78, 1048576
    s_cbranch_scc1 L2_pq_ok
    s_sleep 2
    s_branch L2_pq
L2_pq_ok:
    s_mul_i32 s6, s16, 20
    s_mul_i32 s7, s56, 5
    s_add_u32 s6, s6, s7
    s_lshl_b32 s6, s6, 12
    s_add_u32 s6, s6, 7340032
    buffer_load_dwordx4 v[112:115], v5, s[44:47], s6 offen offset:0 sc1
    buffer_load_dwordx4 v[116:119], v5, s[44:47], s6 offen offset:1024 sc1
    buffer_load_dwordx4 v[120:123], v5, s[44:47], s6 offen offset:2048 sc1
    buffer_load_dwordx4 v[124:127], v5, s[44:47], s6 offen offset:3072 sc1
    s_add_u32 s6, s6, 4096
    buffer_load_dwordx4 v[128:131], v5, s[44:47], s6 offen offset:0 sc1
    buffer_load_dwordx4 v[132:135], v5, s[44:47], s6 offen offset:1024 sc1
    buffer_load_dwordx4 v[136:139], v5, s[44:47], s6 offen offset:2048 sc1
    buffer_load_dwordx4 v[140:143], v5, s[44:47], s6 offen offset:3072 sc1
    s_add_u32 s6, s6, 4096
    buffer_load_dwordx4 v[144:147], v5, s[44:47], s6 offen offset:0 sc1
    buffer_load_dwordx4 v[148:151], v5, s[44:47], s6 offen offset:1024 sc1
    buffer_load_dwordx4 v[152:155], v5, s[44:47], s6 offen offset:2048 sc1
    buffer_load_dwordx4 v[156:159], v5, s[44:47], s6 offen offset:3072 sc1
    s_add_u32 s6, s6, 4096
    buffer_load_dwordx4 v[160:163], v5, s[44:47], s6 offen offset:0 sc1
    buffer_load_dwordx4 v[164:167], v5, s[44:47], s6 offen offset:1024 sc1
    buffer_load_dwordx4 v[168:171], v5, s[44:47], s6 offen offset:2048 sc1
    buffer_load_dwordx4 v[172:175], v5, s[44:47], s6 offen offset:3072 sc1
    s_add_u32 s6, s6, 4096
    buffer_load_dwordx4 v[176:179], v5, s[44:47], s6 offen offset:0 sc1
    buffer_load_dwordx4 v[180:183], v5, s[44:47], s6 offen offset:1024 sc1
    buffer_load_dwordx4 v[184:187], v5, s[44:47], s6 offen offset:2048 sc1
    buffer_load_dwordx4 v[188:191], v5, s[44:47], s6 offen offset:3072 sc1
    s_add_u32 s6, s6, 4096
    s_lshl_b32 s6, s56, 3
    s_and_b32 s7, s2, 7
    s_add_u32 s6, s6, s7
    s_lshl_b32 s6, s6, 8
    s_add_u32 s6, s6, 14225408
    s_mov_b32 s78, 0
    v_mov_b32 v3, 0
L2_kv:
    buffer_load_dword v2, v3, s[44:47], s6 offen sc1
    s_waitcnt vmcnt(0)
    v_readfirstlane_b32 s75, v2
    s_add_u32 s78, s78, 1
    s_and_b32 s75, s75, 255
    s_cmp_ge_u32 s75, 16
    s_cbranch_scc1 L2_kv_ok
    s_cmp_gt_u32 s78, 1048576
    s_cbranch_scc1 L2_kv_ok
    s_sleep 2
    s_branch L2_kv
L2_kv_ok:
    s_mul_i32 s3, s56, 13440
    s_add_u32 s3, s3, 14155776
    s_add_u32 m0, s8, 0
    s_add_u32 s5, s3, 0
    buffer_load_dwordx4 v5, s[44:47], s5 offen offset:0 sc1 lds
    buffer_load_dwordx4 v5, s[44:47], s5 offen offset:1024 sc1 lds
    buffer_load_dwordx4 v5, s[44:47], s5 offen offset:2048 sc1 lds
    buffer_load_dwordx4 v5, s[44:47], s5 offen offset:3072 sc1 lds
    s_add_u32 m0, s8, 4096
    s_add_u32 s5, s3, 4096
    buffer_load_dwordx4 v5, s[44:47], s5 offen offset:0 sc1 lds
    buffer_load_dwordx4 v5, s[44:47], s5 offen offset:1024 sc1 lds
    buffer_load_dwordx4 v5, s[44:47], s5 offen offset:2048 sc1 lds
    buffer_load_dwordx4 v5, s[44:47], s5 offen offset:3072 sc1 lds
    s_add_u32 m0, s8, 8192
    s_add_u32 s5, s3, 8192
    buffer_load_dwordx4 v5, s[44:47], s5 offen offset:0 sc1 lds
    buffer_load_dwordx4 v5, s[44:47], s5 offen offset:1024 sc1 lds
    buffer_load_dwordx4 v5, s[44:47], s5 offen offset:2048 sc1 lds
    buffer_load_dwordx4 v5, s[44:47], s5 offen offset:3072 sc1 lds
    s_add_u32 m0, s8, 12288
    s_add_u32 s5, s3, 12288
    buffer_load_dwordx4 v5, s[44:47], s5 offen offset:0 sc1 lds
    s_mov_b64 exec, 0xff
    buffer_load_dwordx4 v5, s[44:47], s5 offen offset:1024 sc1 lds
    s_mov_b64 exec, -1
    s_setprio 2
    s_waitcnt vmcnt(7) lgkmcnt(0)
    ds_read_b128 v[56:59], v8
    ds_read_b128 v[60:63], v9
    ds_read_b128 v[64:67], v10
    ds_read_b128 v[68:71], v11
    ds_read_b128 v[72:75], v12
    ds_read_b128 v[76:79], v13
    s_waitcnt lgkmcnt(4)
    v_cvt_pk_bf16_f32 v80, v56, v57
    v_cvt_pk_bf16_f32 v81, v58, v59
    v_cvt_pk_bf16_f32 v82, v60, v61
    v_cvt_pk_bf16_f32 v83, v62, v63
    ds_read_b128 v[56:59], v14
    ds_read_b128 v[60:63], v15
    s_waitcnt lgkmcnt(4)
    v_mfma_f32_16x16x32_bf16 v[192:195], v[80:83], v[112:115], 0
    v_cvt_pk_bf16_f32 v84, v64, v65
    v_mfma_f32_16x16x32_bf16 v[200:203], v[80:83], v[116:119], 0
    v_cvt_pk_bf16_f32 v85, v66, v67
    v_mfma_f32_16x16x32_bf16 v[208:211], v[80:83], v[120:123], 0
    v_cvt_pk_bf16_f32 v86, v68, v69
    v_mfma_f32_16x16x32_bf16 v[216:219], v[80:83], v[124:127], 0
    v_cvt_pk_bf16_f32 v87, v70, v71
    ds_read_b128 v[64:67], v16
    ds_read_b128 v[68:71], v17
    s_waitcnt lgkmcnt(4)
    v_mfma_f32_16x16x32_bf16 v[192:195], v[84:87], v[128:131], v[192:195]
    v_cvt_pk_bf16_f32 v88, v72, v73
    v_mfma_f32_16x16x32_bf16 v[200:203], v[84:87], v[132:135], v[200:203]
    v_cvt_pk_bf16_f32 v89, v74, v75
    v_mfma_f32_16x16x32_bf16 v[208:211], v[84:87], v[136:139], v[208:211]
    v_cvt_pk_bf16_f32 v90, v76, v77
    v_mfma_f32_16x16x32_bf16 v[216:219], v[84:87], v[140:143], v[216:219]
    v_cvt_pk_bf16_f32 v91, v78, v79
    ds_read_b128 v[72:75], v18
    ds_read_b128 v[76:79], v19
    s_waitcnt lgkmcnt(4)
    v_mfma_f32_16x16x32_bf16 v[192:195], v[88:91], v[144:147], v[192:195]
    v_cvt_pk_bf16_f32 v92, v56, v57
    v_mfma_f32_16x16x32_bf16 v[200:203], v[88:91], v[148:151], v[200:203]
    v_cvt_pk_bf16_f32 v93, v58, v59
    v_mfma_f32_16x16x32_bf16 v[208:211], v[88:91], v[152:155], v[208:211]
    v_cvt_pk_bf16_f32 v94, v60, v61
    v_mfma_f32_16x16x32_bf16 v[216:219], v[88:91], v[156:159], v[216:219]
    v_cvt_pk_bf16_f32 v95, v62, v63
    ds_read_b128 v[56:59], v20
    ds_read_b128 v[60:63], v21
    s_waitcnt lgkmcnt(4)
    v_mfma_f32_16x16x32_bf16 v[224:227], v[92:95], v[112:115], 0
    v_cvt_pk_bf16_f32 v80, v64, v65
    v_mfma_f32_16x16x32_bf16 v[228:231], v[92:95], v[116:119], 0
    v_cvt_pk_bf16_f32 v81, v66, v67
    v_mfma_f32_16x16x32_bf16 v[232:235], v[92:95], v[120:123], 0
    v_cvt_pk_bf16_f32 v82, v68, v69
    v_mfma_f32_16x16x32_bf16 v[236:239], v[92:95], v[124:127], 0
    v_cvt_pk_bf16_f32 v83, v70, v71
    ds_read_b128 v[64:67], v22
    ds_read_b128 v[68:71], v23
    s_waitcnt lgkmcnt(4)
    v_mfma_f32_16x16x32_bf16 v[240:243], v[80:83], v[112:115], 0
    v_cvt_pk_bf16_f32 v84, v72, v73
    v_cvt_pk_bf16_f32 v85, v74, v75
    v_cvt_pk_bf16_f32 v86, v76, v77
    v_cvt_pk_bf16_f32 v87, v78, v79
    v_add_f32 v192, 0x358637bd, v192
    v_mfma_f32_16x16x32_bf16 v[244:247], v[80:83], v[116:119], 0
    v_add_f32 v193, 0x358637bd, v193
    v_add_f32 v194, 0x358637bd, v194
    v_add_f32 v195, 0x358637bd, v195
    v_add_f32 v200, 0x358637bd, v200
    v_mfma_f32_16x16x32_bf16 v[248:251], v[80:83], v[120:123], 0
    v_add_f32 v201, 0x358637bd, v201
    v_add_f32 v202, 0x358637bd, v202
    v_add_f32 v203, 0x358637bd, v203
    v_add_f32 v208, 0x358637bd, v208
    v_add_f32 v209, 0x358637bd, v209
    v_mfma_f32_16x16x32_bf16 v[252:255], v[80:83], v[124:127], 0
    v_add_f32 v210, 0x358637bd, v210
    v_add_f32 v211, 0x358637bd, v211
    v_add_f32 v216, 0x358637bd, v216
    v_add_f32 v217, 0x358637bd, v217
    ds_read_b128 v[72:75], v24
    ds_read_b128 v[76:79], v25
    s_waitcnt lgkmcnt(4)
    v_mfma_f32_16x16x32_bf16 v[240:243], v[84:87], v[128:131], v[240:243]
    v_cvt_pk_bf16_f32 v88, v56, v57
    v_cvt_pk_bf16_f32 v89, v58, v59
    v_cvt_pk_bf16_f32 v90, v60, v61
    v_cvt_pk_bf16_f32 v91, v62, v63
    v_add_f32 v218, 0x358637bd, v218
    v_mfma_f32_16x16x32_bf16 v[244:247], v[84:87], v[132:135], v[244:247]
    v_add_f32 v219, 0x358637bd, v219
    v_rcp_f32 v192, v192
    v_rcp_f32 v193, v193
    v_rcp_f32 v194, v194
    v_mfma_f32_16x16x32_bf16 v[248:251], v[84:87], v[136:139], v[248:251]
    v_rcp_f32 v195, v195
    v_rcp_f32 v200, v200
    v_rcp_f32 v201, v201
    v_rcp_f32 v202, v202
    v_rcp_f32 v203, v203
    v_mfma_f32_16x16x32_bf16 v[252:255], v[84:87], v[140:143], v[252:255]
    v_rcp_f32 v208, v208
    v_rcp_f32 v209, v209
    v_rcp_f32 v210, v210
    v_rcp_f32 v211, v211
    ds_read_b128 v[56:59], v26
    ds_read_b128 v[60:63], v27
    s_waitcnt lgkmcnt(4)
    v_rcp_f32 v216, v216
    v_rcp_f32 v217, v217
    v_rcp_f32 v218, v218
    v_rcp_f32 v219, v219
    v_mul_f32 v224, v224, v192
    v_mul_f32 v225, v225, v192
    v_mul_f32 v226, v226, v192
    v_mul_f32 v227, v227, v192
    v_mul_f32 v228, v228, v200
    v_mul_f32 v229, v229, v200
    v_mul_f32 v230, v230, v200
    v_mul_f32 v231, v231, v200
    v_mul_f32 v232, v232, v208
    v_mul_f32 v233, v233, v208
    v_mul_f32 v234, v234, v208
    v_mul_f32 v235, v235, v208
    v_mul_f32 v236, v236, v216
    v_mul_f32 v237, v237, v216
    v_mul_f32 v238, v238, v216
    v_mul_f32 v239, v239, v216
    v_cvt_pk_bf16_f32 v96, v224, v225
    v_cvt_pk_bf16_f32 v97, v226, v227
    v_cvt_pk_bf16_f32 v100, v228, v229
    v_cvt_pk_bf16_f32 v101, v230, v231
    v_cvt_pk_bf16_f32 v104, v232, v233
    v_cvt_pk_bf16_f32 v105, v234, v235
    v_cvt_pk_bf16_f32 v108, v236, v237
    v_cvt_pk_bf16_f32 v109, v238, v239
    v_mfma_f32_16x16x32_bf16 v[224:227], v[88:91], v[112:115], 0
    v_cvt_pk_bf16_f32 v92, v64, v65
    v_mfma_f32_16x16x32_bf16 v[228:231], v[88:91], v[116:119], 0
    v_cvt_pk_bf16_f32 v93, v66, v67
    v_mfma_f32_16x16x32_bf16 v[232:235], v[88:91], v[120:123], 0
    v_cvt_pk_bf16_f32 v94, v68, v69
    v_mfma_f32_16x16x32_bf16 v[236:239], v[88:91], v[124:127], 0
    v_cvt_pk_bf16_f32 v95, v70, v71
    ds_read_b128 v[64:67], v28
    ds_read_b128 v[68:71], v29
    s_waitcnt lgkmcnt(4)
    v_mfma_f32_16x16x32_bf16 v[224:227], v[92:95], v[128:131], v[224:227]
    v_cvt_pk_bf16_f32 v80, v72, v73
    v_cvt_pk_bf16_f32 v81, v74, v75
    v_cvt_pk_bf16_f32 v82, v76, v77
    v_cvt_pk_bf16_f32 v83, v78, v79
    v_cndmask_b32 v8, v192, v193, s[84:85]
    v_mfma_f32_16x16x32_bf16 v[228:231], v[92:95], v[132:135], v[228:231]
    v_cndmask_b32 v9, v200, v201, s[84:85]
    v_cndmask_b32 v10, v208, v209, s[84:85]
    v_cndmask_b32 v11, v216, v217, s[84:85]
    v_mul_f32 v240, v240, v8
    v_mfma_f32_16x16x32_bf16 v[232:235], v[92:95], v[136:139], v[232:235]
    v_mul_f32 v241, v241, v8
    v_mul_f32 v242, v242, v8
    v_mul_f32 v243, v243, v8
    v_mul_f32 v244, v244, v9
    v_mul_f32 v245, v245, v9
    v_mfma_f32_16x16x32_bf16 v[236:239], v[92:95], v[140:143], v[236:239]
    v_mul_f32 v246, v246, v9
    v_mul_f32 v247, v247, v9
    v_mul_f32 v248, v248, v10
    v_mul_f32 v249, v249, v10
    ds_read_b128 v[72:75], v30
    ds_read_b128 v[76:79], v31
    s_waitcnt lgkmcnt(4)
    v_mul_f32 v250, v250, v10
    v_mul_f32 v251, v251, v10
    v_mul_f32 v252, v252, v11
    v_mul_f32 v253, v253, v11
    v_mul_f32 v254, v254, v11
    v_mul_f32 v255, v255, v11
    v_cvt_pk_bf16_f32 v98, v240, v241
    v_cvt_pk_bf16_f32 v99, v242, v243
    v_cvt_pk_bf16_f32 v102, v244, v245
    v_cvt_pk_bf16_f32 v103, v246, v247
    v_cvt_pk_bf16_f32 v106, v248, v249
    v_cvt_pk_bf16_f32 v107, v250, v251
    v_cvt_pk_bf16_f32 v110, v252, v253
    v_cvt_pk_bf16_f32 v111, v254, v255
    v_mfma_f32_16x16x32_bf16 v[240:243], v[80:83], v[128:131], 0
    v_cvt_pk_bf16_f32 v84, v56, v57
    v_mfma_f32_16x16x32_bf16 v[244:247], v[80:83], v[132:135], 0
    v_cvt_pk_bf16_f32 v85, v58, v59
    v_mfma_f32_16x16x32_bf16 v[248:251], v[80:83], v[136:139], 0
    v_cvt_pk_bf16_f32 v86, v60, v61
    v_mfma_f32_16x16x32_bf16 v[252:255], v[80:83], v[140:143], 0
    v_cvt_pk_bf16_f32 v87, v62, v63
    s_waitcnt vmcnt(0)
    ds_read_b128 v[56:59], v32
    ds_read_b128 v[60:63], v33
    s_waitcnt lgkmcnt(4)
    v_mfma_f32_16x16x32_bf16 v[240:243], v[84:87], v[144:147], v[240:243]
    v_cvt_pk_bf16_f32 v88, v64, v65
    v_cvt_pk_bf16_f32 v89, v66, v67
    v_cvt_pk_bf16_f32 v90, v68, v69
    v_cvt_pk_bf16_f32 v91, v70, v71
    v_cndmask_b32 v8, v193, v194, s[86:87]
    v_mfma_f32_16x16x32_bf16 v[244:247], v[84:87], v[148:151], v[244:247]
    v_cndmask_b32 v9, v201, v202, s[86:87]
    v_cndmask_b32 v10, v209, v210, s[86:87]
    v_cndmask_b32 v11, v217, v218, s[86:87]
    v_mul_f32 v224, v224, v8
    v_mfma_f32_16x16x32_bf16 v[248:251], v[84:87], v[152:155], v[248:251]
    v_mul_f32 v225, v225, v8
    v_mul_f32 v226, v226, v8
    v_mul_f32 v227, v227, v8
    v_mul_f32 v228, v228, v9
    v_mul_f32 v229, v229, v9
    v_mfma_f32_16x16x32_bf16 v[252:255], v[84:87], v[156:159], v[252:255]
    v_mul_f32 v230, v230, v9
    v_mul_f32 v231, v231, v9
    v_mul_f32 v232, v232, v10
    v_mul_f32 v233, v233, v10
    ds_read_b128 v[64:67], v34
    ds_read_b128 v[68:71], v35
    s_waitcnt lgkmcnt(4)
    v_mul_f32 v234, v234, v10
    v_mul_f32 v235, v235, v10
    v_mul_f32 v236, v236, v11
    v_mul_f32 v237, v237, v11
    v_mul_f32 v238, v238, v11
    v_mul_f32 v239, v239, v11
    v_cvt_pk_bf16_f32 v112, v224, v225
    v_cvt_pk_bf16_f32 v113, v226, v227
    v_cvt_pk_bf16_f32 v116, v228, v229
    v_cvt_pk_bf16_f32 v117, v230, v231
    v_cvt_pk_bf16_f32 v120, v232, v233
    v_cvt_pk_bf16_f32 v121, v234, v235
    v_cvt_pk_bf16_f32 v124, v236, v237
    v_cvt_pk_bf16_f32 v125, v238, v239
    v_mfma_f32_16x16x32_bf16 v[224:227], v[88:91], v[128:131], 0
    v_cvt_pk_bf16_f32 v92, v72, v73
    v_mfma_f32_16x16x32_bf16 v[228:231], v[88:91], v[132:135], 0
    v_cvt_pk_bf16_f32 v93, v74, v75
    v_mfma_f32_16x16x32_bf16 v[232:235], v[88:91], v[136:139], 0
    v_cvt_pk_bf16_f32 v94, v76, v77
    v_mfma_f32_16x16x32_bf16 v[236:239], v[88:91], v[140:143], 0
    v_cvt_pk_bf16_f32 v95, v78, v79
    ds_read_b128 v[72:75], v36
    ds_read_b128 v[76:79], v37
    s_waitcnt lgkmcnt(4)
    v_mfma_f32_16x16x32_bf16 v[224:227], v[92:95], v[144:147], v[224:227]
    v_cvt_pk_bf16_f32 v80, v56, v57
    v_cvt_pk_bf16_f32 v81, v58, v59
    v_cvt_pk_bf16_f32 v82, v60, v61
    v_cvt_pk_bf16_f32 v83, v62, v63
    v_cndmask_b32 v8, v194, v195, s[88:89]
    v_mfma_f32_16x16x32_bf16 v[228:231], v[92:95], v[148:151], v[228:231]
    v_cndmask_b32 v9, v202, v203, s[88:89]
    v_cndmask_b32 v10, v210, v211, s[88:89]
    v_cndmask_b32 v11, v218, v219, s[88:89]
    v_mul_f32 v240, v240, v8
    v_mfma_f32_16x16x32_bf16 v[232:235], v[92:95], v[152:155], v[232:235]
    v_mul_f32 v241, v241, v8
    v_mul_f32 v242, v242, v8
    v_mul_f32 v243, v243, v8
    v_mul_f32 v244, v244, v9
    v_mul_f32 v245, v245, v9
    v_mfma_f32_16x16x32_bf16 v[236:239], v[92:95], v[156:159], v[236:239]
    v_mul_f32 v246, v246, v9
    v_mul_f32 v247, v247, v9
    v_mul_f32 v248, v248, v10
    v_mul_f32 v249, v249, v10
    ds_read_b128 v[56:59], v38
    ds_read_b128 v[60:63], v39
    s_waitcnt lgkmcnt(4)
    v_mfma_f32_16x16x32_bf16 v[196:199], v[80:83], v[144:147], 0
    v_cvt_pk_bf16_f32 v84, v64, v65
    v_cvt_pk_bf16_f32 v85, v66, v67
    v_cvt_pk_bf16_f32 v86, v68, v69
    v_cvt_pk_bf16_f32 v87, v70, v71
    v_mul_f32 v250, v250, v10
    v_mfma_f32_16x16x32_bf16 v[204:207], v[80:83], v[148:151], 0
    v_mul_f32 v251, v251, v10
    v_mul_f32 v252, v252, v11
    v_mul_f32 v253, v253, v11
    v_mul_f32 v254, v254, v11
    v_mfma_f32_16x16x32_bf16 v[212:215], v[80:83], v[152:155], 0
    v_mul_f32 v255, v255, v11
    v_cvt_pk_bf16_f32 v114, v240, v241
    v_cvt_pk_bf16_f32 v115, v242, v243
    v_cvt_pk_bf16_f32 v118, v244, v245
    v_cvt_pk_bf16_f32 v119, v246, v247
    v_mfma_f32_16x16x32_bf16 v[220:223], v[80:83], v[156:159], 0
    v_cvt_pk_bf16_f32 v122, v248, v249
    v_cvt_pk_bf16_f32 v123, v250, v251
    v_cvt_pk_bf16_f32 v126, v252, v253
    v_cvt_pk_bf16_f32 v127, v254, v255
    ds_read_b128 v[64:67], v40
    ds_read_b128 v[68:71], v41
    s_waitcnt lgkmcnt(4)
    v_mfma_f32_16x16x32_bf16 v[196:199], v[84:87], v[160:163], v[196:199]
    v_cvt_pk_bf16_f32 v88, v72, v73
    v_cvt_pk_bf16_f32 v89, v74, v75
    v_cvt_pk_bf16_f32 v90, v76, v77
    v_cvt_pk_bf16_f32 v91, v78, v79
    v_mul_f32 v224, v224, v195
    v_mfma_f32_16x16x32_bf16 v[204:207], v[84:87], v[164:167], v[204:207]
    v_mul_f32 v225, v225, v195
    v_mul_f32 v226, v226, v195
    v_mul_f32 v227, v227, v195
    v_mul_f32 v228, v228, v203
    v_mfma_f32_16x16x32_bf16 v[212:215], v[84:87], v[168:171], v[212:215]
    v_mul_f32 v229, v229, v203
    v_mul_f32 v230, v230, v203
    v_mul_f32 v231, v231, v203
    v_mul_f32 v232, v232, v211
    v_mul_f32 v233, v233, v211
    v_mfma_f32_16x16x32_bf16 v[220:223], v[84:87], v[172:175], v[220:223]
    v_mul_f32 v234, v234, v211
    v_mul_f32 v235, v235, v211
    v_mul_f32 v236, v236, v219
    v_mul_f32 v237, v237, v219
    ds_read_b128 v[72:75], v42
    ds_read_b128 v[76:79], v43
    s_waitcnt lgkmcnt(4)
    v_mfma_f32_16x16x32_bf16 v[196:199], v[88:91], v[176:179], v[196:199]
    v_cvt_pk_bf16_f32 v92, v56, v57
    v_cvt_pk_bf16_f32 v93, v58, v59
    v_cvt_pk_bf16_f32 v94, v60, v61
    v_cvt_pk_bf16_f32 v95, v62, v63
    v_mfma_f32_16x16x32_bf16 v[204:207], v[88:91], v[180:183], v[204:207]
    v_mul_f32 v238, v238, v219
    v_mul_f32 v239, v239, v219
    v_cvt_pk_bf16_f32 v128, v224, v225
    v_mfma_f32_16x16x32_bf16 v[212:215], v[88:91], v[184:187], v[212:215]
    v_cvt_pk_bf16_f32 v129, v226, v227
    v_cvt_pk_bf16_f32 v132, v228, v229
    v_cvt_pk_bf16_f32 v133, v230, v231
    v_cvt_pk_bf16_f32 v136, v232, v233
    v_mfma_f32_16x16x32_bf16 v[220:223], v[88:91], v[188:191], v[220:223]
    v_cvt_pk_bf16_f32 v137, v234, v235
    v_cvt_pk_bf16_f32 v140, v236, v237
    v_cvt_pk_bf16_f32 v141, v238, v239
    ds_read_b128 v[56:59], v44
    ds_read_b128 v[60:63], v45
    s_waitcnt lgkmcnt(4)
    v_mfma_f32_16x16x32_bf16 v[240:243], v[92:95], v[144:147], 0
    v_cvt_pk_bf16_f32 v80, v64, v65
    v_mfma_f32_16x16x32_bf16 v[244:247], v[92:95], v[148:151], 0
    v_cvt_pk_bf16_f32 v81, v66, v67
    v_mfma_f32_16x16x32_bf16 v[248:251], v[92:95], v[152:155], 0
    v_cvt_pk_bf16_f32 v82, v68, v69
    v_mfma_f32_16x16x32_bf16 v[252:255], v[92:95], v[156:159], 0
    v_cvt_pk_bf16_f32 v83, v70, v71
    ds_read_b128 v[64:67], v46
    ds_read_b128 v[68:71], v47
    s_waitcnt lgkmcnt(4)
    v_mfma_f32_16x16x32_bf16 v[240:243], v[80:83], v[160:163], v[240:243]
    v_cvt_pk_bf16_f32 v84, v72, v73
    v_cvt_pk_bf16_f32 v85, v74, v75
    v_cvt_pk_bf16_f32 v86, v76, v77
    v_cvt_pk_bf16_f32 v87, v78, v79
    v_add_f32 v196, 0x358637bd, v196
    v_mfma_f32_16x16x32_bf16 v[244:247], v[80:83], v[164:167], v[244:247]
    v_add_f32 v197, 0x358637bd, v197
    v_add_f32 v198, 0x358637bd, v198
    v_add_f32 v199, 0x358637bd, v199
    v_add_f32 v204, 0x358637bd, v204
    v_mfma_f32_16x16x32_bf16 v[248:251], v[80:83], v[168:171], v[248:251]
    v_add_f32 v205, 0x358637bd, v205
    v_add_f32 v206, 0x358637bd, v206
    v_add_f32 v207, 0x358637bd, v207
    v_add_f32 v212, 0x358637bd, v212
    v_add_f32 v213, 0x358637bd, v213
    v_mfma_f32_16x16x32_bf16 v[252:255], v[80:83], v[172:175], v[252:255]
    v_add_f32 v214, 0x358637bd, v214
    v_add_f32 v215, 0x358637bd, v215
    v_add_f32 v220, 0x358637bd, v220
    v_add_f32 v221, 0x358637bd, v221
    ds_read_b128 v[72:75], v48
    ds_read_b128 v[76:79], v49
    s_waitcnt lgkmcnt(4)
    v_mfma_f32_16x16x32_bf16 v[224:227], v[84:87], v[144:147], 0
    v_cvt_pk_bf16_f32 v88, v56, v57
    v_cvt_pk_bf16_f32 v89, v58, v59
    v_cvt_pk_bf16_f32 v90, v60, v61
    v_cvt_pk_bf16_f32 v91, v62, v63
    v_add_f32 v222, 0x358637bd, v222
    v_mfma_f32_16x16x32_bf16 v[228:231], v[84:87], v[148:151], 0
    v_add_f32 v223, 0x358637bd, v223
    v_rcp_f32 v196, v196
    v_rcp_f32 v197, v197
    v_rcp_f32 v198, v198
    v_mfma_f32_16x16x32_bf16 v[232:235], v[84:87], v[152:155], 0
    v_rcp_f32 v199, v199
    v_rcp_f32 v204, v204
    v_rcp_f32 v205, v205
    v_rcp_f32 v206, v206
    v_rcp_f32 v207, v207
    v_mfma_f32_16x16x32_bf16 v[236:239], v[84:87], v[156:159], 0
    v_rcp_f32 v212, v212
    v_rcp_f32 v213, v213
    v_rcp_f32 v214, v214
    v_rcp_f32 v215, v215
    ds_read_b128 v[56:59], v50
    ds_read_b128 v[60:63], v51
    s_waitcnt lgkmcnt(4)
    v_mfma_f32_16x16x32_bf16 v[224:227], v[88:91], v[160:163], v[224:227]
    v_cvt_pk_bf16_f32 v92, v64, v65
    v_cvt_pk_bf16_f32 v93, v66, v67
    v_cvt_pk_bf16_f32 v94, v68, v69
    v_cvt_pk_bf16_f32 v95, v70, v71
    v_rcp_f32 v220, v220
    v_mfma_f32_16x16x32_bf16 v[228:231], v[88:91], v[164:167], v[228:231]
    v_rcp_f32 v221, v221
    v_rcp_f32 v222, v222
    v_rcp_f32 v223, v223
    v_mul_f32 v240, v240, v196
    v_mfma_f32_16x16x32_bf16 v[232:235], v[88:91], v[168:171], v[232:235]
    v_mul_f32 v241, v241, v196
    v_mul_f32 v242, v242, v196
    v_mul_f32 v243, v243, v196
    v_mul_f32 v244, v244, v204
    v_mul_f32 v245, v245, v204
    v_mfma_f32_16x16x32_bf16 v[236:239], v[88:91], v[172:175], v[236:239]
    v_mul_f32 v246, v246, v204
    v_mul_f32 v247, v247, v204
    v_mul_f32 v248, v248, v212
    v_mul_f32 v249, v249, v212
    ds_read_b128 v[64:67], v52
    ds_read_b128 v[68:71], v53
    s_waitcnt lgkmcnt(4)
    v_mul_f32 v250, v250, v212
    v_mul_f32 v251, v251, v212
    v_mul_f32 v252, v252, v220
    v_mul_f32 v253, v253, v220
    v_mul_f32 v254, v254, v220
    v_mul_f32 v255, v255, v220
    v_cvt_pk_bf16_f32 v130, v240, v241
    v_cvt_pk_bf16_f32 v131, v242, v243
    v_cvt_pk_bf16_f32 v134, v244, v245
    v_cvt_pk_bf16_f32 v135, v246, v247
    v_cvt_pk_bf16_f32 v138, v248, v249
    v_cvt_pk_bf16_f32 v139, v250, v251
    v_cvt_pk_bf16_f32 v142, v252, v253
    v_cvt_pk_bf16_f32 v143, v254, v255
    v_mfma_f32_16x16x32_bf16 v[240:243], v[92:95], v[160:163], 0
    v_cvt_pk_bf16_f32 v80, v72, v73
    v_mfma_f32_16x16x32_bf16 v[244:247], v[92:95], v[164:167], 0
    v_cvt_pk_bf16_f32 v81, v74, v75
    v_mfma_f32_16x16x32_bf16 v[248:251], v[92:95], v[168:171], 0
    v_cvt_pk_bf16_f32 v82, v76, v77
    v_mfma_f32_16x16x32_bf16 v[252:255], v[92:95], v[172:175], 0
    v_cvt_pk_bf16_f32 v83, v78, v79
    ds_read_b128 v[72:75], v54
    ds_read_b128 v[76:79], v55
    s_waitcnt lgkmcnt(4)
    v_mfma_f32_16x16x32_bf16 v[240:243], v[80:83], v[176:179], v[240:243]
    v_cvt_pk_bf16_f32 v84, v56, v57
    v_cvt_pk_bf16_f32 v85, v58, v59
    v_cvt_pk_bf16_f32 v86, v60, v61
    v_cvt_pk_bf16_f32 v87, v62, v63
    v_cndmask_b32 v8, v196, v197, s[84:85]
    v_mfma_f32_16x16x32_bf16 v[244:247], v[80:83], v[180:183], v[244:247]
    v_cndmask_b32 v9, v204, v205, s[84:85]
    v_cndmask_b32 v10, v212, v213, s[84:85]
    v_cndmask_b32 v11, v220, v221, s[84:85]
    v_mul_f32 v224, v224, v8
    v_mfma_f32_16x16x32_bf16 v[248:251], v[80:83], v[184:187], v[248:251]
    v_mul_f32 v225, v225, v8
    v_mul_f32 v226, v226, v8
    v_mul_f32 v227, v227, v8
    v_mul_f32 v228, v228, v9
    v_mul_f32 v229, v229, v9
    v_mfma_f32_16x16x32_bf16 v[252:255], v[80:83], v[188:191], v[252:255]
    v_mul_f32 v230, v230, v9
    v_mul_f32 v231, v231, v9
    v_mul_f32 v232, v232, v10
    v_mul_f32 v233, v233, v10
    s_waitcnt lgkmcnt(2)
    v_mul_f32 v234, v234, v10
    v_mul_f32 v235, v235, v10
    v_mul_f32 v236, v236, v11
    v_mul_f32 v237, v237, v11
    v_mul_f32 v238, v238, v11
    v_mul_f32 v239, v239, v11
    v_cvt_pk_bf16_f32 v144, v224, v225
    v_cvt_pk_bf16_f32 v145, v226, v227
    v_cvt_pk_bf16_f32 v148, v228, v229
    v_cvt_pk_bf16_f32 v149, v230, v231
    v_cvt_pk_bf16_f32 v152, v232, v233
    v_cvt_pk_bf16_f32 v153, v234, v235
    v_cvt_pk_bf16_f32 v156, v236, v237
    v_cvt_pk_bf16_f32 v157, v238, v239
    v_mfma_f32_16x16x32_bf16 v[224:227], v[84:87], v[160:163], 0
    v_cvt_pk_bf16_f32 v88, v64, v65
    v_mfma_f32_16x16x32_bf16 v[228:231], v[84:87], v[164:167], 0
    v_cvt_pk_bf16_f32 v89, v66, v67
    v_mfma_f32_16x16x32_bf16 v[232:235], v[84:87], v[168:171], 0
    v_cvt_pk_bf16_f32 v90, v68, v69
    v_mfma_f32_16x16x32_bf16 v[236:239], v[84:87], v[172:175], 0
    v_cvt_pk_bf16_f32 v91, v70, v71
    s_waitcnt lgkmcnt(0)
    s_nop 0
    v_mfma_f32_16x16x32_bf16 v[224:227], v[88:91], v[176:179], v[224:227]
    v_cvt_pk_bf16_f32 v92, v72, v73
    v_cvt_pk_bf16_f32 v93, v74, v75
    v_cvt_pk_bf16_f32 v94, v76, v77
    v_cvt_pk_bf16_f32 v95, v78, v79
    v_cndmask_b32 v8, v197, v198, s[86:87]
    v_mfma_f32_16x16x32_bf16 v[228:231], v[88:91], v[180:183], v[228:231]
    v_cndmask_b32 v9, v205, v206, s[86:87]
    v_cndmask_b32 v10, v213, v214, s[86:87]
    v_cndmask_b32 v11, v221, v222, s[86:87]
    v_mul_f32 v240, v240, v8
    v_mfma_f32_16x16x32_bf16 v[232:235], v[88:91], v[184:187], v[232:235]
    v_mul_f32 v241, v241, v8
    v_mul_f32 v242, v242, v8
    v_mul_f32 v243, v243, v8
    v_mul_f32 v244, v244, v9
    v_mul_f32 v245, v245, v9
    v_mfma_f32_16x16x32_bf16 v[236:239], v[88:91], v[188:191], v[236:239]
    v_mul_f32 v246, v246, v9
    v_mul_f32 v247, v247, v9
    v_mul_f32 v248, v248, v10
    v_mul_f32 v249, v249, v10
    v_mul_f32 v250, v250, v10
    v_mul_f32 v251, v251, v10
    v_mul_f32 v252, v252, v11
    v_mul_f32 v253, v253, v11
    v_mul_f32 v254, v254, v11
    v_mul_f32 v255, v255, v11
    v_cvt_pk_bf16_f32 v146, v240, v241
    v_cvt_pk_bf16_f32 v147, v242, v243
    v_cvt_pk_bf16_f32 v150, v244, v245
    v_cvt_pk_bf16_f32 v151, v246, v247
    v_cvt_pk_bf16_f32 v154, v248, v249
    v_cvt_pk_bf16_f32 v155, v250, v251
    v_cvt_pk_bf16_f32 v158, v252, v253
    v_cvt_pk_bf16_f32 v159, v254, v255
    v_mfma_f32_16x16x32_bf16 v[240:243], v[92:95], v[176:179], 0
    v_mfma_f32_16x16x32_bf16 v[244:247], v[92:95], v[180:183], 0
    v_mfma_f32_16x16x32_bf16 v[248:251], v[92:95], v[184:187], 0
    v_mfma_f32_16x16x32_bf16 v[252:255], v[92:95], v[188:191], 0
    v_cndmask_b32 v8, v198, v199, s[88:89]
    v_cndmask_b32 v9, v206, v207, s[88:89]
    v_cndmask_b32 v10, v214, v215, s[88:89]
    v_cndmask_b32 v11, v222, v223, s[88:89]
    v_mul_f32 v224, v224, v8
    v_mul_f32 v225, v225, v8
    v_mul_f32 v226, v226, v8
    v_mul_f32 v227, v227, v8
    v_mul_f32 v228, v228, v9
    v_mul_f32 v229, v229, v9
    v_mul_f32 v230, v230, v9
    v_mul_f32 v231, v231, v9
    v_mul_f32 v232, v232, v10
    v_mul_f32 v233, v233, v10
    v_mul_f32 v234, v234, v10
    v_mul_f32 v235, v235, v10
    v_mul_f32 v236, v236, v11
    v_mul_f32 v237, v237, v11
    v_mul_f32 v238, v238, v11
    v_mul_f32 v239, v239, v11
    v_cvt_pk_bf16_f32 v160, v224, v225
    v_cvt_pk_bf16_f32 v161, v226, v227
    v_cvt_pk_bf16_f32 v164, v228, v229
    v_cvt_pk_bf16_f32 v165, v230, v231
    v_cvt_pk_bf16_f32 v168, v232, v233
    v_cvt_pk_bf16_f32 v169, v234, v235
    v_cvt_pk_bf16_f32 v172, v236, v237
    v_cvt_pk_bf16_f32 v173, v238, v239
    v_mul_f32 v240, v240, v199
    v_mul_f32 v241, v241, v199
    v_mul_f32 v242, v242, v199
    v_mul_f32 v243, v243, v199
    v_mul_f32 v244, v244, v207
    v_mul_f32 v245, v245, v207
    v_mul_f32 v246, v246, v207
    v_mul_f32 v247, v247, v207
    v_mul_f32 v248, v248, v215
    v_mul_f32 v249, v249, v215
    v_mul_f32 v250, v250, v215
    v_mul_f32 v251, v251, v215
    v_mul_f32 v252, v252, v223
    v_mul_f32 v253, v253, v223
    v_mul_f32 v254, v254, v223
    v_mul_f32 v255, v255, v223
    v_cvt_pk_bf16_f32 v162, v240, v241
    v_cvt_pk_bf16_f32 v163, v242, v243
    v_cvt_pk_bf16_f32 v166, v244, v245
    v_cvt_pk_bf16_f32 v167, v246, v247
    v_cvt_pk_bf16_f32 v170, v248, v249
    v_cvt_pk_bf16_f32 v171, v250, v251
    v_cvt_pk_bf16_f32 v174, v252, v253
    v_cvt_pk_bf16_f32 v175, v254, v255
    s_setprio 0
    v_add_u32 v2, s4, v5
    s_nop 11
    ds_read_b128 v[192:195], v2 offset:0
    ds_read_b128 v[196:199], v2 offset:1024
    ds_read_b128 v[200:203], v2 offset:2048
    ds_read_b128 v[204:207], v2 offset:3072
    ds_read_b128 v[208:211], v2 offset:4096
    s_waitcnt lgkmcnt(0)
    v_mov_b32 v3, 1
    ds_write_b32 v4, v3 offset:16
    v_mfma_f32_16x16x32_bf16 v[8:11], v[192:195], v[96:99], 0
    s_add_u32 s11, s56, 0
    s_lshr_b32 s12, s11, 2
    v_mfma_f32_16x16x32_bf16 v[12:15], v[192:195], v[100:103], 0
    s_and_b32 s13, s11, 3
    s_lshl_b32 s14, s16, 6
    v_mfma_f32_16x16x32_bf16 v[16:19], v[192:195], v[104:107], 0
    s_lshl_b32 s13, s13, 4
    s_add_u32 s14, s14, s13
    v_mfma_f32_16x16x32_bf16 v[20:23], v[192:195], v[108:111], 0
    s_mul_i32 s14, s14, 1280
    s_mul_i32 s15, s17, 160
    v_mfma_f32_16x16x32_bf16 v[24:27], v[196:199], v[96:99], 0
    ds_read_b128 v[212:215], v2 offset:5120
    s_add_u32 s14, s14, s15
    s_lshl_b32 s12, s12, 5
    v_mfma_f32_16x16x32_bf16 v[28:31], v[196:199], v[100:103], 0
    ds_read_b128 v[216:219], v2 offset:6144
    s_add_u32 s14, s14, s12
    s_cmp_lt_u32 s11, 20
    v_mfma_f32_16x16x32_bf16 v[32:35], v[196:199], v[104:107], 0
    s_cselect_b32 s14, s14, 1073741824
    v_and_b32 v6, 15, v1
    v_mfma_f32_16x16x32_bf16 v[36:39], v[196:199], v[108:111], 0
    ds_read_b128 v[220:223], v2 offset:7168
    v_mul_u32_u24 v6, 1280, v6
    v_lshrrev_b32 v7, 4, v1
    v_mfma_f32_16x16x32_bf16 v[40:43], v[200:203], v[96:99], 0
    ds_read_b128 v[224:227], v2 offset:8192
    v_lshl_add_u32 v6, v7, 3, v6
    v_add_u32 v238, s14, v6
    v_mfma_f32_16x16x32_bf16 v[44:47], v[200:203], v[100:103], 0
    buffer_load_dwordx2 v[232:233], v238, s[36:39], 0 offen
    v_mfma_f32_16x16x32_bf16 v[48:51], v[200:203], v[104:107], 0
    ds_read_b128 v[228:231], v2 offset:9216
    s_lshl_b32 s12, s11, 10
    s_add_u32 s13, s12, 37888
    v_mfma_f32_16x16x32_bf16 v[52:55], v[200:203], v[108:111], 0
    v_add_u32 v241, s13, v5
    s_add_u32 s13, s12, 0
    v_mfma_f32_16x16x32_bf16 v[56:59], v[204:207], v[96:99], 0
    s_add_u32 s14, s12, 18432
    s_cmp_lt_u32 s11, 14
    v_mfma_f32_16x16x32_bf16 v[60:63], v[204:207], v[100:103], 0
    s_cselect_b32 s13, s13, s14
    s_cmp_lt_u32 s11, 19
    v_mfma_f32_16x16x32_bf16 v[64:67], v[204:207], v[104:107], 0
    s_cselect_b32 s13, s13, 28672
    v_add_u32 v242, s13, v5
    v_mfma_f32_16x16x32_bf16 v[68:71], v[204:207], v[108:111], 0
    s_add_u32 s13, s12, 14336
    s_add_u32 s14, s12, 44032
    v_mfma_f32_16x16x32_bf16 v[72:75], v[208:211], v[96:99], 0
    s_cmp_lt_u32 s11, 14
    s_cselect_b32 s13, s13, s14
    v_mfma_f32_16x16x32_bf16 v[76:79], v[208:211], v[100:103], 0
    s_cmp_lt_u32 s11, 19
    s_cselect_b32 s13, s13, 29696
    v_mfma_f32_16x16x32_bf16 v[80:83], v[208:211], v[104:107], 0
    v_add_u32 v243, s13, v5
    s_add_u32 s13, s12, 135168
    v_mfma_f32_16x16x32_bf16 v[84:87], v[208:211], v[108:111], 0
    s_add_u32 s14, s12, 69632
    s_waitcnt lgkmcnt(0)
    v_mfma_f32_16x16x32_bf16 v[8:11], v[212:215], v[112:115], v[8:11]
    s_cmp_lt_u32 s11, 14
    s_cselect_b32 s13, s13, s14
    v_mfma_f32_16x16x32_bf16 v[12:15], v[212:215], v[116:119], v[12:15]
    s_cmp_lt_u32 s11, 19
    s_cselect_b32 s13, s13, 30720
    v_mfma_f32_16x16x32_bf16 v[16:19], v[212:215], v[120:123], v[16:19]
    v_add_u32 v244, s13, v5
    s_add_u32 s13, s12, 149504
    v_mfma_f32_16x16x32_bf16 v[20:23], v[212:215], v[124:127], v[20:23]
    s_add_u32 s14, s12, 95232
    s_cmp_lt_u32 s11, 14
    v_mfma_f32_16x16x32_bf16 v[24:27], v[216:219], v[112:115], v[24:27]
    ds_read_b128 v[192:195], v2 offset:10240
    s_cselect_b32 s13, s13, s14
    s_cmp_lt_u32 s11, 19
    v_mfma_f32_16x16x32_bf16 v[28:31], v[216:219], v[116:119], v[28:31]
    ds_read_b128 v[196:199], v2 offset:11264
    s_cselect_b32 s13, s13, 31744
    v_add_u32 v245, s13, v5
    v_mfma_f32_16x16x32_bf16 v[32:35], v[216:219], v[120:123], v[32:35]
    s_add_u32 s11, s56, 8
    s_lshr_b32 s12, s11, 2
    v_mfma_f32_16x16x32_bf16 v[36:39], v[216:219], v[124:127], v[36:39]
    ds_read_b128 v[200:203], v2 offset:12288
    s_and_b32 s13, s11, 3
    s_lshl_b32 s14, s16, 6
    v_mfma_f32_16x16x32_bf16 v[40:43], v[220:223], v[112:115], v[40:43]
    ds_read_b128 v[204:207], v2 offset:13312
    s_lshl_b32 s13, s13, 4
    s_add_u32 s14, s14, s13
    v_mfma_f32_16x16x32_bf16 v[44:47], v[220:223], v[116:119], v[44:47]
    s_mul_i32 s14, s14, 1280
    v_mfma_f32_16x16x32_bf16 v[48:51], v[220:223], v[120:123], v[48:51]
    ds_read_b128 v[208:211], v2 offset:14336
    s_mul_i32 s15, s17, 160
    s_add_u32 s14, s14, s15
    v_mfma_f32_16x16x32_bf16 v[52:55], v[220:223], v[124:127], v[52:55]
    s_lshl_b32 s12, s12, 5
    s_add_u32 s14, s14, s12
    v_mfma_f32_16x16x32_bf16 v[56:59], v[224:227], v[112:115], v[56:59]
    s_cmp_lt_u32 s11, 20
    s_cselect_b32 s14, s14, 1073741824
    v_mfma_f32_16x16x32_bf16 v[60:63], v[224:227], v[116:119], v[60:63]
    v_and_b32 v6, 15, v1
    v_mul_u32_u24 v6, 1280, v6
    v_mfma_f32_16x16x32_bf16 v[64:67], v[224:227], v[120:123], v[64:67]
    v_lshrrev_b32 v7, 4, v1
    v_lshl_add_u32 v6, v7, 3, v6
    v_mfma_f32_16x16x32_bf16 v[68:71], v[224:227], v[124:127], v[68:71]
    v_add_u32 v239, s14, v6
    buffer_load_dwordx2 v[234:235], v239, s[36:39], 0 offen
    v_mfma_f32_16x16x32_bf16 v[72:75], v[228:231], v[112:115], v[72:75]
    s_lshl_b32 s12, s11, 10
    s_add_u32 s13, s12, 37888
    v_mfma_f32_16x16x32_bf16 v[76:79], v[228:231], v[116:119], v[76:79]
    v_add_u32 v246, s13, v5
    s_add_u32 s13, s12, 0
    v_mfma_f32_16x16x32_bf16 v[80:83], v[228:231], v[120:123], v[80:83]
    s_add_u32 s14, s12, 18432
    s_cmp_lt_u32 s11, 14
    v_mfma_f32_16x16x32_bf16 v[84:87], v[228:231], v[124:127], v[84:87]
    s_cselect_b32 s13, s13, s14
    s_waitcnt lgkmcnt(0)
    v_mfma_f32_16x16x32_bf16 v[8:11], v[192:195], v[128:131], v[8:11]
    s_cmp_lt_u32 s11, 19
    s_cselect_b32 s13, s13, 28672
    v_mfma_f32_16x16x32_bf16 v[12:15], v[192:195], v[132:135], v[12:15]
    v_add_u32 v247, s13, v5
    s_add_u32 s13, s12, 14336
    v_mfma_f32_16x16x32_bf16 v[16:19], v[192:195], v[136:139], v[16:19]
    s_add_u32 s14, s12, 44032
    s_cmp_lt_u32 s11, 14
    v_mfma_f32_16x16x32_bf16 v[20:23], v[192:195], v[140:143], v[20:23]
    s_cselect_b32 s13, s13, s14
    s_cmp_lt_u32 s11, 19
    v_mfma_f32_16x16x32_bf16 v[24:27], v[196:199], v[128:131], v[24:27]
    ds_read_b128 v[212:215], v2 offset:15360
    s_cselect_b32 s13, s13, 29696
    v_add_u32 v248, s13, v5
    v_mfma_f32_16x16x32_bf16 v[28:31], v[196:199], v[132:135], v[28:31]
    ds_read_b128 v[216:219], v2 offset:16384
    s_add_u32 s13, s12, 135168
    s_add_u32 s14, s12, 69632
    v_mfma_f32_16x16x32_bf16 v[32:35], v[196:199], v[136:139], v[32:35]
    s_cmp_lt_u32 s11, 14
    s_cselect_b32 s13, s13, s14
    v_mfma_f32_16x16x32_bf16 v[36:39], v[196:199], v[140:143], v[36:39]
    ds_read_b128 v[220:223], v2 offset:17408
    s_cmp_lt_u32 s11, 19
    s_cselect_b32 s13, s13, 30720
    v_mfma_f32_16x16x32_bf16 v[40:43], v[200:203], v[128:131], v[40:43]
    ds_read_b128 v[224:227], v2 offset:18432
    v_add_u32 v249, s13, v5
    s_add_u32 s13, s12, 149504
    v_mfma_f32_16x16x32_bf16 v[44:47], v[200:203], v[132:135], v[44:47]
    s_add_u32 s14, s12, 95232
    v_mfma_f32_16x16x32_bf16 v[48:51], v[200:203], v[136:139], v[48:51]
    ds_read_b128 v[228:231], v2 offset:19456
    s_cmp_lt_u32 s11, 14
    s_cselect_b32 s13, s13, s14
    v_mfma_f32_16x16x32_bf16 v[52:55], v[200:203], v[140:143], v[52:55]
    s_cmp_lt_u32 s11, 19
    s_cselect_b32 s13, s13, 31744
    v_mfma_f32_16x16x32_bf16 v[56:59], v[204:207], v[128:131], v[56:59]
    v_add_u32 v250, s13, v5
    s_add_u32 s11, s56, 16
    v_mfma_f32_16x16x32_bf16 v[60:63], v[204:207], v[132:135], v[60:63]
    s_lshr_b32 s12, s11, 2
    s_and_b32 s13, s11, 3
    v_mfma_f32_16x16x32_bf16 v[64:67], v[204:207], v[136:139], v[64:67]
    s_lshl_b32 s14, s16, 6
    s_lshl_b32 s13, s13, 4
    v_mfma_f32_16x16x32_bf16 v[68:71], v[204:207], v[140:143], v[68:71]
    s_add_u32 s14, s14, s13
    s_mul_i32 s14, s14, 1280
    v_mfma_f32_16x16x32_bf16 v[72:75], v[208:211], v[128:131], v[72:75]
    s_mul_i32 s15, s17, 160
    s_add_u32 s14, s14, s15
    v_mfma_f32_16x16x32_bf16 v[76:79], v[208:211], v[132:135], v[76:79]
    s_lshl_b32 s12, s12, 5
    s_add_u32 s14, s14, s12
    v_mfma_f32_16x16x32_bf16 v[80:83], v[208:211], v[136:139], v[80:83]
    s_cmp_lt_u32 s11, 20
    s_cselect_b32 s14, s14, 1073741824
    v_mfma_f32_16x16x32_bf16 v[84:87], v[208:211], v[140:143], v[84:87]
    v_and_b32 v6, 15, v1
    s_waitcnt lgkmcnt(0)
    v_mfma_f32_16x16x32_bf16 v[8:11], v[212:215], v[144:147], v[8:11]
    v_mul_u32_u24 v6, 1280, v6
    v_lshrrev_b32 v7, 4, v1
    v_mfma_f32_16x16x32_bf16 v[12:15], v[212:215], v[148:151], v[12:15]
    v_lshl_add_u32 v6, v7, 3, v6
    v_add_u32 v240, s14, v6
    v_mfma_f32_16x16x32_bf16 v[16:19], v[212:215], v[152:155], v[16:19]
    buffer_load_dwordx2 v[236:237], v240, s[36:39], 0 offen
    s_lshl_b32 s12, s11, 10
    v_mfma_f32_16x16x32_bf16 v[20:23], v[212:215], v[156:159], v[20:23]
    s_add_u32 s13, s12, 37888
    v_add_u32 v251, s13, v5
    v_mfma_f32_16x16x32_bf16 v[24:27], v[216:219], v[144:147], v[24:27]
    ds_read_b128 v[192:195], v2 offset:20480
    s_add_u32 s13, s12, 0
    v_mfma_f32_16x16x32_bf16 v[28:31], v[216:219], v[148:151], v[28:31]
    ds_read_b128 v[196:199], v2 offset:21504
    s_add_u32 s14, s12, 18432
    s_cmp_lt_u32 s11, 14
    v_mfma_f32_16x16x32_bf16 v[32:35], v[216:219], v[152:155], v[32:35]
    s_cselect_b32 s13, s13, s14
    s_cmp_lt_u32 s11, 19
    v_mfma_f32_16x16x32_bf16 v[36:39], v[216:219], v[156:159], v[36:39]
    ds_read_b128 v[200:203], v2 offset:22528
    s_cselect_b32 s13, s13, 28672
    v_add_u32 v252, s13, v5
    v_mfma_f32_16x16x32_bf16 v[40:43], v[220:223], v[144:147], v[40:43]
    ds_read_b128 v[204:207], v2 offset:23552
    s_add_u32 s13, s12, 14336
    s_add_u32 s14, s12, 44032
    v_mfma_f32_16x16x32_bf16 v[44:47], v[220:223], v[148:151], v[44:47]
    s_cmp_lt_u32 s11, 14
    v_mfma_f32_16x16x32_bf16 v[48:51], v[220:223], v[152:155], v[48:51]
    ds_read_b128 v[208:211], v2 offset:24576
    s_cselect_b32 s13, s13, s14
    s_cmp_lt_u32 s11, 19
    v_mfma_f32_16x16x32_bf16 v[52:55], v[220:223], v[156:159], v[52:55]
    s_cselect_b32 s13, s13, 29696
    v_add_u32 v253, s13, v5
    v_mfma_f32_16x16x32_bf16 v[56:59], v[224:227], v[144:147], v[56:59]
    s_add_u32 s13, s12, 135168
    s_add_u32 s14, s12, 69632
    v_mfma_f32_16x16x32_bf16 v[60:63], v[224:227], v[148:151], v[60:63]
    s_cmp_lt_u32 s11, 14
    s_cselect_b32 s13, s13, s14
    v_mfma_f32_16x16x32_bf16 v[64:67], v[224:227], v[152:155], v[64:67]
    s_cmp_lt_u32 s11, 19
    v_mfma_f32_16x16x32_bf16 v[68:71], v[224:227], v[156:159], v[68:71]
    s_cselect_b32 s13, s13, 30720
    v_add_u32 v254, s13, v5
    v_mfma_f32_16x16x32_bf16 v[72:75], v[228:231], v[144:147], v[72:75]
    s_add_u32 s13, s12, 149504
    s_add_u32 s14, s12, 95232
    v_mfma_f32_16x16x32_bf16 v[76:79], v[228:231], v[148:151], v[76:79]
    s_cmp_lt_u32 s11, 14
    s_cselect_b32 s13, s13, s14
    v_mfma_f32_16x16x32_bf16 v[80:83], v[228:231], v[152:155], v[80:83]
    s_cmp_lt_u32 s11, 19
    s_cselect_b32 s13, s13, 31744
    v_mfma_f32_16x16x32_bf16 v[84:87], v[228:231], v[156:159], v[84:87]
    v_add_u32 v255, s13, v5
    s_waitcnt lgkmcnt(0)
    v_mfma_f32_16x16x32_bf16 v[8:11], v[192:195], v[160:163], v[8:11]
    v_mfma_f32_16x16x32_bf16 v[12:15], v[192:195], v[164:167], v[12:15]
    v_mfma_f32_16x16x32_bf16 v[16:19], v[192:195], v[168:171], v[16:19]
    v_mfma_f32_16x16x32_bf16 v[20:23], v[192:195], v[172:175], v[20:23]
    v_mfma_f32_16x16x32_bf16 v[24:27], v[196:199], v[160:163], v[24:27]
    v_mfma_f32_16x16x32_bf16 v[28:31], v[196:199], v[164:167], v[28:31]
    v_mfma_f32_16x16x32_bf16 v[32:35], v[196:199], v[168:171], v[32:35]
    s_nop 1
    ds_write_b128 v2, v[8:11] offset:5120
    v_mfma_f32_16x16x32_bf16 v[36:39], v[196:199], v[172:175], v[36:39]
    ds_write_b128 v2, v[12:15] offset:6144
    v_mfma_f32_16x16x32_bf16 v[40:43], v[200:203], v[160:163], v[40:43]
    ds_write_b128 v2, v[16:19] offset:7168
    v_mfma_f32_16x16x32_bf16 v[44:47], v[200:203], v[164:167], v[44:47]
    ds_write_b128 v2, v[20:23] offset:8192
    v_mfma_f32_16x16x32_bf16 v[48:51], v[200:203], v[168:171], v[48:51]
    ds_write_b128 v2, v[24:27] offset:9216
    v_mfma_f32_16x16x32_bf16 v[52:55], v[200:203], v[172:175], v[52:55]
    ds_write_b128 v2, v[28:31] offset:10240
    v_mfma_f32_16x16x32_bf16 v[56:59], v[204:207], v[160:163], v[56:59]
    ds_write_b128 v2, v[32:35] offset:11264
    v_mfma_f32_16x16x32_bf16 v[60:63], v[204:207], v[164:167], v[60:63]
    ds_write_b128 v2, v[36:39] offset:12288
    v_mfma_f32_16x16x32_bf16 v[64:67], v[204:207], v[168:171], v[64:67]
    ds_write_b128 v2, v[40:43] offset:13312
    v_mfma_f32_16x16x32_bf16 v[68:71], v[204:207], v[172:175], v[68:71]
    ds_write_b128 v2, v[44:47] offset:14336
    v_mfma_f32_16x16x32_bf16 v[72:75], v[208:211], v[160:163], v[72:75]
    ds_write_b128 v2, v[48:51] offset:15360
    v_mfma_f32_16x16x32_bf16 v[76:79], v[208:211], v[164:167], v[76:79]
    ds_write_b128 v2, v[52:55] offset:16384
    v_mfma_f32_16x16x32_bf16 v[80:83], v[208:211], v[168:171], v[80:83]
    ds_write_b128 v2, v[56:59] offset:17408
    v_mfma_f32_16x16x32_bf16 v[84:87], v[208:211], v[172:175], v[84:87]
    ds_write_b128 v2, v[60:63] offset:18432
    s_nop 11
    ds_write_b128 v2, v[64:67] offset:19456
    ds_write_b128 v2, v[68:71] offset:20480
    ds_write_b128 v2, v[72:75] offset:21504
    ds_write_b128 v2, v[76:79] offset:22528
    ds_write_b128 v2, v[80:83] offset:23552
    ds_write_b128 v2, v[84:87] offset:24576
    s_branch L2_reduce
L2_ffn:
    s_waitcnt vmcnt(0) lgkmcnt(0)
    s_barrier
    s_cmp_lg_u32 s65, 0
    s_cbranch_scc1 L2_ws
    s_sub_u32 s3, s56, 4
    s_mul_i32 s4, s3, 14
    s_cmp_eq_u32 s3, 3
    s_cselect_b32 s5, 1, 0
    s_sub_u32 s4, s4, s5
    s_cmp_ge_u32 s3, 2
    s_cselect_b32 s5, 13, 14
    s_cselect_b32 s26, 1073741824, 0
    s_and_b32 s6, s16, 3
    s_lshl_b32 s6, s6, 1
    s_add_u32 s6, s6, s17
    s_mul_i32 s6, s6, 7
    s_lshr_b32 s6, s6, 2
    s_sub_u32 s7, s6, s5
    s_cmp_ge_u32 s6, s5
    s_cselect_b32 s6, s7, s6
    s_mul_i32 s22, s16, 54
    s_add_u32 s22, s22, s4
    s_lshl_b32 s22, s22, 12
    s_lshl_b32 s7, s5, 12
    s_add_u32 s23, s22, s7
    s_lshl_b32 s7, s6, 12
    s_add_u32 s18, s22, s7
    s_mul_i32 s24, s17, 74
    s_add_u32 s24, s24, s4
    s_mul_i32 s24, s24, 5120
    s_add_u32 s24, s24, 10485760
    s_mul_i32 s7, s5, 5120
    s_add_u32 s25, s24, s7
    s_mul_i32 s7, s6, 5120
    s_add_u32 s19, s24, s7
L2_ws:
    s_sub_u32 s10, s56, 4
    s_lshl_b32 s10, s10, 1
    s_lshl_b32 s10, 7, s10
    v_mov_b32 v3, 0
    s_cmp_gt_u32 s65, 1
    s_cbranch_scc1 L2_w0
    buffer_load_dwordx4 v[8:11], v5, s[44:47], s19 offen offset:0 sc1
    buffer_load_dwordx4 v[12:15], v5, s[44:47], s19 offen offset:1024 sc1
    buffer_load_dwordx4 v[16:19], v5, s[44:47], s19 offen offset:2048 sc1
    buffer_load_dwordx4 v[20:23], v5, s[44:47], s19 offen offset:3072 sc1
    s_add_u32 s3, s19, 4096
    buffer_load_dwordx4 v[24:27], v5, s[44:47], s3 offen sc1
    s_add_u32 s19, s19, 5120
    s_cmp_eq_u32 s19, s25
    s_cselect_b32 s19, s24, s19
    buffer_load_dwordx4 v[28:31], v5, s[44:47], s19 offen offset:0 sc1
    buffer_load_dwordx4 v[32:35], v5, s[44:47], s19 offen offset:1024 sc1
    buffer_load_dwordx4 v[36:39], v5, s[44:47], s19 offen offset:2048 sc1
    buffer_load_dwordx4 v[40:43], v5, s[44:47], s19 offen offset:3072 sc1
    s_add_u32 s3, s19, 4096
    buffer_load_dwordx4 v[44:47], v5, s[44:47], s3 offen sc1
    s_add_u32 s19, s19, 5120
    s_cmp_eq_u32 s19, s25
    s_cselect_b32 s19, s24, s19
L2_w0:
    buffer_load_dwordx4 v[48:51], v5, s[44:47], s19 offen offset:0 sc1
    buffer_load_dwordx4 v[52:55], v5, s[44:47], s19 offen offset:1024 sc1
    buffer_load_dwordx4 v[128:131], v5, s[44:47], s19 offen offset:2048 sc1
    buffer_load_dwordx4 v[132:135], v5, s[44:47], s19 offen offset:3072 sc1
    s_add_u32 s3, s19, 4096
    buffer_load_dwordx4 v[136:139], v5, s[44:47], s3 offen sc1
    s_add_u32 s19, s19, 5120
    s_cmp_eq_u32 s19, s25
    s_cselect_b32 s19, s24, s19
    buffer_load_dwordx4 v[140:143], v5, s[44:47], s19 offen offset:0 sc1
    buffer_load_dwordx4 v[144:147], v5, s[44:47], s19 offen offset:1024 sc1
    buffer_load_dwordx4 v[148:151], v5, s[44:47], s19 offen offset:2048 sc1
    buffer_load_dwordx4 v[248:251], v5, s[44:47], s19 offen offset:3072 sc1
    s_add_u32 s3, s19, 4096
    buffer_load_dwordx4 v[252:255], v5, s[44:47], s3 offen sc1
    s_add_u32 s19, s19, 5120
    s_cmp_eq_u32 s19, s25
    s_cselect_b32 s19, s24, s19
    buffer_load_dwordx4 v[112:115], v5, s[44:47], s19 offen offset:0 sc1
    buffer_load_dwordx4 v[116:119], v5, s[44:47], s19 offen offset:1024 sc1
    buffer_load_dwordx4 v[120:123], v5, s[44:47], s19 offen offset:2048 sc1
    buffer_load_dwordx4 v[124:127], v5, s[44:47], s19 offen offset:3072 sc1
    s_add_u32 s3, s19, 4096
    buffer_load_dwordx4 v[152:155], v5, s[44:47], s3 offen sc1
    s_add_u32 s19, s19, 5120
    s_cmp_eq_u32 s19, s25
    s_cselect_b32 s19, s24, s19
    buffer_load_dwordx4 v[156:159], v5, s[44:47], s19 offen offset:0 sc1
    buffer_load_dwordx4 v[160:163], v5, s[44:47], s19 offen offset:1024 sc1
    buffer_load_dwordx4 v[164:167], v5, s[44:47], s19 offen offset:2048 sc1
    buffer_load_dwordx4 v[200:203], v5, s[44:47], s19 offen offset:3072 sc1
    s_add_u32 s3, s19, 4096
    buffer_load_dwordx4 v[204:207], v5, s[44:47], s3 offen sc1
    s_add_u32 s19, s19, 5120
    s_cmp_eq_u32 s19, s25
    s_cselect_b32 s19, s24, s19
    s_mov_b32 s78, 0
    v_mov_b32 v3, 0
L2_h:
    buffer_load_dword v2, v3, s[44:47], s64 offen sc1
    s_waitcnt vmcnt(0)
    v_readfirstlane_b32 s75, v2
    s_add_u32 s78, s78, 1
    s_and_b32 s75, s75, s10
    s_cmp_ge_u32 s75, s10
    s_cbranch_scc1 L2_h_ok
    s_cmp_gt_u32 s78, 1048576
    s_cbranch_scc1 L2_h_ok
    s_sleep 2
    s_branch L2_h
L2_h_ok:
    buffer_load_dwordx4 v[192:195], v5, s[44:47], s18 offen offset:0 sc1
    buffer_load_dwordx4 v[196:199], v5, s[44:47], s18 offen offset:1024 sc1
    buffer_load_dwordx4 v[208:211], v5, s[44:47], s18 offen offset:2048 sc1
    buffer_load_dwordx4 v[212:215], v5, s[44:47], s18 offen offset:3072 sc1
    s_add_u32 s18, s18, 4096
    s_cmp_eq_u32 s18, s23
    s_cselect_b32 s18, s22, s18
    buffer_load_dwordx4 v[216:219], v5, s[44:47], s18 offen offset:0 sc1
    buffer_load_dwordx4 v[220:223], v5, s[44:47], s18 offen offset:1024 sc1
    buffer_load_dwordx4 v[224:227], v5, s[44:47], s18 offen offset:2048 sc1
    buffer_load_dwordx4 v[228:231], v5, s[44:47], s18 offen offset:3072 sc1
    s_add_u32 s18, s18, 4096
    s_cmp_eq_u32 s18, s23
    s_cselect_b32 s18, s22, s18
    buffer_load_dwordx4 v[232:235], v5, s[44:47], s18 offen offset:0 sc1
    buffer_load_dwordx4 v[236:239], v5, s[44:47], s18 offen offset:1024 sc1
    buffer_load_dwordx4 v[240:243], v5, s[44:47], s18 offen offset:2048 sc1
    buffer_load_dwordx4 v[244:247], v5, s[44:47], s18 offen offset:3072 sc1
    s_add_u32 s18, s18, 4096
    s_cmp_eq_u32 s18, s23
    s_cselect_b32 s18, s22, s18
    s_setprio 1
    s_waitcnt vmcnt(11)
    v_mfma_f32_16x16x32_bf16 v[88:91], v[8:11], v[192:195], 0
    v_mfma_f32_16x16x32_bf16 v[104:107], v[12:15], v[192:195], 0
    v_mfma_f32_16x16x32_bf16 v[176:179], v[16:19], v[192:195], 0
    v_mfma_f32_16x16x32_bf16 v[56:59], v[20:23], v[192:195], 0
    v_mfma_f32_16x16x32_bf16 v[72:75], v[24:27], v[192:195], 0
    s_waitcnt vmcnt(10)
    v_mfma_f32_16x16x32_bf16 v[92:95], v[8:11], v[196:199], 0
    v_mfma_f32_16x16x32_bf16 v[108:111], v[12:15], v[196:199], 0
    v_mfma_f32_16x16x32_bf16 v[180:183], v[16:19], v[196:199], 0
    v_mfma_f32_16x16x32_bf16 v[60:63], v[20:23], v[196:199], 0
    v_mfma_f32_16x16x32_bf16 v[76:79], v[24:27], v[196:199], 0
    buffer_load_dwordx4 v[192:195], v5, s[44:47], s18 offen offset:0 sc1
    s_waitcnt vmcnt(10)
    v_mfma_f32_16x16x32_bf16 v[96:99], v[8:11], v[208:211], 0
    v_mfma_f32_16x16x32_bf16 v[168:171], v[12:15], v[208:211], 0
    v_mfma_f32_16x16x32_bf16 v[184:187], v[16:19], v[208:211], 0
    v_mfma_f32_16x16x32_bf16 v[64:67], v[20:23], v[208:211], 0
    v_mfma_f32_16x16x32_bf16 v[80:83], v[24:27], v[208:211], 0
    buffer_load_dwordx4 v[196:199], v5, s[44:47], s18 offen offset:1024 sc1
    s_waitcnt vmcnt(10)
    v_mfma_f32_16x16x32_bf16 v[100:103], v[8:11], v[212:215], 0
    v_mfma_f32_16x16x32_bf16 v[172:175], v[12:15], v[212:215], 0
    v_mfma_f32_16x16x32_bf16 v[188:191], v[16:19], v[212:215], 0
    v_mfma_f32_16x16x32_bf16 v[68:71], v[20:23], v[212:215], 0
    v_mfma_f32_16x16x32_bf16 v[84:87], v[24:27], v[212:215], 0
    buffer_load_dwordx4 v[208:211], v5, s[44:47], s18 offen offset:2048 sc1
    s_waitcnt vmcnt(10)
    v_mfma_f32_16x16x32_bf16 v[88:91], v[28:31], v[216:219], v[88:91]
    v_mfma_f32_16x16x32_bf16 v[104:107], v[32:35], v[216:219], v[104:107]
    v_mfma_f32_16x16x32_bf16 v[176:179], v[36:39], v[216:219], v[176:179]
    v_mfma_f32_16x16x32_bf16 v[56:59], v[40:43], v[216:219], v[56:59]
    v_mfma_f32_16x16x32_bf16 v[72:75], v[44:47], v[216:219], v[72:75]
    buffer_load_dwordx4 v[212:215], v5, s[44:47], s18 offen offset:3072 sc1
    s_add_u32 s18, s18, 4096
    s_cmp_eq_u32 s18, s23
    s_cselect_b32 s18, s22, s18
    buffer_load_dwordx4 v[8:11], v5, s[44:47], s19 offen offset:0 sc1
    buffer_load_dwordx4 v[12:15], v5, s[44:47], s19 offen offset:1024 sc1
    buffer_load_dwordx4 v[16:19], v5, s[44:47], s19 offen offset:2048 sc1
    buffer_load_dwordx4 v[20:23], v5, s[44:47], s19 offen offset:3072 sc1
    s_add_u32 s3, s19, 4096
    buffer_load_dwordx4 v[24:27], v5, s[44:47], s3 offen sc1
    s_add_u32 s19, s19, 5120
    s_cmp_eq_u32 s19, s25
    s_cselect_b32 s19, s24, s19
    s_waitcnt vmcnt(15)
    v_mfma_f32_16x16x32_bf16 v[92:95], v[28:31], v[220:223], v[92:95]
    v_mfma_f32_16x16x32_bf16 v[108:111], v[32:35], v[220:223], v[108:111]
    v_mfma_f32_16x16x32_bf16 v[180:183], v[36:39], v[220:223], v[180:183]
    v_mfma_f32_16x16x32_bf16 v[60:63], v[40:43], v[220:223], v[60:63]
    v_mfma_f32_16x16x32_bf16 v[76:79], v[44:47], v[220:223], v[76:79]
    buffer_load_dwordx4 v[216:219], v5, s[44:47], s18 offen offset:0 sc1
    s_waitcnt vmcnt(15)
    v_mfma_f32_16x16x32_bf16 v[96:99], v[28:31], v[224:227], v[96:99]
    v_mfma_f32_16x16x32_bf16 v[168:171], v[32:35], v[224:227], v[168:171]
    v_mfma_f32_16x16x32_bf16 v[184:187], v[36:39], v[224:227], v[184:187]
    v_mfma_f32_16x16x32_bf16 v[64:67], v[40:43], v[224:227], v[64:67]
    v_mfma_f32_16x16x32_bf16 v[80:83], v[44:47], v[224:227], v[80:83]
    buffer_load_dwordx4 v[220:223], v5, s[44:47], s18 offen offset:1024 sc1
    s_waitcnt vmcnt(15)
    v_mfma_f32_16x16x32_bf16 v[100:103], v[28:31], v[228:231], v[100:103]
    v_mfma_f32_16x16x32_bf16 v[172:175], v[32:35], v[228:231], v[172:175]
    v_mfma_f32_16x16x32_bf16 v[188:191], v[36:39], v[228:231], v[188:191]
    v_mfma_f32_16x16x32_bf16 v[68:71], v[40:43], v[228:231], v[68:71]
    v_mfma_f32_16x16x32_bf16 v[84:87], v[44:47], v[228:231], v[84:87]
    buffer_load_dwordx4 v[224:227], v5, s[44:47], s18 offen offset:2048 sc1
    s_waitcnt vmcnt(15)
    v_mfma_f32_16x16x32_bf16 v[88:91], v[48:51], v[232:235], v[88:91]
    v_mfma_f32_16x16x32_bf16 v[104:107], v[52:55], v[232:235], v[104:107]
    v_mfma_f32_16x16x32_bf16 v[176:179], v[128:131], v[232:235], v[176:179]
    v_mfma_f32_16x16x32_bf16 v[56:59], v[132:135], v[232:235], v[56:59]
    v_mfma_f32_16x16x32_bf16 v[72:75], v[136:139], v[232:235], v[72:75]
    buffer_load_dwordx4 v[228:231], v5, s[44:47], s18 offen offset:3072 sc1
    s_add_u32 s18, s18, 4096
    s_cmp_eq_u32 s18, s23
    s_cselect_b32 s18, s22, s18
    buffer_load_dwordx4 v[28:31], v5, s[44:47], s19 offen offset:0 sc1
    buffer_load_dwordx4 v[32:35], v5, s[44:47], s19 offen offset:1024 sc1
    buffer_load_dwordx4 v[36:39], v5, s[44:47], s19 offen offset:2048 sc1
    buffer_load_dwordx4 v[40:43], v5, s[44:47], s19 offen offset:3072 sc1
    s_add_u32 s3, s19, 4096
    buffer_load_dwordx4 v[44:47], v5, s[44:47], s3 offen sc1
    s_add_u32 s19, s19, 5120
    s_cmp_eq_u32 s19, s25
    s_cselect_b32 s19, s24, s19
    s_waitcnt vmcnt(20)
    v_mfma_f32_16x16x32_bf16 v[92:95], v[48:51], v[236:239], v[92:95]
    v_mfma_f32_16x16x32_bf16 v[108:111], v[52:55], v[236:239], v[108:111]
    v_mfma_f32_16x16x32_bf16 v[180:183], v[128:131], v[236:239], v[180:183]
    v_mfma_f32_16x16x32_bf16 v[60:63], v[132:135], v[236:239], v[60:63]
    v_mfma_f32_16x16x32_bf16 v[76:79], v[136:139], v[236:239], v[76:79]
    buffer_load_dwordx4 v[232:235], v5, s[44:47], s18 offen offset:0 sc1
    s_waitcnt vmcnt(20)
    v_mfma_f32_16x16x32_bf16 v[96:99], v[48:51], v[240:243], v[96:99]
    v_mfma_f32_16x16x32_bf16 v[168:171], v[52:55], v[240:243], v[168:171]
    v_mfma_f32_16x16x32_bf16 v[184:187], v[128:131], v[240:243], v[184:187]
    v_mfma_f32_16x16x32_bf16 v[64:67], v[132:135], v[240:243], v[64:67]
    v_mfma_f32_16x16x32_bf16 v[80:83], v[136:139], v[240:243], v[80:83]
    buffer_load_dwordx4 v[236:239], v5, s[44:47], s18 offen offset:1024 sc1
    s_waitcnt vmcnt(20)
    v_mfma_f32_16x16x32_bf16 v[100:103], v[48:51], v[244:247], v[100:103]
    v_mfma_f32_16x16x32_bf16 v[172:175], v[52:55], v[244:247], v[172:175]
    v_mfma_f32_16x16x32_bf16 v[188:191], v[128:131], v[244:247], v[188:191]
    v_mfma_f32_16x16x32_bf16 v[68:71], v[132:135], v[244:247], v[68:71]
    v_mfma_f32_16x16x32_bf16 v[84:87], v[136:139], v[244:247], v[84:87]
    buffer_load_dwordx4 v[240:243], v5, s[44:47], s18 offen offset:2048 sc1
    s_waitcnt vmcnt(20)
    v_mfma_f32_16x16x32_bf16 v[88:91], v[140:143], v[192:195], v[88:91]
    v_mfma_f32_16x16x32_bf16 v[104:107], v[144:147], v[192:195], v[104:107]
    v_mfma_f32_16x16x32_bf16 v[176:179], v[148:151], v[192:195], v[176:179]
    v_mfma_f32_16x16x32_bf16 v[56:59], v[248:251], v[192:195], v[56:59]
    v_mfma_f32_16x16x32_bf16 v[72:75], v[252:255], v[192:195], v[72:75]
    buffer_load_dwordx4 v[244:247], v5, s[44:47], s18 offen offset:3072 sc1
    s_add_u32 s18, s18, 4096
    s_cmp_eq_u32 s18, s23
    s_cselect_b32 s18, s22, s18
    buffer_load_dwordx4 v[48:51], v5, s[44:47], s19 offen offset:0 sc1
    buffer_load_dwordx4 v[52:55], v5, s[44:47], s19 offen offset:1024 sc1
    buffer_load_dwordx4 v[128:131], v5, s[44:47], s19 offen offset:2048 sc1
    buffer_load_dwordx4 v[132:135], v5, s[44:47], s19 offen offset:3072 sc1
    s_add_u32 s3, s19, 4096
    buffer_load_dwordx4 v[136:139], v5, s[44:47], s3 offen sc1
    s_add_u32 s19, s19, 5120
    s_cmp_eq_u32 s19, s25
    s_cselect_b32 s19, s24, s19
    s_waitcnt vmcnt(25)
    v_mfma_f32_16x16x32_bf16 v[92:95], v[140:143], v[196:199], v[92:95]
    v_mfma_f32_16x16x32_bf16 v[108:111], v[144:147], v[196:199], v[108:111]
    v_mfma_f32_16x16x32_bf16 v[180:183], v[148:151], v[196:199], v[180:183]
    v_mfma_f32_16x16x32_bf16 v[60:63], v[248:251], v[196:199], v[60:63]
    v_mfma_f32_16x16x32_bf16 v[76:79], v[252:255], v[196:199], v[76:79]
    buffer_load_dwordx4 v[192:195], v5, s[44:47], s18 offen offset:0 sc1
    s_waitcnt vmcnt(25)
    v_mfma_f32_16x16x32_bf16 v[96:99], v[140:143], v[208:211], v[96:99]
    v_mfma_f32_16x16x32_bf16 v[168:171], v[144:147], v[208:211], v[168:171]
    v_mfma_f32_16x16x32_bf16 v[184:187], v[148:151], v[208:211], v[184:187]
    v_mfma_f32_16x16x32_bf16 v[64:67], v[248:251], v[208:211], v[64:67]
    v_mfma_f32_16x16x32_bf16 v[80:83], v[252:255], v[208:211], v[80:83]
    buffer_load_dwordx4 v[196:199], v5, s[44:47], s18 offen offset:1024 sc1
    s_waitcnt vmcnt(25)
    v_mfma_f32_16x16x32_bf16 v[100:103], v[140:143], v[212:215], v[100:103]
    v_mfma_f32_16x16x32_bf16 v[172:175], v[144:147], v[212:215], v[172:175]
    v_mfma_f32_16x16x32_bf16 v[188:191], v[148:151], v[212:215], v[188:191]
    v_mfma_f32_16x16x32_bf16 v[68:71], v[248:251], v[212:215], v[68:71]
    v_mfma_f32_16x16x32_bf16 v[84:87], v[252:255], v[212:215], v[84:87]
    buffer_load_dwordx4 v[208:211], v5, s[44:47], s18 offen offset:2048 sc1
    s_waitcnt vmcnt(20)
    v_mfma_f32_16x16x32_bf16 v[88:91], v[112:115], v[216:219], v[88:91]
    v_mfma_f32_16x16x32_bf16 v[104:107], v[116:119], v[216:219], v[104:107]
    v_mfma_f32_16x16x32_bf16 v[176:179], v[120:123], v[216:219], v[176:179]
    v_mfma_f32_16x16x32_bf16 v[56:59], v[124:127], v[216:219], v[56:59]
    v_mfma_f32_16x16x32_bf16 v[72:75], v[152:155], v[216:219], v[72:75]
    buffer_load_dwordx4 v[212:215], v5, s[44:47], s18 offen offset:3072 sc1
    s_add_u32 s18, s18, 4096
    s_cmp_eq_u32 s18, s23
    s_cselect_b32 s18, s22, s18
    buffer_load_dwordx4 v[140:143], v5, s[44:47], s19 offen offset:0 sc1
    buffer_load_dwordx4 v[144:147], v5, s[44:47], s19 offen offset:1024 sc1
    buffer_load_dwordx4 v[148:151], v5, s[44:47], s19 offen offset:2048 sc1
    buffer_load_dwordx4 v[248:251], v5, s[44:47], s19 offen offset:3072 sc1
    s_add_u32 s3, s19, 4096
    buffer_load_dwordx4 v[252:255], v5, s[44:47], s3 offen sc1
    s_add_u32 s19, s19, 5120
    s_cmp_eq_u32 s19, s25
    s_cselect_b32 s19, s24, s19
    s_waitcnt vmcnt(25)
    v_mfma_f32_16x16x32_bf16 v[92:95], v[112:115], v[220:223], v[92:95]
    v_mfma_f32_16x16x32_bf16 v[108:111], v[116:119], v[220:223], v[108:111]
    v_mfma_f32_16x16x32_bf16 v[180:183], v[120:123], v[220:223], v[180:183]
    v_mfma_f32_16x16x32_bf16 v[60:63], v[124:127], v[220:223], v[60:63]
    v_mfma_f32_16x16x32_bf16 v[76:79], v[152:155], v[220:223], v[76:79]
    buffer_load_dwordx4 v[216:219], v5, s[44:47], s18 offen offset:0 sc1
    s_waitcnt vmcnt(25)
    v_mfma_f32_16x16x32_bf16 v[96:99], v[112:115], v[224:227], v[96:99]
    v_mfma_f32_16x16x32_bf16 v[168:171], v[116:119], v[224:227], v[168:171]
    v_mfma_f32_16x16x32_bf16 v[184:187], v[120:123], v[224:227], v[184:187]
    v_mfma_f32_16x16x32_bf16 v[64:67], v[124:127], v[224:227], v[64:67]
    v_mfma_f32_16x16x32_bf16 v[80:83], v[152:155], v[224:227], v[80:83]
    buffer_load_dwordx4 v[220:223], v5, s[44:47], s18 offen offset:1024 sc1
    s_waitcnt vmcnt(25)
    v_mfma_f32_16x16x32_bf16 v[100:103], v[112:115], v[228:231], v[100:103]
    v_mfma_f32_16x16x32_bf16 v[172:175], v[116:119], v[228:231], v[172:175]
    v_mfma_f32_16x16x32_bf16 v[188:191], v[120:123], v[228:231], v[188:191]
    v_mfma_f32_16x16x32_bf16 v[68:71], v[124:127], v[228:231], v[68:71]
    v_mfma_f32_16x16x32_bf16 v[84:87], v[152:155], v[228:231], v[84:87]
    buffer_load_dwordx4 v[224:227], v5, s[44:47], s18 offen offset:2048 sc1
    s_waitcnt vmcnt(20)
    v_mfma_f32_16x16x32_bf16 v[88:91], v[156:159], v[232:235], v[88:91]
    v_mfma_f32_16x16x32_bf16 v[104:107], v[160:163], v[232:235], v[104:107]
    v_mfma_f32_16x16x32_bf16 v[176:179], v[164:167], v[232:235], v[176:179]
    v_mfma_f32_16x16x32_bf16 v[56:59], v[200:203], v[232:235], v[56:59]
    v_mfma_f32_16x16x32_bf16 v[72:75], v[204:207], v[232:235], v[72:75]
    buffer_load_dwordx4 v[228:231], v5, s[44:47], s18 offen offset:3072 sc1
    s_add_u32 s18, s18, 4096
    s_cmp_eq_u32 s18, s23
    s_cselect_b32 s18, s22, s18
    buffer_load_dwordx4 v[112:115], v5, s[44:47], s19 offen offset:0 sc1
    buffer_load_dwordx4 v[116:119], v5, s[44:47], s19 offen offset:1024 sc1
    buffer_load_dwordx4 v[120:123], v5, s[44:47], s19 offen offset:2048 sc1
    buffer_load_dwordx4 v[124:127], v5, s[44:47], s19 offen offset:3072 sc1
    s_add_u32 s3, s19, 4096
    buffer_load_dwordx4 v[152:155], v5, s[44:47], s3 offen sc1
    s_add_u32 s19, s19, 5120
    s_cmp_eq_u32 s19, s25
    s_cselect_b32 s19, s24, s19
    s_waitcnt vmcnt(25)
    v_mfma_f32_16x16x32_bf16 v[92:95], v[156:159], v[236:239], v[92:95]
    v_mfma_f32_16x16x32_bf16 v[108:111], v[160:163], v[236:239], v[108:111]
    v_mfma_f32_16x16x32_bf16 v[180:183], v[164:167], v[236:239], v[180:183]
    v_mfma_f32_16x16x32_bf16 v[60:63], v[200:203], v[236:239], v[60:63]
    v_mfma_f32_16x16x32_bf16 v[76:79], v[204:207], v[236:239], v[76:79]
    buffer_load_dwordx4 v[232:235], v5, s[44:47], s18 offen offset:0 sc1
    s_waitcnt vmcnt(25)
    v_mfma_f32_16x16x32_bf16 v[96:99], v[156:159], v[240:243], v[96:99]
    v_mfma_f32_16x16x32_bf16 v[168:171], v[160:163], v[240:243], v[168:171]
    v_mfma_f32_16x16x32_bf16 v[184:187], v[164:167], v[240:243], v[184:187]
    v_mfma_f32_16x16x32_bf16 v[64:67], v[200:203], v[240:243], v[64:67]
    v_mfma_f32_16x16x32_bf16 v[80:83], v[204:207], v[240:243], v[80:83]
    buffer_load_dwordx4 v[236:239], v5, s[44:47], s18 offen offset:1024 sc1
    s_waitcnt vmcnt(25)
    v_mfma_f32_16x16x32_bf16 v[100:103], v[156:159], v[244:247], v[100:103]
    v_mfma_f32_16x16x32_bf16 v[172:175], v[160:163], v[244:247], v[172:175]
    v_mfma_f32_16x16x32_bf16 v[188:191], v[164:167], v[244:247], v[188:191]
    v_mfma_f32_16x16x32_bf16 v[68:71], v[200:203], v[244:247], v[68:71]
    v_mfma_f32_16x16x32_bf16 v[84:87], v[204:207], v[244:247], v[84:87]
    buffer_load_dwordx4 v[240:243], v5, s[44:47], s18 offen offset:2048 sc1
    s_waitcnt vmcnt(20)
    v_mfma_f32_16x16x32_bf16 v[88:91], v[8:11], v[192:195], v[88:91]
    v_mfma_f32_16x16x32_bf16 v[104:107], v[12:15], v[192:195], v[104:107]
    v_mfma_f32_16x16x32_bf16 v[176:179], v[16:19], v[192:195], v[176:179]
    v_mfma_f32_16x16x32_bf16 v[56:59], v[20:23], v[192:195], v[56:59]
    v_mfma_f32_16x16x32_bf16 v[72:75], v[24:27], v[192:195], v[72:75]
    buffer_load_dwordx4 v[244:247], v5, s[44:47], s18 offen offset:3072 sc1
    s_add_u32 s18, s18, 4096
    s_cmp_eq_u32 s18, s23
    s_cselect_b32 s18, s22, s18
    buffer_load_dwordx4 v[156:159], v5, s[44:47], s19 offen offset:0 sc1
    buffer_load_dwordx4 v[160:163], v5, s[44:47], s19 offen offset:1024 sc1
    buffer_load_dwordx4 v[164:167], v5, s[44:47], s19 offen offset:2048 sc1
    buffer_load_dwordx4 v[200:203], v5, s[44:47], s19 offen offset:3072 sc1
    s_add_u32 s3, s19, 4096
    buffer_load_dwordx4 v[204:207], v5, s[44:47], s3 offen sc1
    s_add_u32 s19, s19, 5120
    s_cmp_eq_u32 s19, s25
    s_cselect_b32 s19, s24, s19
    s_waitcnt vmcnt(25)
    v_mfma_f32_16x16x32_bf16 v[92:95], v[8:11], v[196:199], v[92:95]
    v_mfma_f32_16x16x32_bf16 v[108:111], v[12:15], v[196:199], v[108:111]
    v_mfma_f32_16x16x32_bf16 v[180:183], v[16:19], v[196:199], v[180:183]
    v_mfma_f32_16x16x32_bf16 v[60:63], v[20:23], v[196:199], v[60:63]
    v_mfma_f32_16x16x32_bf16 v[76:79], v[24:27], v[196:199], v[76:79]
    buffer_load_dwordx4 v[192:195], v5, s[44:47], s18 offen offset:0 sc1
    s_waitcnt vmcnt(25)
    v_mfma_f32_16x16x32_bf16 v[96:99], v[8:11], v[208:211], v[96:99]
    v_mfma_f32_16x16x32_bf16 v[168:171], v[12:15], v[208:211], v[168:171]
    v_mfma_f32_16x16x32_bf16 v[184:187], v[16:19], v[208:211], v[184:187]
    v_mfma_f32_16x16x32_bf16 v[64:67], v[20:23], v[208:211], v[64:67]
    v_mfma_f32_16x16x32_bf16 v[80:83], v[24:27], v[208:211], v[80:83]
    buffer_load_dwordx4 v[196:199], v5, s[44:47], s18 offen offset:1024 sc1
    s_waitcnt vmcnt(25)
    v_mfma_f32_16x16x32_bf16 v[100:103], v[8:11], v[212:215], v[100:103]
    v_mfma_f32_16x16x32_bf16 v[172:175], v[12:15], v[212:215], v[172:175]
    v_mfma_f32_16x16x32_bf16 v[188:191], v[16:19], v[212:215], v[188:191]
    v_mfma_f32_16x16x32_bf16 v[68:71], v[20:23], v[212:215], v[68:71]
    v_mfma_f32_16x16x32_bf16 v[84:87], v[24:27], v[212:215], v[84:87]
    buffer_load_dwordx4 v[208:211], v5, s[44:47], s18 offen offset:2048 sc1
    s_waitcnt vmcnt(20)
    v_mfma_f32_16x16x32_bf16 v[88:91], v[28:31], v[216:219], v[88:91]
    v_mfma_f32_16x16x32_bf16 v[104:107], v[32:35], v[216:219], v[104:107]
    v_mfma_f32_16x16x32_bf16 v[176:179], v[36:39], v[216:219], v[176:179]
    v_mfma_f32_16x16x32_bf16 v[56:59], v[40:43], v[216:219], v[56:59]
    v_mfma_f32_16x16x32_bf16 v[72:75], v[44:47], v[216:219], v[72:75]
    buffer_load_dwordx4 v[212:215], v5, s[44:47], s18 offen offset:3072 sc1
    s_add_u32 s18, s18, 4096
    s_cmp_eq_u32 s18, s23
    s_cselect_b32 s18, s22, s18
    buffer_load_dwordx4 v[8:11], v5, s[44:47], s19 offen offset:0 sc1
    buffer_load_dwordx4 v[12:15], v5, s[44:47], s19 offen offset:1024 sc1
    buffer_load_dwordx4 v[16:19], v5, s[44:47], s19 offen offset:2048 sc1
    buffer_load_dwordx4 v[20:23], v5, s[44:47], s19 offen offset:3072 sc1
    s_add_u32 s3, s19, 4096
    buffer_load_dwordx4 v[24:27], v5, s[44:47], s3 offen sc1
    s_add_u32 s19, s19, 5120
    s_cmp_eq_u32 s19, s25
    s_cselect_b32 s19, s24, s19
    s_waitcnt vmcnt(25)
    v_mfma_f32_16x16x32_bf16 v[92:95], v[28:31], v[220:223], v[92:95]
    v_mfma_f32_16x16x32_bf16 v[108:111], v[32:35], v[220:223], v[108:111]
    v_mfma_f32_16x16x32_bf16 v[180:183], v[36:39], v[220:223], v[180:183]
    v_mfma_f32_16x16x32_bf16 v[60:63], v[40:43], v[220:223], v[60:63]
    v_mfma_f32_16x16x32_bf16 v[76:79], v[44:47], v[220:223], v[76:79]
    buffer_load_dwordx4 v[216:219], v5, s[44:47], s18 offen offset:0 sc1
    s_waitcnt vmcnt(25)
    v_mfma_f32_16x16x32_bf16 v[96:99], v[28:31], v[224:227], v[96:99]
    v_mfma_f32_16x16x32_bf16 v[168:171], v[32:35], v[224:227], v[168:171]
    v_mfma_f32_16x16x32_bf16 v[184:187], v[36:39], v[224:227], v[184:187]
    v_mfma_f32_16x16x32_bf16 v[64:67], v[40:43], v[224:227], v[64:67]
    v_mfma_f32_16x16x32_bf16 v[80:83], v[44:47], v[224:227], v[80:83]
    buffer_load_dwordx4 v[220:223], v5, s[44:47], s18 offen offset:1024 sc1
    s_waitcnt vmcnt(25)
    v_mfma_f32_16x16x32_bf16 v[100:103], v[28:31], v[228:231], v[100:103]
    v_mfma_f32_16x16x32_bf16 v[172:175], v[32:35], v[228:231], v[172:175]
    v_mfma_f32_16x16x32_bf16 v[188:191], v[36:39], v[228:231], v[188:191]
    v_mfma_f32_16x16x32_bf16 v[68:71], v[40:43], v[228:231], v[68:71]
    v_mfma_f32_16x16x32_bf16 v[84:87], v[44:47], v[228:231], v[84:87]
    buffer_load_dwordx4 v[224:227], v5, s[44:47], s18 offen offset:2048 sc1
    s_waitcnt vmcnt(20)
    v_mfma_f32_16x16x32_bf16 v[88:91], v[48:51], v[232:235], v[88:91]
    v_mfma_f32_16x16x32_bf16 v[104:107], v[52:55], v[232:235], v[104:107]
    v_mfma_f32_16x16x32_bf16 v[176:179], v[128:131], v[232:235], v[176:179]
    v_mfma_f32_16x16x32_bf16 v[56:59], v[132:135], v[232:235], v[56:59]
    v_mfma_f32_16x16x32_bf16 v[72:75], v[136:139], v[232:235], v[72:75]
    buffer_load_dwordx4 v[228:231], v5, s[44:47], s18 offen offset:3072 sc1
    s_add_u32 s18, s18, 4096
    s_cmp_eq_u32 s18, s23
    s_cselect_b32 s18, s22, s18
    s_add_u32 s19, s19, s26
    buffer_load_dwordx4 v[28:31], v5, s[44:47], s19 offen offset:0 sc1
    buffer_load_dwordx4 v[32:35], v5, s[44:47], s19 offen offset:1024 sc1
    buffer_load_dwordx4 v[36:39], v5, s[44:47], s19 offen offset:2048 sc1
    buffer_load_dwordx4 v[40:43], v5, s[44:47], s19 offen offset:3072 sc1
    s_add_u32 s3, s19, 4096
    buffer_load_dwordx4 v[44:47], v5, s[44:47], s3 offen sc1
    s_add_u32 s19, s19, 5120
    s_cmp_eq_u32 s19, s25
    s_cselect_b32 s19, s24, s19
    s_waitcnt vmcnt(25)
    v_mfma_f32_16x16x32_bf16 v[92:95], v[48:51], v[236:239], v[92:95]
    v_mfma_f32_16x16x32_bf16 v[108:111], v[52:55], v[236:239], v[108:111]
    v_mfma_f32_16x16x32_bf16 v[180:183], v[128:131], v[236:239], v[180:183]
    v_mfma_f32_16x16x32_bf16 v[60:63], v[132:135], v[236:239], v[60:63]
    v_mfma_f32_16x16x32_bf16 v[76:79], v[136:139], v[236:239], v[76:79]
    buffer_load_dwordx4 v[232:235], v5, s[44:47], s18 offen offset:0 sc1
    s_waitcnt vmcnt(25)
    v_mfma_f32_16x16x32_bf16 v[96:99], v[48:51], v[240:243], v[96:99]
    v_mfma_f32_16x16x32_bf16 v[168:171], v[52:55], v[240:243], v[168:171]
    v_mfma_f32_16x16x32_bf16 v[184:187], v[128:131], v[240:243], v[184:187]
    v_mfma_f32_16x16x32_bf16 v[64:67], v[132:135], v[240:243], v[64:67]
    v_mfma_f32_16x16x32_bf16 v[80:83], v[136:139], v[240:243], v[80:83]
    buffer_load_dwordx4 v[236:239], v5, s[44:47], s18 offen offset:1024 sc1
    s_waitcnt vmcnt(25)
    v_mfma_f32_16x16x32_bf16 v[100:103], v[48:51], v[244:247], v[100:103]
    v_mfma_f32_16x16x32_bf16 v[172:175], v[52:55], v[244:247], v[172:175]
    v_mfma_f32_16x16x32_bf16 v[188:191], v[128:131], v[244:247], v[188:191]
    v_mfma_f32_16x16x32_bf16 v[68:71], v[132:135], v[244:247], v[68:71]
    v_mfma_f32_16x16x32_bf16 v[84:87], v[136:139], v[244:247], v[84:87]
    buffer_load_dwordx4 v[240:243], v5, s[44:47], s18 offen offset:2048 sc1
    s_waitcnt vmcnt(20)
    v_mfma_f32_16x16x32_bf16 v[88:91], v[140:143], v[192:195], v[88:91]
    v_mfma_f32_16x16x32_bf16 v[104:107], v[144:147], v[192:195], v[104:107]
    v_mfma_f32_16x16x32_bf16 v[176:179], v[148:151], v[192:195], v[176:179]
    v_mfma_f32_16x16x32_bf16 v[56:59], v[248:251], v[192:195], v[56:59]
    v_mfma_f32_16x16x32_bf16 v[72:75], v[252:255], v[192:195], v[72:75]
    buffer_load_dwordx4 v[244:247], v5, s[44:47], s18 offen offset:3072 sc1
    s_add_u32 s18, s18, 4096
    s_cmp_eq_u32 s18, s23
    s_cselect_b32 s18, s22, s18
    s_waitcnt vmcnt(20)
    v_mfma_f32_16x16x32_bf16 v[92:95], v[140:143], v[196:199], v[92:95]
    v_mfma_f32_16x16x32_bf16 v[108:111], v[144:147], v[196:199], v[108:111]
    v_mfma_f32_16x16x32_bf16 v[180:183], v[148:151], v[196:199], v[180:183]
    v_mfma_f32_16x16x32_bf16 v[60:63], v[248:251], v[196:199], v[60:63]
    v_mfma_f32_16x16x32_bf16 v[76:79], v[252:255], v[196:199], v[76:79]
    buffer_load_dwordx4 v[192:195], v5, s[44:47], s18 offen offset:0 sc1
    s_waitcnt vmcnt(20)
    v_mfma_f32_16x16x32_bf16 v[96:99], v[140:143], v[208:211], v[96:99]
    v_mfma_f32_16x16x32_bf16 v[168:171], v[144:147], v[208:211], v[168:171]
    v_mfma_f32_16x16x32_bf16 v[184:187], v[148:151], v[208:211], v[184:187]
    v_mfma_f32_16x16x32_bf16 v[64:67], v[248:251], v[208:211], v[64:67]
    v_mfma_f32_16x16x32_bf16 v[80:83], v[252:255], v[208:211], v[80:83]
    buffer_load_dwordx4 v[196:199], v5, s[44:47], s18 offen offset:1024 sc1
    s_waitcnt vmcnt(20)
    v_mfma_f32_16x16x32_bf16 v[100:103], v[140:143], v[212:215], v[100:103]
    v_mfma_f32_16x16x32_bf16 v[172:175], v[144:147], v[212:215], v[172:175]
    v_mfma_f32_16x16x32_bf16 v[188:191], v[148:151], v[212:215], v[188:191]
    v_mfma_f32_16x16x32_bf16 v[68:71], v[248:251], v[212:215], v[68:71]
    v_mfma_f32_16x16x32_bf16 v[84:87], v[252:255], v[212:215], v[84:87]
    buffer_load_dwordx4 v[208:211], v5, s[44:47], s18 offen offset:2048 sc1
    s_waitcnt vmcnt(15)
    v_mfma_f32_16x16x32_bf16 v[88:91], v[112:115], v[216:219], v[88:91]
    v_mfma_f32_16x16x32_bf16 v[104:107], v[116:119], v[216:219], v[104:107]
    v_mfma_f32_16x16x32_bf16 v[176:179], v[120:123], v[216:219], v[176:179]
    v_mfma_f32_16x16x32_bf16 v[56:59], v[124:127], v[216:219], v[56:59]
    v_mfma_f32_16x16x32_bf16 v[72:75], v[152:155], v[216:219], v[72:75]
    buffer_load_dwordx4 v[212:215], v5, s[44:47], s18 offen offset:3072 sc1
    s_add_u32 s18, s18, 4096
    s_cmp_eq_u32 s18, s23
    s_cselect_b32 s18, s22, s18
    s_waitcnt vmcnt(15)
    v_mfma_f32_16x16x32_bf16 v[92:95], v[112:115], v[220:223], v[92:95]
    v_mfma_f32_16x16x32_bf16 v[108:111], v[116:119], v[220:223], v[108:111]
    v_mfma_f32_16x16x32_bf16 v[180:183], v[120:123], v[220:223], v[180:183]
    v_mfma_f32_16x16x32_bf16 v[60:63], v[124:127], v[220:223], v[60:63]
    v_mfma_f32_16x16x32_bf16 v[76:79], v[152:155], v[220:223], v[76:79]
    s_add_u32 s18, s18, s26
    buffer_load_dwordx4 v[216:219], v5, s[44:47], s18 offen offset:0 sc1
    s_waitcnt vmcnt(15)
    v_mfma_f32_16x16x32_bf16 v[96:99], v[112:115], v[224:227], v[96:99]
    v_mfma_f32_16x16x32_bf16 v[168:171], v[116:119], v[224:227], v[168:171]
    v_mfma_f32_16x16x32_bf16 v[184:187], v[120:123], v[224:227], v[184:187]
    v_mfma_f32_16x16x32_bf16 v[64:67], v[124:127], v[224:227], v[64:67]
    v_mfma_f32_16x16x32_bf16 v[80:83], v[152:155], v[224:227], v[80:83]
    buffer_load_dwordx4 v[220:223], v5, s[44:47], s18 offen offset:1024 sc1
    s_waitcnt vmcnt(15)
    v_mfma_f32_16x16x32_bf16 v[100:103], v[112:115], v[228:231], v[100:103]
    v_mfma_f32_16x16x32_bf16 v[172:175], v[116:119], v[228:231], v[172:175]
    v_mfma_f32_16x16x32_bf16 v[188:191], v[120:123], v[228:231], v[188:191]
    v_mfma_f32_16x16x32_bf16 v[68:71], v[124:127], v[228:231], v[68:71]
    v_mfma_f32_16x16x32_bf16 v[84:87], v[152:155], v[228:231], v[84:87]
    buffer_load_dwordx4 v[224:227], v5, s[44:47], s18 offen offset:2048 sc1
    s_waitcnt vmcnt(10)
    v_mfma_f32_16x16x32_bf16 v[88:91], v[156:159], v[232:235], v[88:91]
    v_mfma_f32_16x16x32_bf16 v[104:107], v[160:163], v[232:235], v[104:107]
    v_mfma_f32_16x16x32_bf16 v[176:179], v[164:167], v[232:235], v[176:179]
    v_mfma_f32_16x16x32_bf16 v[56:59], v[200:203], v[232:235], v[56:59]
    v_mfma_f32_16x16x32_bf16 v[72:75], v[204:207], v[232:235], v[72:75]
    buffer_load_dwordx4 v[228:231], v5, s[44:47], s18 offen offset:3072 sc1
    s_add_u32 s18, s18, 4096
    s_cmp_eq_u32 s18, s23
    s_cselect_b32 s18, s22, s18
    s_waitcnt vmcnt(10)
    v_mfma_f32_16x16x32_bf16 v[92:95], v[156:159], v[236:239], v[92:95]
    v_mfma_f32_16x16x32_bf16 v[108:111], v[160:163], v[236:239], v[108:111]
    v_mfma_f32_16x16x32_bf16 v[180:183], v[164:167], v[236:239], v[180:183]
    v_mfma_f32_16x16x32_bf16 v[60:63], v[200:203], v[236:239], v[60:63]
    v_mfma_f32_16x16x32_bf16 v[76:79], v[204:207], v[236:239], v[76:79]
    s_waitcnt vmcnt(9)
    v_mfma_f32_16x16x32_bf16 v[96:99], v[156:159], v[240:243], v[96:99]
    v_mfma_f32_16x16x32_bf16 v[168:171], v[160:163], v[240:243], v[168:171]
    v_mfma_f32_16x16x32_bf16 v[184:187], v[164:167], v[240:243], v[184:187]
    v_mfma_f32_16x16x32_bf16 v[64:67], v[200:203], v[240:243], v[64:67]
    v_mfma_f32_16x16x32_bf16 v[80:83], v[204:207], v[240:243], v[80:83]
    s_waitcnt vmcnt(8)
    v_mfma_f32_16x16x32_bf16 v[100:103], v[156:159], v[244:247], v[100:103]
    v_mfma_f32_16x16x32_bf16 v[172:175], v[160:163], v[244:247], v[172:175]
    v_mfma_f32_16x16x32_bf16 v[188:191], v[164:167], v[244:247], v[188:191]
    v_mfma_f32_16x16x32_bf16 v[68:71], v[200:203], v[244:247], v[68:71]
    v_mfma_f32_16x16x32_bf16 v[84:87], v[204:207], v[244:247], v[84:87]
    s_waitcnt vmcnt(7)
    v_mfma_f32_16x16x32_bf16 v[88:91], v[8:11], v[192:195], v[88:91]
    v_mfma_f32_16x16x32_bf16 v[104:107], v[12:15], v[192:195], v[104:107]
    v_mfma_f32_16x16x32_bf16 v[176:179], v[16:19], v[192:195], v[176:179]
    v_mfma_f32_16x16x32_bf16 v[56:59], v[20:23], v[192:195], v[56:59]
    v_mfma_f32_16x16x32_bf16 v[72:75], v[24:27], v[192:195], v[72:75]
    s_waitcnt vmcnt(6)
    v_mfma_f32_16x16x32_bf16 v[92:95], v[8:11], v[196:199], v[92:95]
    v_mfma_f32_16x16x32_bf16 v[108:111], v[12:15], v[196:199], v[108:111]
    v_mfma_f32_16x16x32_bf16 v[180:183], v[16:19], v[196:199], v[180:183]
    v_mfma_f32_16x16x32_bf16 v[60:63], v[20:23], v[196:199], v[60:63]
    v_mfma_f32_16x16x32_bf16 v[76:79], v[24:27], v[196:199], v[76:79]
    s_waitcnt vmcnt(5)
    v_mfma_f32_16x16x32_bf16 v[96:99], v[8:11], v[208:211], v[96:99]
    v_mfma_f32_16x16x32_bf16 v[168:171], v[12:15], v[208:211], v[168:171]
    v_mfma_f32_16x16x32_bf16 v[184:187], v[16:19], v[208:211], v[184:187]
    v_mfma_f32_16x16x32_bf16 v[64:67], v[20:23], v[208:211], v[64:67]
    v_mfma_f32_16x16x32_bf16 v[80:83], v[24:27], v[208:211], v[80:83]
    s_waitcnt vmcnt(4)
    v_mfma_f32_16x16x32_bf16 v[100:103], v[8:11], v[212:215], v[100:103]
    v_mfma_f32_16x16x32_bf16 v[172:175], v[12:15], v[212:215], v[172:175]
    v_mfma_f32_16x16x32_bf16 v[188:191], v[16:19], v[212:215], v[188:191]
    v_mfma_f32_16x16x32_bf16 v[68:71], v[20:23], v[212:215], v[68:71]
    v_mfma_f32_16x16x32_bf16 v[84:87], v[24:27], v[212:215], v[84:87]
    s_waitcnt vmcnt(3)
    v_mfma_f32_16x16x32_bf16 v[88:91], v[28:31], v[216:219], v[88:91]
    v_mfma_f32_16x16x32_bf16 v[104:107], v[32:35], v[216:219], v[104:107]
    v_mfma_f32_16x16x32_bf16 v[176:179], v[36:39], v[216:219], v[176:179]
    v_mfma_f32_16x16x32_bf16 v[56:59], v[40:43], v[216:219], v[56:59]
    v_mfma_f32_16x16x32_bf16 v[72:75], v[44:47], v[216:219], v[72:75]
    s_waitcnt vmcnt(2)
    v_mfma_f32_16x16x32_bf16 v[92:95], v[28:31], v[220:223], v[92:95]
    v_mfma_f32_16x16x32_bf16 v[108:111], v[32:35], v[220:223], v[108:111]
    v_mfma_f32_16x16x32_bf16 v[180:183], v[36:39], v[220:223], v[180:183]
    v_mfma_f32_16x16x32_bf16 v[60:63], v[40:43], v[220:223], v[60:63]
    v_mfma_f32_16x16x32_bf16 v[76:79], v[44:47], v[220:223], v[76:79]
    s_waitcnt vmcnt(1)
    v_mfma_f32_16x16x32_bf16 v[96:99], v[28:31], v[224:227], v[96:99]
    v_mfma_f32_16x16x32_bf16 v[168:171], v[32:35], v[224:227], v[168:171]
    v_mfma_f32_16x16x32_bf16 v[184:187], v[36:39], v[224:227], v[184:187]
    v_mfma_f32_16x16x32_bf16 v[64:67], v[40:43], v[224:227], v[64:67]
    v_mfma_f32_16x16x32_bf16 v[80:83], v[44:47], v[224:227], v[80:83]
    s_waitcnt vmcnt(0)
    v_mfma_f32_16x16x32_bf16 v[100:103], v[28:31], v[228:231], v[100:103]
    v_mfma_f32_16x16x32_bf16 v[172:175], v[32:35], v[228:231], v[172:175]
    v_mfma_f32_16x16x32_bf16 v[188:191], v[36:39], v[228:231], v[188:191]
    v_mfma_f32_16x16x32_bf16 v[68:71], v[40:43], v[228:231], v[68:71]
    v_mfma_f32_16x16x32_bf16 v[84:87], v[44:47], v[228:231], v[84:87]
    s_setprio 0
    s_waitcnt vmcnt(0)
    s_add_u32 s11, s56, 0
    s_lshr_b32 s12, s11, 2
    s_and_b32 s13, s11, 3
    s_lshl_b32 s14, s16, 6
    s_lshl_b32 s13, s13, 4
    s_add_u32 s14, s14, s13
    s_mul_i32 s14, s14, 1280
    s_mul_i32 s15, s17, 160
    s_add_u32 s14, s14, s15
    s_lshl_b32 s12, s12, 5
    s_add_u32 s14, s14, s12
    s_cmp_lt_u32 s11, 20
    s_cselect_b32 s14, s14, 1073741824
    v_and_b32 v6, 15, v1
    v_mul_u32_u24 v6, 1280, v6
    v_lshrrev_b32 v7, 4, v1
    v_lshl_add_u32 v6, v7, 3, v6
    v_add_u32 v238, s14, v6
    buffer_load_dwordx2 v[232:233], v238, s[36:39], 0 offen
    s_lshl_b32 s12, s11, 10
    s_add_u32 s13, s12, 37888
    v_add_u32 v241, s13, v5
    s_add_u32 s13, s12, 0
    s_add_u32 s14, s12, 18432
    s_cmp_lt_u32 s11, 14
    s_cselect_b32 s13, s13, s14
    s_cmp_lt_u32 s11, 19
    s_cselect_b32 s13, s13, 28672
    v_add_u32 v242, s13, v5
    s_add_u32 s13, s12, 14336
    s_add_u32 s14, s12, 44032
    s_cmp_lt_u32 s11, 14
    s_cselect_b32 s13, s13, s14
    s_cmp_lt_u32 s11, 19
    s_cselect_b32 s13, s13, 29696
    v_add_u32 v243, s13, v5
    s_add_u32 s13, s12, 135168
    s_add_u32 s14, s12, 69632
    s_cmp_lt_u32 s11, 14
    s_cselect_b32 s13, s13, s14
    s_cmp_lt_u32 s11, 19
    s_cselect_b32 s13, s13, 30720
    v_add_u32 v244, s13, v5
    s_add_u32 s13, s12, 149504
    s_add_u32 s14, s12, 95232
    s_cmp_lt_u32 s11, 14
    s_cselect_b32 s13, s13, s14
    s_cmp_lt_u32 s11, 19
    s_cselect_b32 s13, s13, 31744
    v_add_u32 v245, s13, v5
    s_add_u32 s11, s56, 8
    s_lshr_b32 s12, s11, 2
    s_and_b32 s13, s11, 3
    s_lshl_b32 s14, s16, 6
    s_lshl_b32 s13, s13, 4
    s_add_u32 s14, s14, s13
    s_mul_i32 s14, s14, 1280
    s_mul_i32 s15, s17, 160
    s_add_u32 s14, s14, s15
    s_lshl_b32 s12, s12, 5
    s_add_u32 s14, s14, s12
    s_cmp_lt_u32 s11, 20
    s_cselect_b32 s14, s14, 1073741824
    v_and_b32 v6, 15, v1
    v_mul_u32_u24 v6, 1280, v6
    v_lshrrev_b32 v7, 4, v1
    v_lshl_add_u32 v6, v7, 3, v6
    v_add_u32 v239, s14, v6
    buffer_load_dwordx2 v[234:235], v239, s[36:39], 0 offen
    s_lshl_b32 s12, s11, 10
    s_add_u32 s13, s12, 37888
    v_add_u32 v246, s13, v5
    s_add_u32 s13, s12, 0
    s_add_u32 s14, s12, 18432
    s_cmp_lt_u32 s11, 14
    s_cselect_b32 s13, s13, s14
    s_cmp_lt_u32 s11, 19
    s_cselect_b32 s13, s13, 28672
    v_add_u32 v247, s13, v5
    s_add_u32 s13, s12, 14336
    s_add_u32 s14, s12, 44032
    s_cmp_lt_u32 s11, 14
    s_cselect_b32 s13, s13, s14
    s_cmp_lt_u32 s11, 19
    s_cselect_b32 s13, s13, 29696
    v_add_u32 v248, s13, v5
    s_add_u32 s13, s12, 135168
    s_add_u32 s14, s12, 69632
    s_cmp_lt_u32 s11, 14
    s_cselect_b32 s13, s13, s14
    s_cmp_lt_u32 s11, 19
    s_cselect_b32 s13, s13, 30720
    v_add_u32 v249, s13, v5
    s_add_u32 s13, s12, 149504
    s_add_u32 s14, s12, 95232
    s_cmp_lt_u32 s11, 14
    s_cselect_b32 s13, s13, s14
    s_cmp_lt_u32 s11, 19
    s_cselect_b32 s13, s13, 31744
    v_add_u32 v250, s13, v5
    s_add_u32 s11, s56, 16
    s_lshr_b32 s12, s11, 2
    s_and_b32 s13, s11, 3
    s_lshl_b32 s14, s16, 6
    s_lshl_b32 s13, s13, 4
    s_add_u32 s14, s14, s13
    s_mul_i32 s14, s14, 1280
    s_mul_i32 s15, s17, 160
    s_add_u32 s14, s14, s15
    s_lshl_b32 s12, s12, 5
    s_add_u32 s14, s14, s12
    s_cmp_lt_u32 s11, 20
    s_cselect_b32 s14, s14, 1073741824
    v_and_b32 v6, 15, v1
    v_mul_u32_u24 v6, 1280, v6
    v_lshrrev_b32 v7, 4, v1
    v_lshl_add_u32 v6, v7, 3, v6
    v_add_u32 v240, s14, v6
    buffer_load_dwordx2 v[236:237], v240, s[36:39], 0 offen
    s_lshl_b32 s12, s11, 10
    s_add_u32 s13, s12, 37888
    v_add_u32 v251, s13, v5
    s_add_u32 s13, s12, 0
    s_add_u32 s14, s12, 18432
    s_cmp_lt_u32 s11, 14
    s_cselect_b32 s13, s13, s14
    s_cmp_lt_u32 s11, 19
    s_cselect_b32 s13, s13, 28672
    v_add_u32 v252, s13, v5
    s_add_u32 s13, s12, 14336
    s_add_u32 s14, s12, 44032
    s_cmp_lt_u32 s11, 14
    s_cselect_b32 s13, s13, s14
    s_cmp_lt_u32 s11, 19
    s_cselect_b32 s13, s13, 29696
    v_add_u32 v253, s13, v5
    s_add_u32 s13, s12, 135168
    s_add_u32 s14, s12, 69632
    s_cmp_lt_u32 s11, 14
    s_cselect_b32 s13, s13, s14
    s_cmp_lt_u32 s11, 19
    s_cselect_b32 s13, s13, 30720
    v_add_u32 v254, s13, v5
    s_add_u32 s13, s12, 149504
    s_add_u32 s14, s12, 95232
    s_cmp_lt_u32 s11, 14
    s_cselect_b32 s13, s13, s14
    s_cmp_lt_u32 s11, 19
    s_cselect_b32 s13, s13, 31744
    v_add_u32 v255, s13, v5
    s_sub_u32 s3, s56, 4
    s_mul_i32 s8, s3, 14336
    s_cmp_ge_u32 s3, 2
    s_cselect_b32 s9, 106496, 0
    s_add_u32 s8, s8, s9
    v_add_u32 v2, s8, v5
    s_add_u32 s9, s8, 13456
    v_mov_b32 v4, s9
    s_mov_b32 s78, 0
L2_wfree:
    ds_read_b32 v3, v4
    s_waitcnt lgkmcnt(0)
    v_readfirstlane_b32 s9, v3
    s_add_u32 s78, s78, 1
    s_cmp_eq_u32 s9, 1
    s_cbranch_scc1 L2_wfree_ok
    s_cmp_gt_u32 s78, 16777216
    s_cbranch_scc1 L2_wfree_ok
    s_sleep 2
    s_branch L2_wfree
L2_wfree_ok:
    s_mul_i32 s8, s3, 25600
    s_add_u32 s8, s8, 32768
    v_add_u32 v3, s8, v5
    s_lshl_b32 s8, s3, 10
    v_add_u32 v4, s8, v5
    ds_write_b128 v2, v[88:91] offset:0
    ds_write_b128 v2, v[92:95] offset:1024
    ds_write_b128 v2, v[96:99] offset:2048
    ds_write_b128 v2, v[100:103] offset:3072
    ds_write_b128 v2, v[104:107] offset:4096
    ds_write_b128 v2, v[108:111] offset:5120
    ds_write_b128 v2, v[168:171] offset:6144
    ds_write_b128 v2, v[172:175] offset:7168
    ds_write_b128 v2, v[176:179] offset:8192
    ds_write_b128 v2, v[180:183] offset:9216
    ds_write_b128 v2, v[184:187] offset:10240
    ds_write_b128 v2, v[188:191] offset:11264
    ds_write_b128 v2, v[56:59] offset:12288
    ds_write_b128 v2, v[60:63] offset:13312
    ds_write_b128 v3, v[64:67] offset:0
    ds_write_b128 v3, v[68:71] offset:1024
    ds_write_b128 v3, v[72:75] offset:2048
    ds_write_b128 v3, v[76:79] offset:3072
    ds_write_b128 v3, v[80:83] offset:4096
    ds_write_b128 v4, v[84:87] offset:28672
L2_reduce:
    s_setprio 0
    s_waitcnt lgkmcnt(0)
    s_barrier
    v_add_u32 v2, 51200, v241
    ds_read_b128 v[8:11], v241 offset:0
    ds_read_b128 v[12:15], v241 offset:25600
    ds_read_b128 v[16:19], v2 offset:0
    ds_read_b128 v[20:23], v2 offset:25600
    ds_read_b128 v[24:27], v242
    ds_read_b128 v[28:31], v243
    ds_read_b128 v[32:35], v244
    ds_read_b128 v[36:39], v245
    v_add_u32 v2, 51200, v246
    ds_read_b128 v[40:43], v246 offset:0
    ds_read_b128 v[44:47], v246 offset:25600
    ds_read_b128 v[48:51], v2 offset:0
    ds_read_b128 v[52:55], v2 offset:25600
    ds_read_b128 v[56:59], v247
    ds_read_b128 v[60:63], v248
    ds_read_b128 v[64:67], v249
    ds_read_b128 v[68:71], v250
    s_waitcnt vmcnt(0) lgkmcnt(8)
    v_pk_add_f32 v[8:9], v[8:9], v[24:25] op_sel:[0,0] op_sel_hi:[1,1]
    v_pk_add_f32 v[10:11], v[10:11], v[26:27] op_sel:[0,0] op_sel_hi:[1,1]
    v_pk_add_f32 v[12:13], v[12:13], v[28:29] op_sel:[0,0] op_sel_hi:[1,1]
    v_pk_add_f32 v[14:15], v[14:15], v[30:31] op_sel:[0,0] op_sel_hi:[1,1]
    v_pk_add_f32 v[16:17], v[16:17], v[32:33] op_sel:[0,0] op_sel_hi:[1,1]
    v_pk_add_f32 v[18:19], v[18:19], v[34:35] op_sel:[0,0] op_sel_hi:[1,1]
    v_pk_add_f32 v[20:21], v[20:21], v[36:37] op_sel:[0,0] op_sel_hi:[1,1]
    v_pk_add_f32 v[22:23], v[22:23], v[38:39] op_sel:[0,0] op_sel_hi:[1,1]
    v_pk_add_f32 v[8:9], v[8:9], v[16:17] op_sel:[0,0] op_sel_hi:[1,1]
    v_pk_add_f32 v[10:11], v[10:11], v[18:19] op_sel:[0,0] op_sel_hi:[1,1]
    v_pk_add_f32 v[12:13], v[12:13], v[20:21] op_sel:[0,0] op_sel_hi:[1,1]
    v_pk_add_f32 v[14:15], v[14:15], v[22:23] op_sel:[0,0] op_sel_hi:[1,1]
    v_pk_add_f32 v[8:9], v[8:9], v[12:13] op_sel:[0,0] op_sel_hi:[1,1]
    v_pk_add_f32 v[10:11], v[10:11], v[14:15] op_sel:[0,0] op_sel_hi:[1,1]
    v_lshlrev_b32 v12, 16, v232
    v_and_b32 v13, 0xffff0000, v232
    v_lshlrev_b32 v14, 16, v233
    v_and_b32 v15, 0xffff0000, v233
    v_pk_add_f32 v[8:9], v[8:9], v[12:13] op_sel:[0,0] op_sel_hi:[1,1]
    v_pk_add_f32 v[10:11], v[10:11], v[14:15] op_sel:[0,0] op_sel_hi:[1,1]
    v_cvt_pk_bf16_f32 v232, v8, v9
    v_cvt_pk_bf16_f32 v233, v10, v11
    buffer_store_dwordx2 v[232:233], v238, s[52:55], 0 offen
    s_cmp_ge_u32 s56, 4
    s_cbranch_scc1 L2_last
    v_add_u32 v2, 51200, v251
    ds_read_b128 v[72:75], v251 offset:0
    ds_read_b128 v[76:79], v251 offset:25600
    ds_read_b128 v[80:83], v2 offset:0
    ds_read_b128 v[84:87], v2 offset:25600
    ds_read_b128 v[88:91], v252
    ds_read_b128 v[92:95], v253
    ds_read_b128 v[96:99], v254
    ds_read_b128 v[100:103], v255
    s_waitcnt lgkmcnt(0)
    v_pk_add_f32 v[72:73], v[72:73], v[88:89] op_sel:[0,0] op_sel_hi:[1,1]
    v_pk_add_f32 v[74:75], v[74:75], v[90:91] op_sel:[0,0] op_sel_hi:[1,1]
    v_pk_add_f32 v[76:77], v[76:77], v[92:93] op_sel:[0,0] op_sel_hi:[1,1]
    v_pk_add_f32 v[78:79], v[78:79], v[94:95] op_sel:[0,0] op_sel_hi:[1,1]
    v_pk_add_f32 v[80:81], v[80:81], v[96:97] op_sel:[0,0] op_sel_hi:[1,1]
    v_pk_add_f32 v[82:83], v[82:83], v[98:99] op_sel:[0,0] op_sel_hi:[1,1]
    v_pk_add_f32 v[84:85], v[84:85], v[100:101] op_sel:[0,0] op_sel_hi:[1,1]
    v_pk_add_f32 v[86:87], v[86:87], v[102:103] op_sel:[0,0] op_sel_hi:[1,1]
    v_pk_add_f32 v[72:73], v[72:73], v[80:81] op_sel:[0,0] op_sel_hi:[1,1]
    v_pk_add_f32 v[74:75], v[74:75], v[82:83] op_sel:[0,0] op_sel_hi:[1,1]
    v_pk_add_f32 v[76:77], v[76:77], v[84:85] op_sel:[0,0] op_sel_hi:[1,1]
    v_pk_add_f32 v[78:79], v[78:79], v[86:87] op_sel:[0,0] op_sel_hi:[1,1]
    v_pk_add_f32 v[72:73], v[72:73], v[76:77] op_sel:[0,0] op_sel_hi:[1,1]
    v_pk_add_f32 v[74:75], v[74:75], v[78:79] op_sel:[0,0] op_sel_hi:[1,1]
    v_lshlrev_b32 v76, 16, v236
    v_and_b32 v77, 0xffff0000, v236
    v_lshlrev_b32 v78, 16, v237
    v_and_b32 v79, 0xffff0000, v237
    v_pk_add_f32 v[72:73], v[72:73], v[76:77] op_sel:[0,0] op_sel_hi:[1,1]
    v_pk_add_f32 v[74:75], v[74:75], v[78:79] op_sel:[0,0] op_sel_hi:[1,1]
    v_cvt_pk_bf16_f32 v236, v72, v73
    v_cvt_pk_bf16_f32 v237, v74, v75
    buffer_store_dwordx2 v[236:237], v240, s[52:55], 0 offen
L2_last:
    s_waitcnt lgkmcnt(0)
    v_pk_add_f32 v[40:41], v[40:41], v[56:57] op_sel:[0,0] op_sel_hi:[1,1]
    v_pk_add_f32 v[42:43], v[42:43], v[58:59] op_sel:[0,0] op_sel_hi:[1,1]
    v_pk_add_f32 v[44:45], v[44:45], v[60:61] op_sel:[0,0] op_sel_hi:[1,1]
    v_pk_add_f32 v[46:47], v[46:47], v[62:63] op_sel:[0,0] op_sel_hi:[1,1]
    v_pk_add_f32 v[48:49], v[48:49], v[64:65] op_sel:[0,0] op_sel_hi:[1,1]
    v_pk_add_f32 v[50:51], v[50:51], v[66:67] op_sel:[0,0] op_sel_hi:[1,1]
    v_pk_add_f32 v[52:53], v[52:53], v[68:69] op_sel:[0,0] op_sel_hi:[1,1]
    v_pk_add_f32 v[54:55], v[54:55], v[70:71] op_sel:[0,0] op_sel_hi:[1,1]
    v_pk_add_f32 v[40:41], v[40:41], v[48:49] op_sel:[0,0] op_sel_hi:[1,1]
    v_pk_add_f32 v[42:43], v[42:43], v[50:51] op_sel:[0,0] op_sel_hi:[1,1]
    v_pk_add_f32 v[44:45], v[44:45], v[52:53] op_sel:[0,0] op_sel_hi:[1,1]
    v_pk_add_f32 v[46:47], v[46:47], v[54:55] op_sel:[0,0] op_sel_hi:[1,1]
    v_pk_add_f32 v[40:41], v[40:41], v[44:45] op_sel:[0,0] op_sel_hi:[1,1]
    v_pk_add_f32 v[42:43], v[42:43], v[46:47] op_sel:[0,0] op_sel_hi:[1,1]
    v_lshlrev_b32 v44, 16, v234
    v_and_b32 v45, 0xffff0000, v234
    v_lshlrev_b32 v46, 16, v235
    v_and_b32 v47, 0xffff0000, v235
    v_pk_add_f32 v[40:41], v[40:41], v[44:45] op_sel:[0,0] op_sel_hi:[1,1]
    v_pk_add_f32 v[42:43], v[42:43], v[46:47] op_sel:[0,0] op_sel_hi:[1,1]
    v_cvt_pk_bf16_f32 v234, v40, v41
    v_cvt_pk_bf16_f32 v235, v42, v43
    buffer_store_dwordx2 v[234:235], v239, s[52:55], 0 offen
L2_done:
L_k1_exit:
    s_endpgm
L_code_end:
.section .rodata,"a"
.p2align 6
.amdhsa_kernel parallel_sum__linear_attn_block__geglu_ffn__prompt_kernel
  .amdhsa_next_free_vgpr 256
  .amdhsa_next_free_sgpr 102
  .amdhsa_accum_offset 256
  .amdhsa_group_segment_fixed_size 0
  .amdhsa_kernarg_size 80
  .amdhsa_user_sgpr_count 2
  .amdhsa_user_sgpr_kernarg_segment_ptr 1
  .amdhsa_system_sgpr_workgroup_id_x 1
.end_amdhsa_kernel
```
